```python
import torch

def _softmax(x, axis=-1):
    return torch.softmax(x, dim=axis)
def _gelu(x):
    return torch.nn.functional.gelu(x, approximate="tanh")
def _silu(x):
    return torch.nn.functional.silu(x)
def _sigmoid(x):
    return torch.sigmoid(x)
def _layernorm(x, axis=-1, eps=1e-5):
    m = x.mean(dim=axis, keepdim=True)
    v = x.var(dim=axis, keepdim=True, unbiased=False)
    return (x - m) / torch.sqrt(v + eps)
def _scatter_add(tgt, idx, src, axis=0):
    return tgt.clone().index_add_(axis, idx, src)
def _segment_sum(src, seg, n):
    out = torch.zeros((n,) + src.shape[1:], dtype=src.dtype)
    return out.index_add_(0, seg, src)
def _pad(x, pw):
    flat = tuple(v for pair in reversed(pw) for v in pair)
    return torch.nn.functional.pad(x, flat)

kernel_name = 'interleave_layers__sliding_local_dilated__dense_activation_squared_relu__prompt'

def setup_inputs():

    _w = (lambda a: (lambda t: t.to(torch.bfloat16) if t.is_floating_point() else t)(torch.as_tensor(a)))
    def _A_setup():
        B, S, D = 1, 2048, 640
        return {
            "x": _w((lambda *s: torch.randn(*s, dtype=torch.bfloat16) * 0.05)(B, S, D)),
            "wqkv": _w((lambda *s: torch.randn(*s, dtype=torch.bfloat16) * 0.05)(D, 3 * D)),
            "wo": _w((lambda *s: torch.randn(*s, dtype=torch.bfloat16) * 0.05)(D, D)),
        }
    _A_in = _A_setup()

    def _B_setup():
        B, S, D, F = 1, 2048, 640, 1728
        return {
            "x": _w((lambda *s: torch.randn(*s, dtype=torch.bfloat16) * 0.05)(B, S, D)),
            "w1": _w((lambda *s: torch.randn(*s, dtype=torch.bfloat16) * 0.05)(D, F)),
            "b1": _w((lambda *s: torch.randn(*s, dtype=torch.bfloat16) * 0.2)(F)),
            "w2": _w((lambda *s: torch.randn(*s, dtype=torch.bfloat16) * 0.05)(F, D)),
            "b2": _w((lambda *s: torch.randn(*s, dtype=torch.bfloat16) * 0.8)(D)),
        }
    _B_in = _B_setup()

    return {
        "A_x": _A_in["x"],
        "A_wqkv": _A_in["wqkv"],
        "A_wo": _A_in["wo"],
        "B_x": _B_in["x"],
        "B_w1": _B_in["w1"],
        "B_b1": _B_in["b1"],
        "B_w2": _B_in["w2"],
        "B_b2": _B_in["b2"],
    }

def reference(A_x, A_wqkv, A_wo, B_x, B_w1, B_b1, B_w2, B_b2):
    def _A_ref(x, wqkv, wo):
        B, S, D = x.shape
        H = 32; Dh = D // H
        W, dil = 8, 2
        qkv = (lambda x, *d: x.permute(*d))((x @ wqkv).reshape(B, S, 3, H, Dh), 2, 0, 3, 1, 4)
        q, k, v = qkv[0], qkv[1], qkv[2]
        scale = Dh ** -0.5
        pos = torch.arange(S)
        off = torch.arange(W) * dil
        idx = pos[:, None] - off[None, :]
        mask = idx >= 0
        idx_c = torch.where(mask, idx, 0).reshape(-1)
        kg = k[:, :, idx_c, :].reshape(B, H, S, W, Dh)
        vg = v[:, :, idx_c, :].reshape(B, H, S, W, Dh)
        logits = torch.einsum("bhsd,bhswd->bhsw", q, kg) * scale
        logits = torch.where(mask[None, None, :, :], logits, -1e9)
        attn = _softmax(logits, axis=-1)
        o = torch.einsum("bhsw,bhswd->bhsd", attn, vg)
        return (lambda x, *d: x.permute(*d))(o, 0, 2, 1, 3).reshape(B, S, D) @ wo

    def _B_ref(x, w1, b1, w2, b2):
        h = torch.einsum("bsd,df->bsf", x, w1) + b1
        zero = torch.zeros_like(h)
        r = torch.where(h > zero, h, zero)
        h = r * r
        out = torch.einsum("bsf,fd->bsd", h, w2) + b2
        return out

    x = A_x
    x = x + _A_ref(_layernorm(x, axis=-1), A_wqkv, A_wo)
    x = x + _B_ref(_layernorm(x, axis=-1), B_w1, B_b1, B_w2, B_b2)
    x = x + _A_ref(_layernorm(x, axis=-1), A_wqkv, A_wo)
    x = x + _B_ref(_layernorm(x, axis=-1), B_w1, B_b1, B_w2, B_b2)
    return x
```

```asm
; @launch kernel=pack_kernel grid=(316,1,1) block=(256,1,1) lds=32768
; @launch kernel=main_kernel grid=(256,1,1) block=(256,1,1) lds=161536
.amdgcn_target "amdgcn-amd-amdhsa--gfx950"
.text
.globl pack_kernel
.p2align 8
.type pack_kernel,@function
pack_kernel:
  s_cmp_ge_u32 s2, 316
  s_cbranch_scc1 pack_kernel_end
  s_load_dwordx4 s[20:23], s[0:1], 0
  s_load_dwordx2 s[24:25], s[0:1], 16
  s_load_dwordx2 s[26:27], s[0:1], 32
  s_load_dwordx2 s[28:29], s[0:1], 48
  s_load_dwordx2 s[30:31], s[0:1], 80
  v_lshrrev_b32 v1, 6, v0
  v_and_b32 v2, 63, v0
  v_readfirstlane_b32 s16, v1
  v_lshlrev_b32 v3, 4, v2
  s_waitcnt lgkmcnt(0)
  s_mov_b32 s4, s30
  s_and_b32 s5, s31, 0xffff
  s_mov_b32 s6, 0x10000000
  s_mov_b32 s7, 0x00020000
  s_cmp_eq_u32 s2, 307
  s_cbranch_scc1 pack_flags
  s_cmp_ge_u32 s2, 308
  s_cbranch_scc1 pack_warm
  s_cmp_ge_u32 s2, 144
  s_cbranch_scc1 pack_gen
  s_cmp_ge_u32 s2, 80
  s_cbranch_scc1 pack_x
  s_mov_b32 s8, s22
  s_and_b32 s9, s23, 0xffff
  s_mov_b32 s10, 0x258000
  s_mov_b32 s11, 0x00020000
  s_and_b32 s40, s2, 1
  s_lshr_b32 s41, s2, 1
  s_mul_i32 s42, s41, 61440
  s_mul_i32 s43, s40, 640
  s_add_u32 s42, s42, s43
  s_mov_b32 s44, 546
  s_add_u32 s45, s16, 0
  s_lshl_b32 s46, s45, 6
  v_add_u32 v4, s46, v2
  v_mul_u32_u24 v5, 2185, v4
  v_lshrrev_b32 v5, 18, v5
  v_mul_u32_u24 v6, 120, v5
  v_sub_u32 v6, v4, v6
  v_mul_u32_u24 v7, 205, v6
  v_lshrrev_b32 v7, 13, v7
  v_mul_u32_u24 v8, 40, v7
  v_sub_u32 v8, v6, v8
  v_mul_u32_u24 v5, 3840, v5
  v_mul_u32_u24 v7, 1280, v7
  v_add_u32 v5, v5, v7
  v_lshl_add_u32 v5, v8, 4, v5
  s_lshl_b32 m0, s45, 10
  s_nop 0
  buffer_load_dwordx4 v5, s[8:11], s42 offen lds
  s_add_u32 s45, s16, 4
  s_lshl_b32 s46, s45, 6
  v_add_u32 v4, s46, v2
  v_mul_u32_u24 v5, 2185, v4
  v_lshrrev_b32 v5, 18, v5
  v_mul_u32_u24 v6, 120, v5
  v_sub_u32 v6, v4, v6
  v_mul_u32_u24 v7, 205, v6
  v_lshrrev_b32 v7, 13, v7
  v_mul_u32_u24 v8, 40, v7
  v_sub_u32 v8, v6, v8
  v_mul_u32_u24 v5, 3840, v5
  v_mul_u32_u24 v7, 1280, v7
  v_add_u32 v5, v5, v7
  v_lshl_add_u32 v5, v8, 4, v5
  s_lshl_b32 m0, s45, 10
  s_nop 0
  buffer_load_dwordx4 v5, s[8:11], s42 offen lds
  s_add_u32 s45, s16, 8
  s_lshl_b32 s46, s45, 6
  v_add_u32 v4, s46, v2
  v_mul_u32_u24 v5, 2185, v4
  v_lshrrev_b32 v5, 18, v5
  v_mul_u32_u24 v6, 120, v5
  v_sub_u32 v6, v4, v6
  v_mul_u32_u24 v7, 205, v6
  v_lshrrev_b32 v7, 13, v7
  v_mul_u32_u24 v8, 40, v7
  v_sub_u32 v8, v6, v8
  v_mul_u32_u24 v5, 3840, v5
  v_mul_u32_u24 v7, 1280, v7
  v_add_u32 v5, v5, v7
  v_lshl_add_u32 v5, v8, 4, v5
  s_lshl_b32 m0, s45, 10
  s_nop 0
  buffer_load_dwordx4 v5, s[8:11], s42 offen lds
  s_add_u32 s45, s16, 12
  s_lshl_b32 s46, s45, 6
  v_add_u32 v4, s46, v2
  v_mul_u32_u24 v5, 2185, v4
  v_lshrrev_b32 v5, 18, v5
  v_mul_u32_u24 v6, 120, v5
  v_sub_u32 v6, v4, v6
  v_mul_u32_u24 v7, 205, v6
  v_lshrrev_b32 v7, 13, v7
  v_mul_u32_u24 v8, 40, v7
  v_sub_u32 v8, v6, v8
  v_mul_u32_u24 v5, 3840, v5
  v_mul_u32_u24 v7, 1280, v7
  v_add_u32 v5, v5, v7
  v_lshl_add_u32 v5, v8, 4, v5
  s_lshl_b32 m0, s45, 10
  s_nop 0
  buffer_load_dwordx4 v5, s[8:11], s42 offen lds
  s_add_u32 s45, s16, 16
  s_lshl_b32 s46, s45, 6
  v_add_u32 v4, s46, v2
  v_mul_u32_u24 v5, 2185, v4
  v_lshrrev_b32 v5, 18, v5
  v_mul_u32_u24 v6, 120, v5
  v_sub_u32 v6, v4, v6
  v_mul_u32_u24 v7, 205, v6
  v_lshrrev_b32 v7, 13, v7
  v_mul_u32_u24 v8, 40, v7
  v_sub_u32 v8, v6, v8
  v_mul_u32_u24 v5, 3840, v5
  v_mul_u32_u24 v7, 1280, v7
  v_add_u32 v5, v5, v7
  v_lshl_add_u32 v5, v8, 4, v5
  s_lshl_b32 m0, s45, 10
  s_nop 0
  buffer_load_dwordx4 v5, s[8:11], s42 offen lds
  s_add_u32 s45, s16, 20
  s_lshl_b32 s46, s45, 6
  v_add_u32 v4, s46, v2
  v_mul_u32_u24 v5, 2185, v4
  v_lshrrev_b32 v5, 18, v5
  v_mul_u32_u24 v6, 120, v5
  v_sub_u32 v6, v4, v6
  v_mul_u32_u24 v7, 205, v6
  v_lshrrev_b32 v7, 13, v7
  v_mul_u32_u24 v8, 40, v7
  v_sub_u32 v8, v6, v8
  v_mul_u32_u24 v5, 3840, v5
  v_mul_u32_u24 v7, 1280, v7
  v_add_u32 v5, v5, v7
  v_lshl_add_u32 v5, v8, 4, v5
  s_lshl_b32 m0, s45, 10
  s_nop 0
  buffer_load_dwordx4 v5, s[8:11], s42 offen lds
  s_add_u32 s45, s16, 24
  s_lshl_b32 s46, s45, 6
  v_add_u32 v4, s46, v2
  v_mul_u32_u24 v5, 2185, v4
  v_lshrrev_b32 v5, 18, v5
  v_mul_u32_u24 v6, 120, v5
  v_sub_u32 v6, v4, v6
  v_mul_u32_u24 v7, 205, v6
  v_lshrrev_b32 v7, 13, v7
  v_mul_u32_u24 v8, 40, v7
  v_sub_u32 v8, v6, v8
  v_mul_u32_u24 v5, 3840, v5
  v_mul_u32_u24 v7, 1280, v7
  v_add_u32 v5, v5, v7
  v_lshl_add_u32 v5, v8, 4, v5
  s_lshl_b32 m0, s45, 10
  s_nop 0
  buffer_load_dwordx4 v5, s[8:11], s42 offen lds
  s_add_u32 s45, s16, 28
  s_lshl_b32 s46, s45, 6
  v_add_u32 v4, s46, v2
  v_mul_u32_u24 v5, 2185, v4
  v_lshrrev_b32 v5, 18, v5
  v_mul_u32_u24 v6, 120, v5
  v_sub_u32 v6, v4, v6
  v_mul_u32_u24 v7, 205, v6
  v_lshrrev_b32 v7, 13, v7
  v_mul_u32_u24 v8, 40, v7
  v_sub_u32 v8, v6, v8
  v_mul_u32_u24 v5, 3840, v5
  v_mul_u32_u24 v7, 1280, v7
  v_add_u32 v5, v5, v7
  v_lshl_add_u32 v5, v8, 4, v5
  s_lshl_b32 m0, s45, 10
  s_cmp_ge_u32 s45, 30
  s_cbranch_scc1 pack_q_skip
  buffer_load_dwordx4 v5, s[8:11], s42 offen lds
pack_q_skip:
  v_lshrrev_b32 v4, 4, v2
  v_lshrrev_b32 v5, 1, v4
  v_and_b32 v6, 1, v4
  v_bfe_u32 v7, v2, 2, 2
  v_and_b32 v8, 3, v2
  v_lshl_add_u32 v7, v6, 3, v7
  v_mul_u32_u24 v7, 1920, v7
  s_lshl_b32 s45, s16, 3
  v_lshl_add_u32 v9, v8, 1, v5
  v_add_u32 v9, s45, v9
  v_lshlrev_b32 v10, 3, v9
  v_add_u32 v11, 1104, v10
  v_mov_b32 v12, 72
  v_cmp_ge_u32 vcc, 21, v9
  s_nop 1
  v_cndmask_b32 v11, v11, v12, vcc
  v_mov_b32 v12, -1
  v_cmp_ge_u32 vcc, 20, v9
  s_nop 1
  v_cndmask_b32 v11, v11, v12, vcc
  v_add_u32 v12, -88, v10
  v_cmp_ge_u32 vcc, 19, v9
  s_nop 1
  v_cndmask_b32 v11, v11, v12, vcc
  v_mov_b32 v12, -1
  v_cmp_ge_u32 vcc, 15, v9
  s_nop 1
  v_cndmask_b32 v11, v11, v12, vcc
  v_add_u32 v12, -80, v10
  v_cmp_ge_u32 vcc, 14, v9
  s_nop 1
  v_cndmask_b32 v11, v11, v12, vcc
  v_add_u32 v12, 632, v10
  v_cmp_ge_u32 vcc, 9, v9
  s_nop 1
  v_cndmask_b32 v11, v11, v12, vcc
  v_mov_b32 v12, 712
  v_cmp_ge_u32 vcc, 5, v9
  s_nop 1
  v_cndmask_b32 v11, v11, v12, vcc
  v_add_u32 v12, 640, v10
  v_cmp_ge_u32 vcc, 4, v9
  s_nop 1
  v_cndmask_b32 v11, v11, v12, vcc
  v_cmp_ne_u32 vcc, -1, v11
  s_nop 1
  v_cndmask_b32 v11, 0, v11, vcc
  v_add_u32 v11, v11, v7
  v_bfe_u32 v12, v2, 2, 2
  v_lshl_add_u32 v12, v12, 1, v5
  v_add_u32 v12, s45, v12
  v_cmp_ne_u32 vcc, 15, v12
  s_nop 1
  v_cndmask_b32 v13, 0, -1, vcc
  v_cmp_ne_u32 vcc, 20, v12
  s_nop 1
  v_cndmask_b32 v13, 0, v13, vcc
  v_mul_u32_u24 v14, 20480, v5
  v_lshl_add_u32 v14, v6, 8, v14
  v_and_b32 v15, 15, v2
  v_lshl_add_u32 v14, v15, 4, v14
  s_lshr_b32 s46, s41, 1
  s_and_b32 s47, s41, 1
  s_lshl_b32 s46, s46, 10
  s_lshl_b32 s47, s47, 9
  s_add_u32 s46, s46, s47
  s_mul_i32 s47, s16, 40960
  s_add_u32 s46, s46, s47
  s_mul_i32 s47, s40, 1310720
  s_add_u32 s46, s46, s47
  s_add_u32 s46, s46, 0
  s_waitcnt vmcnt(0)
  s_barrier
  ds_read_b64_tr_b16 v[16:17], v11 offset:0
  ds_read_b64_tr_b16 v[18:19], v11 offset:7680
  ds_read_b64_tr_b16 v[20:21], v11 offset:80
  ds_read_b64_tr_b16 v[22:23], v11 offset:7760
  ds_read_b64_tr_b16 v[24:25], v11 offset:160
  ds_read_b64_tr_b16 v[26:27], v11 offset:7840
  ds_read_b64_tr_b16 v[28:29], v11 offset:240
  ds_read_b64_tr_b16 v[30:31], v11 offset:7920
  ds_read_b64_tr_b16 v[32:33], v11 offset:320
  ds_read_b64_tr_b16 v[34:35], v11 offset:8000
  ds_read_b64_tr_b16 v[36:37], v11 offset:400
  ds_read_b64_tr_b16 v[38:39], v11 offset:8080
  ds_read_b64_tr_b16 v[40:41], v11 offset:480
  ds_read_b64_tr_b16 v[42:43], v11 offset:8160
  ds_read_b64_tr_b16 v[44:45], v11 offset:560
  ds_read_b64_tr_b16 v[46:47], v11 offset:8240
  s_waitcnt lgkmcnt(14)
  v_and_b32 v16, v16, v13
  v_and_b32 v17, v17, v13
  v_and_b32 v18, v18, v13
  v_and_b32 v19, v19, v13
  buffer_store_dwordx4 v[16:19], v14, s[4:7], s46 offen sc1
  s_add_u32 s46, s46, 163840
  s_waitcnt lgkmcnt(12)
  v_and_b32 v20, v20, v13
  v_and_b32 v21, v21, v13
  v_and_b32 v22, v22, v13
  v_and_b32 v23, v23, v13
  buffer_store_dwordx4 v[20:23], v14, s[4:7], s46 offen sc1
  s_add_u32 s46, s46, 163840
  s_waitcnt lgkmcnt(10)
  v_and_b32 v24, v24, v13
  v_and_b32 v25, v25, v13
  v_and_b32 v26, v26, v13
  v_and_b32 v27, v27, v13
  buffer_store_dwordx4 v[24:27], v14, s[4:7], s46 offen sc1
  s_add_u32 s46, s46, 163840
  s_waitcnt lgkmcnt(8)
  v_and_b32 v28, v28, v13
  v_and_b32 v29, v29, v13
  v_and_b32 v30, v30, v13
  v_and_b32 v31, v31, v13
  buffer_store_dwordx4 v[28:31], v14, s[4:7], s46 offen sc1
  s_add_u32 s46, s46, 163840
  s_waitcnt lgkmcnt(6)
  v_and_b32 v32, v32, v13
  v_and_b32 v33, v33, v13
  v_and_b32 v34, v34, v13
  v_and_b32 v35, v35, v13
  buffer_store_dwordx4 v[32:35], v14, s[4:7], s46 offen sc1
  s_add_u32 s46, s46, 163840
  s_waitcnt lgkmcnt(4)
  v_and_b32 v36, v36, v13
  v_and_b32 v37, v37, v13
  v_and_b32 v38, v38, v13
  v_and_b32 v39, v39, v13
  buffer_store_dwordx4 v[36:39], v14, s[4:7], s46 offen sc1
  s_add_u32 s46, s46, 163840
  s_waitcnt lgkmcnt(2)
  v_and_b32 v40, v40, v13
  v_and_b32 v41, v41, v13
  v_and_b32 v42, v42, v13
  v_and_b32 v43, v43, v13
  buffer_store_dwordx4 v[40:43], v14, s[4:7], s46 offen sc1
  s_add_u32 s46, s46, 163840
  s_waitcnt lgkmcnt(0)
  v_and_b32 v44, v44, v13
  v_and_b32 v45, v45, v13
  v_and_b32 v46, v46, v13
  v_and_b32 v47, v47, v13
  buffer_store_dwordx4 v[44:47], v14, s[4:7], s46 offen sc1
  s_add_u32 s46, s46, 163840
  s_branch pack_kernel_end
pack_gen:
  s_sub_u32 s17, s2, 144
  s_lshl_b32 s17, s17, 2
  s_add_u32 s17, s17, s16
  s_cmp_ge_u32 s17, 650
  s_cbranch_scc1 pack_kernel_end
  s_cmp_ge_u32 s17, 280
  s_cbranch_scc1 pack_g1
  s_mov_b32 s8, s26
  s_and_b32 s9, s27, 0xffff
  s_mov_b32 s10, 0x21c000
  s_mov_b32 s11, 0x00020000
  s_mov_b32 s40, 3456
  s_mov_b32 s41, 20
  s_mov_b32 s42, 3473408
  s_mul_i32 s43, s17, 2341
  s_lshr_b32 s43, s43, 16
  s_mul_i32 s44, s43, 28
  s_sub_u32 s44, s17, s44
  s_branch pack_g_go
pack_g1:
  s_cmp_ge_u32 s17, 380
  s_cbranch_scc1 pack_g2
  s_mov_b32 s8, s24
  s_and_b32 s9, s25, 0xffff
  s_mov_b32 s10, 0xc8000
  s_mov_b32 s11, 0x00020000
  s_mov_b32 s40, 1280
  s_mov_b32 s41, 20
  s_mov_b32 s42, 2621440
  s_sub_u32 s17, s17, 280
  s_branch pack_g10
pack_g2:
  s_mov_b32 s8, s28
  s_and_b32 s9, s29, 0xffff
  s_mov_b32 s10, 0x21c000
  s_mov_b32 s11, 0x00020000
  s_mov_b32 s40, 1280
  s_mov_b32 s41, 54
  s_mov_b32 s42, 5767168
  s_sub_u32 s17, s17, 380
pack_g10:
  s_mul_i32 s43, s17, 6554
  s_lshr_b32 s43, s43, 16
  s_mul_i32 s44, s43, 10
  s_sub_u32 s44, s17, s44
pack_g_go:
  v_lshrrev_b32 v4, 3, v2
  v_and_b32 v5, 7, v2
  v_mul_lo_u32 v4, v4, s40
  v_lshl_add_u32 v4, v5, 4, v4
  s_mul_i32 s45, s43, s40
  s_lshl_b32 s45, s45, 6
  s_lshl_b32 s46, s44, 7
  s_add_u32 s45, s45, s46
  s_cmp_ge_u32 s46, s40
  s_cselect_b32 s45, 0x7ff00000, s45
  s_lshl_b32 s47, s40, 3
  s_lshl_b32 s48, s16, 13
  s_add_u32 m0, s48, 0
  s_nop 0
  buffer_load_dwordx4 v4, s[8:11], s45 offen lds
  s_add_u32 s45, s45, s47
  s_add_u32 m0, s48, 1024
  s_nop 0
  buffer_load_dwordx4 v4, s[8:11], s45 offen lds
  s_add_u32 s45, s45, s47
  s_add_u32 m0, s48, 2048
  s_nop 0
  buffer_load_dwordx4 v4, s[8:11], s45 offen lds
  s_add_u32 s45, s45, s47
  s_add_u32 m0, s48, 3072
  s_nop 0
  buffer_load_dwordx4 v4, s[8:11], s45 offen lds
  s_add_u32 s45, s45, s47
  s_add_u32 m0, s48, 4096
  s_nop 0
  buffer_load_dwordx4 v4, s[8:11], s45 offen lds
  s_add_u32 s45, s45, s47
  s_add_u32 m0, s48, 5120
  s_nop 0
  buffer_load_dwordx4 v4, s[8:11], s45 offen lds
  s_add_u32 s45, s45, s47
  s_add_u32 m0, s48, 6144
  s_nop 0
  buffer_load_dwordx4 v4, s[8:11], s45 offen lds
  s_add_u32 s45, s45, s47
  s_add_u32 m0, s48, 7168
  s_nop 0
  buffer_load_dwordx4 v4, s[8:11], s45 offen lds
  s_add_u32 s45, s45, s47
  v_lshrrev_b32 v6, 4, v2
  v_bfe_u32 v7, v2, 2, 2
  v_lshl_add_u32 v6, v6, 3, v7
  v_lshlrev_b32 v6, 7, v6
  v_and_b32 v7, 3, v2
  v_lshl_add_u32 v6, v7, 4, v6
  v_add_u32 v6, s48, v6
  s_lshl_b32 s49, s44, 2
  s_mul_i32 s49, s49, s41
  s_lshl_b32 s50, s43, 1
  s_add_u32 s49, s49, s50
  s_lshl_b32 s49, s49, 10
  s_add_u32 s49, s49, s42
  s_lshl_b32 s50, s41, 10
  s_waitcnt vmcnt(4)
  ds_read_b64_tr_b16 v[16:17], v6 offset:0
  ds_read_b64_tr_b16 v[18:19], v6 offset:512
  ds_read_b64_tr_b16 v[20:21], v6 offset:8
  ds_read_b64_tr_b16 v[22:23], v6 offset:520
  ds_read_b64_tr_b16 v[24:25], v6 offset:64
  ds_read_b64_tr_b16 v[26:27], v6 offset:576
  ds_read_b64_tr_b16 v[28:29], v6 offset:72
  ds_read_b64_tr_b16 v[30:31], v6 offset:584
  s_mov_b32 s51, s49
  s_waitcnt lgkmcnt(6)
  buffer_store_dwordx4 v[16:19], v3, s[4:7], s51 offen offset:0 sc1
  s_add_u32 s51, s51, s50
  s_waitcnt lgkmcnt(4)
  buffer_store_dwordx4 v[20:23], v3, s[4:7], s51 offen offset:0 sc1
  s_add_u32 s51, s51, s50
  s_waitcnt lgkmcnt(2)
  buffer_store_dwordx4 v[24:27], v3, s[4:7], s51 offen offset:0 sc1
  s_add_u32 s51, s51, s50
  s_waitcnt lgkmcnt(0)
  buffer_store_dwordx4 v[28:31], v3, s[4:7], s51 offen offset:0 sc1
  s_add_u32 s51, s51, s50
  s_waitcnt vmcnt(4)
  ds_read_b64_tr_b16 v[32:33], v6 offset:4096
  ds_read_b64_tr_b16 v[34:35], v6 offset:4608
  ds_read_b64_tr_b16 v[36:37], v6 offset:4104
  ds_read_b64_tr_b16 v[38:39], v6 offset:4616
  ds_read_b64_tr_b16 v[40:41], v6 offset:4160
  ds_read_b64_tr_b16 v[42:43], v6 offset:4672
  ds_read_b64_tr_b16 v[44:45], v6 offset:4168
  ds_read_b64_tr_b16 v[46:47], v6 offset:4680
  s_mov_b32 s51, s49
  s_waitcnt lgkmcnt(6)
  buffer_store_dwordx4 v[32:35], v3, s[4:7], s51 offen offset:1024 sc1
  s_add_u32 s51, s51, s50
  s_waitcnt lgkmcnt(4)
  buffer_store_dwordx4 v[36:39], v3, s[4:7], s51 offen offset:1024 sc1
  s_add_u32 s51, s51, s50
  s_waitcnt lgkmcnt(2)
  buffer_store_dwordx4 v[40:43], v3, s[4:7], s51 offen offset:1024 sc1
  s_add_u32 s51, s51, s50
  s_waitcnt lgkmcnt(0)
  buffer_store_dwordx4 v[44:47], v3, s[4:7], s51 offen offset:1024 sc1
  s_add_u32 s51, s51, s50
  s_branch pack_kernel_end
pack_x:
  s_mov_b32 s8, s20
  s_and_b32 s9, s21, 0xffff
  s_mov_b32 s10, 0x280000
  s_mov_b32 s11, 0x00020000
  s_sub_u32 s44, s2, 80
  s_lshl_b32 s44, s44, 2
  s_add_u32 s44, s44, s16
  s_lshr_b32 s45, s44, 1
  s_and_b32 s46, s44, 1
  v_and_b32 v4, 15, v2
  v_lshrrev_b32 v5, 4, v2
  v_mul_u32_u24 v6, 1280, v4
  v_lshl_add_u32 v6, v5, 4, v6
  s_mul_i32 s41, s45, 20480
  s_mul_i32 s47, s46, 640
  s_add_u32 s47, s47, s41
  s_mul_i32 s42, s46, 10240
  s_add_u32 s42, s42, s41
  s_add_u32 s42, s42, 8388608
  buffer_load_dwordx4 v[16:19], v6, s[8:11], s47 offen offset:0
  buffer_load_dwordx4 v[20:23], v6, s[8:11], s47 offen offset:64
  buffer_load_dwordx4 v[24:27], v6, s[8:11], s47 offen offset:128
  buffer_load_dwordx4 v[28:31], v6, s[8:11], s47 offen offset:192
  buffer_load_dwordx4 v[32:35], v6, s[8:11], s47 offen offset:256
  buffer_load_dwordx4 v[36:39], v6, s[8:11], s47 offen offset:320
  buffer_load_dwordx4 v[40:43], v6, s[8:11], s47 offen offset:384
  buffer_load_dwordx4 v[44:47], v6, s[8:11], s47 offen offset:448
  buffer_load_dwordx4 v[48:51], v6, s[8:11], s47 offen offset:512
  buffer_load_dwordx4 v[52:55], v6, s[8:11], s47 offen offset:576
  v_mov_b32 v8, 0
  v_mov_b32 v9, 0
  v_mov_b32 v12, 0x3f803f80
  s_waitcnt vmcnt(9)
  buffer_store_dwordx4 v[16:19], v3, s[4:7], s42 offen sc1
  s_add_u32 s42, s42, 1024
  v_dot2c_f32_bf16 v8, v16, v12
  v_dot2c_f32_bf16 v9, v16, v16
  v_dot2c_f32_bf16 v8, v17, v12
  v_dot2c_f32_bf16 v9, v17, v17
  v_dot2c_f32_bf16 v8, v18, v12
  v_dot2c_f32_bf16 v9, v18, v18
  v_dot2c_f32_bf16 v8, v19, v12
  v_dot2c_f32_bf16 v9, v19, v19
  s_waitcnt vmcnt(9)
  buffer_store_dwordx4 v[20:23], v3, s[4:7], s42 offen sc1
  s_add_u32 s42, s42, 1024
  v_dot2c_f32_bf16 v8, v20, v12
  v_dot2c_f32_bf16 v9, v20, v20
  v_dot2c_f32_bf16 v8, v21, v12
  v_dot2c_f32_bf16 v9, v21, v21
  v_dot2c_f32_bf16 v8, v22, v12
  v_dot2c_f32_bf16 v9, v22, v22
  v_dot2c_f32_bf16 v8, v23, v12
  v_dot2c_f32_bf16 v9, v23, v23
  s_waitcnt vmcnt(9)
  buffer_store_dwordx4 v[24:27], v3, s[4:7], s42 offen sc1
  s_add_u32 s42, s42, 1024
  v_dot2c_f32_bf16 v8, v24, v12
  v_dot2c_f32_bf16 v9, v24, v24
  v_dot2c_f32_bf16 v8, v25, v12
  v_dot2c_f32_bf16 v9, v25, v25
  v_dot2c_f32_bf16 v8, v26, v12
  v_dot2c_f32_bf16 v9, v26, v26
  v_dot2c_f32_bf16 v8, v27, v12
  v_dot2c_f32_bf16 v9, v27, v27
  s_waitcnt vmcnt(9)
  buffer_store_dwordx4 v[28:31], v3, s[4:7], s42 offen sc1
  s_add_u32 s42, s42, 1024
  v_dot2c_f32_bf16 v8, v28, v12
  v_dot2c_f32_bf16 v9, v28, v28
  v_dot2c_f32_bf16 v8, v29, v12
  v_dot2c_f32_bf16 v9, v29, v29
  v_dot2c_f32_bf16 v8, v30, v12
  v_dot2c_f32_bf16 v9, v30, v30
  v_dot2c_f32_bf16 v8, v31, v12
  v_dot2c_f32_bf16 v9, v31, v31
  s_waitcnt vmcnt(9)
  buffer_store_dwordx4 v[32:35], v3, s[4:7], s42 offen sc1
  s_add_u32 s42, s42, 1024
  v_dot2c_f32_bf16 v8, v32, v12
  v_dot2c_f32_bf16 v9, v32, v32
  v_dot2c_f32_bf16 v8, v33, v12
  v_dot2c_f32_bf16 v9, v33, v33
  v_dot2c_f32_bf16 v8, v34, v12
  v_dot2c_f32_bf16 v9, v34, v34
  v_dot2c_f32_bf16 v8, v35, v12
  v_dot2c_f32_bf16 v9, v35, v35
  s_waitcnt vmcnt(9)
  buffer_store_dwordx4 v[36:39], v3, s[4:7], s42 offen sc1
  s_add_u32 s42, s42, 1024
  v_dot2c_f32_bf16 v8, v36, v12
  v_dot2c_f32_bf16 v9, v36, v36
  v_dot2c_f32_bf16 v8, v37, v12
  v_dot2c_f32_bf16 v9, v37, v37
  v_dot2c_f32_bf16 v8, v38, v12
  v_dot2c_f32_bf16 v9, v38, v38
  v_dot2c_f32_bf16 v8, v39, v12
  v_dot2c_f32_bf16 v9, v39, v39
  s_waitcnt vmcnt(9)
  buffer_store_dwordx4 v[40:43], v3, s[4:7], s42 offen sc1
  s_add_u32 s42, s42, 1024
  v_dot2c_f32_bf16 v8, v40, v12
  v_dot2c_f32_bf16 v9, v40, v40
  v_dot2c_f32_bf16 v8, v41, v12
  v_dot2c_f32_bf16 v9, v41, v41
  v_dot2c_f32_bf16 v8, v42, v12
  v_dot2c_f32_bf16 v9, v42, v42
  v_dot2c_f32_bf16 v8, v43, v12
  v_dot2c_f32_bf16 v9, v43, v43
  s_waitcnt vmcnt(9)
  buffer_store_dwordx4 v[44:47], v3, s[4:7], s42 offen sc1
  s_add_u32 s42, s42, 1024
  v_dot2c_f32_bf16 v8, v44, v12
  v_dot2c_f32_bf16 v9, v44, v44
  v_dot2c_f32_bf16 v8, v45, v12
  v_dot2c_f32_bf16 v9, v45, v45
  v_dot2c_f32_bf16 v8, v46, v12
  v_dot2c_f32_bf16 v9, v46, v46
  v_dot2c_f32_bf16 v8, v47, v12
  v_dot2c_f32_bf16 v9, v47, v47
  s_waitcnt vmcnt(9)
  buffer_store_dwordx4 v[48:51], v3, s[4:7], s42 offen sc1
  s_add_u32 s42, s42, 1024
  v_dot2c_f32_bf16 v8, v48, v12
  v_dot2c_f32_bf16 v9, v48, v48
  v_dot2c_f32_bf16 v8, v49, v12
  v_dot2c_f32_bf16 v9, v49, v49
  v_dot2c_f32_bf16 v8, v50, v12
  v_dot2c_f32_bf16 v9, v50, v50
  v_dot2c_f32_bf16 v8, v51, v12
  v_dot2c_f32_bf16 v9, v51, v51
  s_waitcnt vmcnt(9)
  buffer_store_dwordx4 v[52:55], v3, s[4:7], s42 offen sc1
  s_add_u32 s42, s42, 1024
  v_dot2c_f32_bf16 v8, v52, v12
  v_dot2c_f32_bf16 v9, v52, v52
  v_dot2c_f32_bf16 v8, v53, v12
  v_dot2c_f32_bf16 v9, v53, v53
  v_dot2c_f32_bf16 v8, v54, v12
  v_dot2c_f32_bf16 v9, v54, v54
  v_dot2c_f32_bf16 v8, v55, v12
  v_dot2c_f32_bf16 v9, v55, v55
  s_nop 1
  v_mov_b32 v13, v8
  s_nop 1
  v_permlane16_swap_b32 v8, v13
  v_add_f32 v8, v8, v13
  v_mov_b32 v13, v8
  s_nop 1
  v_permlane32_swap_b32 v8, v13
  v_add_f32 v8, v8, v13
  v_mov_b32 v13, v9
  s_nop 1
  v_permlane16_swap_b32 v9, v13
  v_add_f32 v9, v9, v13
  v_mov_b32 v13, v9
  s_nop 1
  v_permlane32_swap_b32 v9, v13
  v_add_f32 v9, v9, v13
  v_mov_b32 v10, 0
  v_mov_b32 v11, 0
  v_cmp_gt_u32 vcc, 16, v2
  s_nop 1
  v_cndmask_b32 v8, 0, v8, vcc
  v_cndmask_b32 v9, 0, v9, vcc
  v_lshlrev_b32 v13, 7, v4
  v_lshl_add_u32 v13, v5, 4, v13
  s_lshl_b32 s42, s45, 11
  s_lshl_b32 s47, s46, 6
  s_add_u32 s42, s42, s47
  s_add_u32 s42, s42, 39845888
  buffer_store_dwordx4 v[8:11], v13, s[4:7], s42 offen sc1
  s_branch pack_kernel_end
pack_flags:
  v_lshlrev_b32 v6, 2, v0
  v_mov_b32 v7, 1
  s_mov_b32 s42, 43646976
  buffer_store_dword v7, v6, s[4:7], s42 offen
  v_mov_b32 v7, 1
  s_mov_b32 s42, 43648000
  buffer_store_dword v7, v6, s[4:7], s42 offen
  v_mov_b32 v7, 0
  s_mov_b32 s42, 43649024
  buffer_store_dword v7, v6, s[4:7], s42 offen
  v_mov_b32 v7, 0
  s_mov_b32 s42, 43650048
  buffer_store_dword v7, v6, s[4:7], s42 offen
  v_mov_b32 v7, 0
  s_mov_b32 s42, 43651072
  buffer_store_dword v7, v6, s[4:7], s42 offen
  v_mov_b32 v7, 0
  s_mov_b32 s42, 43652096
  buffer_store_dword v7, v6, s[4:7], s42 offen
  v_mov_b32 v7, 0
  s_mov_b32 s42, 43653120
  buffer_store_dword v7, v6, s[4:7], s42 offen
  v_mov_b32 v7, 0
  s_mov_b32 s42, 43654144
  buffer_store_dword v7, v6, s[4:7], s42 offen
  v_mov_b32 v7, 0
  s_mov_b32 s42, 43655168
  buffer_store_dword v7, v6, s[4:7], s42 offen
  v_mov_b32 v7, 0
  s_mov_b32 s42, 43656192
  buffer_store_dword v7, v6, s[4:7], s42 offen
  v_mov_b32 v7, 0
  s_mov_b32 s42, 43657216
  buffer_store_dword v7, v6, s[4:7], s42 offen
  v_mov_b32 v7, 0
  s_mov_b32 s42, 43658240
  buffer_store_dword v7, v6, s[4:7], s42 offen
  v_mov_b32 v7, 0
  s_mov_b32 s42, 43659264
  buffer_store_dword v7, v6, s[4:7], s42 offen
  v_mov_b32 v7, 0
  s_mov_b32 s42, 43660288
  buffer_store_dword v7, v6, s[4:7], s42 offen
  v_mov_b32 v7, 0
  s_mov_b32 s42, 43661312
  buffer_store_dword v7, v6, s[4:7], s42 offen
  v_mov_b32 v7, 0
  s_mov_b32 s42, 43662336
  buffer_store_dword v7, v6, s[4:7], s42 offen
  v_mov_b32 v7, 0
  s_mov_b32 s42, 43663360
  buffer_store_dword v7, v6, s[4:7], s42 offen
  v_mov_b32 v7, 0
  s_mov_b32 s42, 43664384
  buffer_store_dword v7, v6, s[4:7], s42 offen
  v_cmp_gt_u32 vcc, 16, v0
  s_nop 1
  v_cndmask_b32 v7, 0, 1, vcc
  s_mov_b32 s42, 43679744
  buffer_store_dword v7, v6, s[4:7], s42 offen
  s_mov_b32 s42, 43680768
  buffer_store_dword v7, v6, s[4:7], s42 offen
  s_mov_b32 s42, 43681792
  buffer_store_dword v7, v6, s[4:7], s42 offen
  v_mov_b32 v7, 0
  s_mov_b32 s42, 43515904
  buffer_store_dword v7, v6, s[4:7], s42 offen
  s_mov_b32 s42, 43516928
  buffer_store_dword v7, v6, s[4:7], s42 offen
  s_mov_b32 s42, 43517952
  buffer_store_dword v7, v6, s[4:7], s42 offen
  s_mov_b32 s42, 43518976
  buffer_store_dword v7, v6, s[4:7], s42 offen
  s_mov_b32 s42, 43520000
  buffer_store_dword v7, v6, s[4:7], s42 offen
  s_branch pack_kernel_end
pack_warm:
  s_getpc_b64 s[40:41]
pack_pc:
  s_add_u32 s40, s40, main_kernel-pack_pc
  s_addc_u32 s41, s41, 0
  v_lshlrev_b32 v4, 4, v0
  global_load_dwordx4 v[8:11], v4, s[40:41]
  v_add_u32 v4, 4096, v4
  global_load_dwordx4 v[8:11], v4, s[40:41]
  v_add_u32 v4, 4096, v4
  global_load_dwordx4 v[8:11], v4, s[40:41]
  v_add_u32 v4, 4096, v4
  global_load_dwordx4 v[8:11], v4, s[40:41]
  v_add_u32 v4, 4096, v4
  global_load_dwordx4 v[8:11], v4, s[40:41]
  v_add_u32 v4, 4096, v4
  global_load_dwordx4 v[8:11], v4, s[40:41]
  v_add_u32 v4, 4096, v4
  global_load_dwordx4 v[8:11], v4, s[40:41]
  v_add_u32 v4, 4096, v4
  global_load_dwordx4 v[8:11], v4, s[40:41]
  v_add_u32 v4, 4096, v4
  global_load_dwordx4 v[8:11], v4, s[40:41]
  v_add_u32 v4, 4096, v4
  global_load_dwordx4 v[8:11], v4, s[40:41]
  v_add_u32 v4, 4096, v4
  global_load_dwordx4 v[8:11], v4, s[40:41]
  v_add_u32 v4, 4096, v4
  global_load_dwordx4 v[8:11], v4, s[40:41]
  v_add_u32 v4, 4096, v4
  global_load_dwordx4 v[8:11], v4, s[40:41]
  v_add_u32 v4, 4096, v4
  global_load_dwordx4 v[8:11], v4, s[40:41]
  v_add_u32 v4, 4096, v4
  s_waitcnt vmcnt(0)
pack_kernel_end:
  s_endpgm
.globl main_kernel
.p2align 8
.type main_kernel,@function
main_kernel:
  s_cmp_ge_u32 s2, 256
  s_cbranch_scc1 main_kernel_end
  s_load_dwordx2 s[52:53], s[0:1], 80
  s_load_dwordx2 s[54:55], s[0:1], 40
  s_load_dwordx2 s[56:57], s[0:1], 56
  s_load_dwordx2 s[58:59], s[0:1], 64
  v_lshrrev_b32 v1, 6, v0
  v_and_b32 v2, 63, v0
  v_readfirstlane_b32 s20, v1
  s_and_b32 s60, s2, 7
  s_lshr_b32 s61, s2, 3
  s_lshl_b32 s21, s60, 1
  s_lshr_b32 s62, s61, 4
  s_add_u32 s21, s21, s62
  s_and_b32 s22, s61, 15
  s_lshr_b32 s34, s22, 3
  s_and_b32 s35, s22, 7
  v_lshlrev_b32 v3, 4, v2
  s_lshl_b32 s33, s22, 2
  s_add_u32 s33, s33, s20
  s_mul_i32 s31, s33, 40960
  s_add_u32 s32, s31, 3473408
  s_add_u32 s31, s31, 0
  s_waitcnt lgkmcnt(0)
  s_mov_b32 s4, s52
  s_and_b32 s5, s53, 0xffff
  s_mov_b32 s6, 0x10000000
  s_mov_b32 s7, 0x00020000
  s_lshl_b32 s29, s21, 3
  s_mul_i32 s30, s20, 5120
  s_mul_i32 s69, s29, 20480
  s_add_u32 s69, s69, s30
  v_mov_b32 v87, 0
  s_add_u32 s60, s69, 8531968
  s_mov_b32 m0, s30
  v_and_b32 v14, 15, v2
  buffer_load_dwordx4 v3, s[4:7], s60 offen offset:0 sc1 lds
  buffer_load_dwordx4 v3, s[4:7], s60 offen offset:1024 sc1 lds
  buffer_load_dwordx4 v3, s[4:7], s60 offen offset:2048 sc1 lds
  buffer_load_dwordx4 v3, s[4:7], s60 offen offset:3072 sc1 lds
  s_add_u32 m0, s30, 4096
  s_add_u32 s60, s60, 4096
  buffer_load_dwordx4 v3, s[4:7], s60 offen sc1 lds
  v_lshrrev_b32 v15, 4, v2
  v_lshlrev_b32 v21, 7, v14
  v_lshl_add_u32 v12, v15, 5, v21
  s_sub_u32 s60, s29, s20
  s_lshl_b32 s60, s60, 11
  s_add_u32 s60, s60, 39860224
  buffer_load_dwordx4 v[72:75], v12, s[4:7], s60 offen sc1
  buffer_load_dwordx4 v[76:79], v12, s[4:7], s60 offen offset:16 sc1
  s_add_u32 s64, s31, 0
  s_add_u32 s65, s31, 4096
  s_add_u32 s66, s31, 8192
  s_add_u32 s67, s31, 12288
  s_add_u32 s68, s31, 16384
  v_add_u32 v30, 20480, v3
  s_add_u32 s60, s69, 8511488
  s_add_u32 m0, s30, 20480
  s_nop 0
  buffer_load_dwordx4 v3, s[4:7], s60 offen offset:0 sc1 lds
  buffer_load_dwordx4 v3, s[4:7], s60 offen offset:1024 sc1 lds
  buffer_load_dwordx4 v3, s[4:7], s60 offen offset:2048 sc1 lds
  buffer_load_dwordx4 v3, s[4:7], s60 offen offset:3072 sc1 lds
  s_add_u32 m0, s30, 24576
  s_add_u32 s60, s60, 4096
  buffer_load_dwordx4 v3, s[4:7], s60 offen sc1 lds
  s_add_u32 s60, s69, 8491008
  s_add_u32 m0, s30, 40960
  s_nop 0
  buffer_load_dwordx4 v3, s[4:7], s60 offen offset:0 sc1 lds
  buffer_load_dwordx4 v3, s[4:7], s60 offen offset:1024 sc1 lds
  buffer_load_dwordx4 v3, s[4:7], s60 offen offset:2048 sc1 lds
  buffer_load_dwordx4 v3, s[4:7], s60 offen offset:3072 sc1 lds
  s_add_u32 m0, s30, 45056
  s_add_u32 s60, s60, 4096
  buffer_load_dwordx4 v3, s[4:7], s60 offen sc1 lds
  s_add_u32 s60, s69, 8470528
  s_add_u32 m0, s30, 61440
  s_nop 0
  buffer_load_dwordx4 v3, s[4:7], s60 offen offset:0 sc1 lds
  buffer_load_dwordx4 v3, s[4:7], s60 offen offset:1024 sc1 lds
  buffer_load_dwordx4 v3, s[4:7], s60 offen offset:2048 sc1 lds
  buffer_load_dwordx4 v3, s[4:7], s60 offen offset:3072 sc1 lds
  s_add_u32 m0, s30, 65536
  s_add_u32 s60, s60, 4096
  buffer_load_dwordx4 v3, s[4:7], s60 offen sc1 lds
  buffer_load_dwordx4 a[0:3], v3, s[4:7], s64 offen offset:0
  buffer_load_dwordx4 a[4:7], v30, s[4:7], s64 offen offset:0
  buffer_load_dwordx4 a[8:11], v3, s[4:7], s64 offen offset:1024
  buffer_load_dwordx4 a[12:15], v30, s[4:7], s64 offen offset:1024
  s_mov_b32 s16, s58
  s_and_b32 s17, s59, 0xffff
  s_mov_b32 s18, 0x280000
  s_mov_b32 s19, 0x00020000
  s_mov_b32 s23, 0
  s_mov_b32 s24, 0
  s_mov_b32 s25, 0
  s_mov_b32 s26, 0
  s_mov_b32 s27, 0
  s_mov_b32 s28, 0
  s_cmp_ge_u32 s22, 14
  buffer_load_dwordx4 a[16:19], v3, s[4:7], s64 offen offset:2048
  s_cselect_b32 s32, 0x7ff00000, s32
  s_cselect_b32 s50, 0x7ff00000, 0
  s_lshr_b32 s43, s20, 1
  s_and_b32 s45, s20, 1
  s_lshr_b32 s60, s35, 1
  s_and_b32 s61, s35, 1
  s_lshl_b32 s44, s61, 3
  s_mul_i32 s62, s60, 5
  s_add_u32 s42, s62, 2
  s_mul_i32 s63, s61, 3
  s_add_u32 s62, s62, s63
  s_add_u32 s41, s62, s43
  buffer_load_dwordx4 a[20:23], v30, s[4:7], s64 offen offset:2048
  s_xor_b32 s63, s43, 1
  s_add_u32 s63, s62, s63
  s_lshl_b32 s36, s41, 1
  s_add_u32 s37, s36, 1
  s_lshl_b32 s38, s63, 1
  s_add_u32 s39, s38, 1
  s_lshl_b32 s40, s42, 1
  s_add_u32 s40, s40, s61
  s_sub_u32 s60, s29, s43
  s_mul_i32 s71, s60, 20480
  s_add_u32 s71, s71, 18874368
  s_add_u32 s3, s69, s50
  buffer_load_dwordx4 a[24:27], v3, s[4:7], s64 offen offset:3072
  s_mul_i32 s70, s29, 57344
  s_lshl_b32 s60, s33, 10
  s_add_u32 s70, s70, s60
  s_add_u32 s70, s70, s50
  s_add_u32 s70, s70, 25165824
  s_lshl_b32 s100, s21, 6
  s_add_u32 s100, s100, 43646976
  s_lshl_b32 s60, s21, 4
  s_add_u32 s60, s60, s22
  s_mul_i32 s48, s60, 4608
  s_add_u32 s48, s48, 40894464
  s_sub_u32 s46, s48, 73728
  buffer_load_dwordx4 a[28:31], v30, s[4:7], s64 offen offset:3072
  s_lshl_b32 s47, s60, 2
  s_add_u32 s47, s47, 43679744
  s_add_u32 s49, s47, 64
  s_cmp_eq_u32 s21, 0
  s_cselect_b32 s46, 43515904, s46
  s_cmp_eq_u32 s21, 15
  s_cselect_b32 s49, 0x7ff00000, s49
  s_cmp_eq_u32 s21, 0
  s_cselect_b32 s60, s43, 0
  s_cmp_eq_u32 s60, 1
  s_cselect_b32 s51, 0xf149f2ca, 0
  v_lshlrev_b32 v13, 4, v15
  buffer_load_dwordx4 a[32:35], v3, s[4:7], s65 offen offset:0
  v_add_u32 v4, 61440, v3
  v_lshlrev_b32 v5, 2, v14
  v_mul_u32_u24 v22, 1280, v14
  v_add_u32 v22, v22, v13
  v_lshlrev_b32 v23, 3, v14
  v_add_u32 v23, 141568, v23
  s_lshl_b32 s60, s20, 11
  s_add_u32 s60, s60, 142592
  v_add_u32 v0, s60, v3
  s_mul_i32 s60, s20, 640
  s_add_u32 s60, s60, 158976
  v_lshlrev_b32 v1, 5, v15
  buffer_load_dwordx4 a[36:39], v30, s[4:7], s65 offen offset:0
  v_add_u32 v1, s60, v1
  v_mov_b32 v86, 1
  v_mov_b32 v87, 0
  v_mul_u32_u24 v24, 272, v14
  s_lshl_b32 s60, s20, 6
  s_add_u32 s60, s60, 106752
  v_add_u32 v6, v24, v13
  v_add_u32 v6, s60, v6
  s_mul_i32 s60, s43, 4352
  s_sub_u32 s60, 102400, s60
  s_mul_i32 s61, s45, 48
  v_add_u32 v25, s61, v13
  buffer_load_dwordx4 a[40:43], v3, s[4:7], s65 offen offset:1024
  v_cmp_gt_u32 vcc, 2, v15
  s_nop 1
  v_cndmask_b32 v25, 32, v25, vcc
  v_add_u32 v25, v25, v24
  v_add_u32 v7, s60, v25
  s_add_u32 s61, s61, 80
  v_add_u32 v25, s61, v13
  v_add_u32 v25, v25, v24
  v_add_u32 v8, s60, v25
  v_lshrrev_b32 v25, 2, v2
  v_mul_u32_u24 v25, 272, v25
  v_and_b32 v26, 3, v2
  v_lshl_add_u32 v25, v26, 3, v25
  buffer_load_dwordx4 a[44:47], v30, s[4:7], s65 offen offset:1024
  s_mul_i32 s61, s45, 40
  s_add_u32 s61, s61, 176
  s_add_u32 s61, s61, s60
  v_add_u32 v9, s61, v25
  s_mul_i32 s60, s22, 40
  s_mul_i32 s61, s45, 20
  s_add_u32 s60, s60, s61
  v_lshlrev_b32 v25, 2, v15
  v_add_u32 v25, s60, v25
  v_lshrrev_b32 v26, 3, v25
  v_lshlrev_b32 v26, 8, v26
  v_lshl_add_u32 v26, v14, 4, v26
  buffer_load_dwordx4 a[48:51], v3, s[4:7], s65 offen offset:2048
  v_and_b32 v25, 4, v25
  v_lshl_add_u32 v10, v25, 1, v26
  s_add_u32 s61, s60, 16
  v_mov_b32 v25, s61
  v_lshrrev_b32 v26, 3, v25
  v_lshlrev_b32 v26, 8, v26
  v_lshl_add_u32 v26, v14, 4, v26
  v_and_b32 v25, 4, v25
  v_lshl_add_u32 v11, v25, 1, v26
  v_mov_b32 v25, 0x7ff00000
  v_cmp_gt_u32 vcc, 16, v2
  s_nop 1
  v_cndmask_b32 v11, v25, v11, vcc
  buffer_load_dwordx4 a[52:55], v30, s[4:7], s65 offen offset:2048
  s_xor_b32 s60, s20, 1
  s_mul_i32 s60, s60, 9216
  s_add_u32 s60, s60, 102400
  v_add_u32 v16, s60, v3
  s_xor_b32 s60, s20, 2
  s_mul_i32 s60, s60, 9216
  s_add_u32 s60, s60, 105472
  v_add_u32 v17, s60, v3
  s_xor_b32 s60, s20, 3
  s_mul_i32 s60, s60, 9216
  s_add_u32 s60, s60, 108544
  v_add_u32 v18, s60, v3
  buffer_load_dwordx4 a[56:59], v3, s[4:7], s65 offen offset:3072
  s_cmp_eq_u32 s43, 0
  s_cselect_b64 vcc, -1, 0
  v_cndmask_b32 v19, v18, v16, vcc
  s_mul_i32 s60, s20, 9216
  s_add_u32 s60, s60, 102400
  v_add_u32 v20, s60, v3
  s_mov_b32 s12, 0
  v_mov_b32 v64, 0x3f803f80
  v_mov_b32 v65, 0x3f803f80
  v_mov_b32 v66, 0x3f803f80
  v_mov_b32 v67, 0x3f803f80
  s_mul_i32 s63, s20, 5120
  s_add_u32 s63, s63, 2621440
  s_mul_i32 s64, s36, 20480
  s_add_u32 s64, s64, s63
  s_mul_i32 s65, s37, 20480
  s_add_u32 s65, s65, s63
  s_mul_i32 s66, s38, 20480
  s_add_u32 s66, s66, s63
  s_mul_i32 s67, s39, 20480
  s_add_u32 s67, s67, s63
  s_mul_i32 s68, s40, 20480
  s_add_u32 s68, s68, s63
  s_waitcnt vmcnt(32)
  s_waitcnt vmcnt(25)
  s_waitcnt vmcnt(20)
  s_barrier
  ds_read_b128 a[224:227], v3 offset:0
  ds_read_b128 a[228:231], v3 offset:20480
  ds_read_b128 a[232:235], v3 offset:40960
  ds_read_b128 a[236:239], v3 offset:1024
  ds_read_b128 a[240:243], v3 offset:21504
  ds_read_b128 a[244:247], v3 offset:41984
  ds_read_b128 a[248:251], v3 offset:2048
  s_waitcnt lgkmcnt(5)
  s_waitcnt vmcnt(13)
  v_mfma_f32_16x16x32_bf16 v[40:43], a[0:3], v[64:67], 0
  v_mfma_f32_16x16x32_bf16 v[44:47], a[4:7], v[64:67], 0
  v_mfma_f32_16x16x32_bf16 v[24:27], a[0:3], a[224:227], 0
  ds_read_b128 a[252:255], v3 offset:22528
  s_add_u32 s55, s31, 24576
  buffer_load_dwordx4 a[60:63], v3, s[4:7], s55 offen offset:3072
  v_mfma_f32_16x16x32_bf16 v[28:31], a[4:7], a[224:227], 0
  s_add_u32 s55, s31, 8192
  v_add_f32 v72, v72, v74
  v_mfma_f32_16x16x32_bf16 v[32:35], a[0:3], a[228:231], 0
  ds_read_b128 a[224:227], v3 offset:43008
  v_add_f32 v73, v73, v75
  v_add_f32 v76, v76, v78
  v_mfma_f32_16x16x32_bf16 v[36:39], a[4:7], a[228:231], 0
  s_waitcnt lgkmcnt(5)
  v_add_f32 v77, v77, v79
  v_add_f32 v72, v72, v76
  v_mfma_f32_16x16x32_bf16 v[104:107], a[0:3], a[232:235], 0
  ds_read_b128 a[228:231], v3 offset:3072
  buffer_load_dwordx4 a[64:67], v3, s[4:7], s55 offen offset:0
  s_add_u32 s55, s31, 28672
  v_mfma_f32_16x16x32_bf16 v[108:111], a[4:7], a[232:235], 0
  v_add_f32 v73, v73, v77
  v_mov_b32 v74, v72
  s_waitcnt vmcnt(13)
  v_mfma_f32_16x16x32_bf16 v[40:43], a[8:11], v[64:67], v[40:43]
  v_mfma_f32_16x16x32_bf16 v[44:47], a[12:15], v[64:67], v[44:47]
  v_mfma_f32_16x16x32_bf16 v[24:27], a[8:11], a[236:239], v[24:27]
  ds_read_b128 a[232:235], v3 offset:23552
  v_mov_b32 v75, v73
  v_permlane16_swap_b32 v72, v74
  v_mfma_f32_16x16x32_bf16 v[28:31], a[12:15], a[236:239], v[28:31]
  s_waitcnt lgkmcnt(5)
  v_permlane16_swap_b32 v73, v75
  v_add_f32 v72, v72, v74
  v_mfma_f32_16x16x32_bf16 v[32:35], a[8:11], a[240:243], v[32:35]
  ds_read_b128 a[236:239], v3 offset:44032
  buffer_load_dwordx4 a[68:71], v3, s[4:7], s55 offen offset:0
  s_add_u32 s55, s31, 8192
  v_mfma_f32_16x16x32_bf16 v[36:39], a[12:15], a[240:243], v[36:39]
  v_add_f32 v73, v73, v75
  v_mov_b32 v74, v72
  v_mfma_f32_16x16x32_bf16 v[104:107], a[8:11], a[244:247], v[104:107]
  ds_read_b128 a[240:243], v3 offset:4096
  v_mov_b32 v75, v73
  v_permlane32_swap_b32 v72, v74
  v_mfma_f32_16x16x32_bf16 v[108:111], a[12:15], a[244:247], v[108:111]
  s_waitcnt lgkmcnt(5)
  v_permlane32_swap_b32 v73, v75
  v_add_f32 v72, v72, v74
  s_waitcnt vmcnt(12)
  v_mfma_f32_16x16x32_bf16 v[40:43], a[16:19], v[64:67], v[40:43]
  v_mfma_f32_16x16x32_bf16 v[44:47], a[20:23], v[64:67], v[44:47]
  v_mfma_f32_16x16x32_bf16 v[24:27], a[16:19], a[248:251], v[24:27]
  ds_read_b128 a[244:247], v3 offset:24576
  buffer_load_dwordx4 a[72:75], v3, s[4:7], s55 offen offset:1024
  s_add_u32 s55, s31, 28672
  v_mfma_f32_16x16x32_bf16 v[28:31], a[20:23], a[248:251], v[28:31]
  v_add_f32 v73, v73, v75
  v_mul_f32 v72, 0x3acccccd, v72
  v_mfma_f32_16x16x32_bf16 v[32:35], a[16:19], a[252:255], v[32:35]
  ds_read_b128 a[248:251], v3 offset:45056
  v_mul_f32 v73, 0x3acccccd, v73
  v_fma_f32 v73, -v72, v72, v73
  v_mfma_f32_16x16x32_bf16 v[36:39], a[20:23], a[252:255], v[36:39]
  s_waitcnt lgkmcnt(5)
  v_max_f32 v73, 0, v73
  v_cvt_pk_bf16_f32 v74, v72, v73
  v_mfma_f32_16x16x32_bf16 v[104:107], a[16:19], a[224:227], v[104:107]
  ds_read_b128 a[252:255], v3 offset:5120
  buffer_load_dwordx4 a[76:79], v3, s[4:7], s55 offen offset:1024
  s_add_u32 s55, s31, 8192
  v_mfma_f32_16x16x32_bf16 v[108:111], a[20:23], a[224:227], v[108:111]
  v_lshlrev_b32 v72, 16, v74
  v_and_b32 v73, 0xffff0000, v74
  s_waitcnt vmcnt(12)
  v_mfma_f32_16x16x32_bf16 v[40:43], a[24:27], v[64:67], v[40:43]
  v_mfma_f32_16x16x32_bf16 v[44:47], a[28:31], v[64:67], v[44:47]
  v_mfma_f32_16x16x32_bf16 v[24:27], a[24:27], a[228:231], v[24:27]
  ds_read_b128 a[224:227], v3 offset:25600
  v_add_f32 v73, 0x3727c5ac, v73
  v_cvt_pk_bf16_f32 v73, v73, v73
  v_mfma_f32_16x16x32_bf16 v[28:31], a[28:31], a[228:231], v[28:31]
  s_waitcnt lgkmcnt(5)
  v_lshlrev_b32 v73, 16, v73
  v_sqrt_f32 v73, v73
  v_mfma_f32_16x16x32_bf16 v[32:35], a[24:27], a[232:235], v[32:35]
  ds_read_b128 a[228:231], v3 offset:46080
  buffer_load_dwordx4 a[80:83], v3, s[4:7], s55 offen offset:2048
  s_add_u32 s55, s31, 28672
  v_mfma_f32_16x16x32_bf16 v[36:39], a[28:31], a[232:235], v[36:39]
  v_cvt_pk_bf16_f32 v73, v73, v73
  v_lshlrev_b32 v73, 16, v73
  v_mfma_f32_16x16x32_bf16 v[104:107], a[24:27], a[236:239], v[104:107]
  ds_read_b128 a[232:235], v3 offset:6144
  v_rcp_f32 v74, v73
  s_lshl_b32 s53, s20, 7
  v_add_u32 v76, s53, v23
  v_mfma_f32_16x16x32_bf16 v[108:111], a[28:31], a[236:239], v[108:111]
  s_waitcnt lgkmcnt(5)
  v_mul_f32 v75, v72, v74
  ds_write_b64 v76, v[74:75] offset:0
  s_waitcnt vmcnt(11)
  v_mfma_f32_16x16x32_bf16 v[40:43], a[32:35], v[64:67], v[40:43]
  v_mfma_f32_16x16x32_bf16 v[44:47], a[36:39], v[64:67], v[44:47]
  v_mfma_f32_16x16x32_bf16 v[24:27], a[32:35], a[240:243], v[24:27]
  ds_read_b128 a[236:239], v3 offset:26624
  buffer_load_dwordx4 a[84:87], v3, s[4:7], s55 offen offset:2048
  s_add_u32 s55, s31, 8192
  v_mfma_f32_16x16x32_bf16 v[28:31], a[36:39], a[240:243], v[28:31]
  v_lshlrev_b32 v148, 2, v15
  v_sub_u32 v148, v14, v148
  v_mfma_f32_16x16x32_bf16 v[32:35], a[32:35], a[244:247], v[32:35]
  s_waitcnt lgkmcnt(1)
  s_barrier
  s_sub_u32 s53, s29, s20
  s_lshl_b32 s53, s53, 11
  s_add_u32 s53, s53, s25
  s_add_u32 s53, s53, 39852032
  buffer_load_dwordx4 v[72:75], v12, s[4:7], s53 offen sc1
  buffer_load_dwordx4 v[76:79], v12, s[4:7], s53 offen offset:16 sc1
  s_cmp_lg_u32 s20, 3
  s_cbranch_scc1 Lxt
  s_getreg_b32 s62, hwreg(HW_REG_XCC_ID)
  s_and_b32 s62, s62, 15
  s_add_u32 s62, s62, 1
  v_mov_b32 v88, s62
  s_lshl_b32 s61, s21, 4
  s_add_u32 s61, s61, s22
  s_lshl_b32 s61, s61, 2
  s_add_u32 s61, s61, 43664384
  s_mov_b64 exec, 1
  buffer_store_dword v88, v87, s[4:7], s61 offen sc1
  s_mov_b64 exec, -1
Lxt:
  ds_read_b128 a[240:243], v3 offset:47104
  v_mov_b32 v150, 0xf149f2ca
  v_add_u32 v149, 16, v148
  v_mfma_f32_16x16x32_bf16 v[36:39], a[36:39], a[244:247], v[36:39]
  v_and_b32 v149, 0xfffffff1, v149
  v_cmp_eq_u32 vcc, 0, v149
  s_nop 1
  v_cndmask_b32 v96, v150, 0, vcc
  v_mfma_f32_16x16x32_bf16 v[104:107], a[32:35], a[248:251], v[104:107]
  ds_read_b128 a[244:247], v3 offset:7168
  buffer_load_dwordx4 a[88:91], v3, s[4:7], s55 offen offset:3072
  s_add_u32 s55, s31, 28672
  v_mfma_f32_16x16x32_bf16 v[108:111], a[36:39], a[248:251], v[108:111]
  v_add_u32 v149, 15, v148
  v_and_b32 v149, 0xfffffff1, v149
  s_waitcnt vmcnt(13)
  v_mfma_f32_16x16x32_bf16 v[40:43], a[40:43], v[64:67], v[40:43]
  v_mfma_f32_16x16x32_bf16 v[44:47], a[44:47], v[64:67], v[44:47]
  v_mfma_f32_16x16x32_bf16 v[24:27], a[40:43], a[252:255], v[24:27]
  ds_read_b128 a[248:251], v3 offset:27648
  v_cmp_eq_u32 vcc, 0, v149
  s_nop 1
  v_cndmask_b32 v97, v150, 0, vcc
  v_mfma_f32_16x16x32_bf16 v[28:31], a[44:47], a[252:255], v[28:31]
  v_add_u32 v149, 14, v148
  v_and_b32 v149, 0xfffffff1, v149
  v_mfma_f32_16x16x32_bf16 v[32:35], a[40:43], a[224:227], v[32:35]
  ds_read_b128 a[252:255], v3 offset:48128
  buffer_load_dwordx4 a[92:95], v3, s[4:7], s55 offen offset:3072
  s_add_u32 s55, s31, 12288
  v_mfma_f32_16x16x32_bf16 v[36:39], a[44:47], a[224:227], v[36:39]
  v_cmp_eq_u32 vcc, 0, v149
  s_nop 1
  v_cndmask_b32 v98, v150, 0, vcc
  v_mfma_f32_16x16x32_bf16 v[104:107], a[40:43], a[228:231], v[104:107]
  ds_read_b128 a[224:227], v3 offset:8192
  v_add_u32 v149, 13, v148
  v_and_b32 v149, 0xfffffff1, v149
  v_mfma_f32_16x16x32_bf16 v[108:111], a[44:47], a[228:231], v[108:111]
  s_waitcnt lgkmcnt(5)
  v_cmp_eq_u32 vcc, 0, v149
  s_nop 1
  v_cndmask_b32 v99, v150, 0, vcc
  s_waitcnt vmcnt(12)
  v_mfma_f32_16x16x32_bf16 v[40:43], a[48:51], v[64:67], v[40:43]
  v_mfma_f32_16x16x32_bf16 v[44:47], a[52:55], v[64:67], v[44:47]
  v_mfma_f32_16x16x32_bf16 v[24:27], a[48:51], a[232:235], v[24:27]
  ds_read_b128 a[228:231], v3 offset:28672
  buffer_load_dwordx4 a[96:99], v3, s[4:7], s55 offen offset:0
  s_add_u32 s55, s31, 32768
  v_mfma_f32_16x16x32_bf16 v[28:31], a[52:55], a[232:235], v[28:31]
  v_add_u32 v149, 0, v148
  v_and_b32 v149, 0xfffffff1, v149
  v_mfma_f32_16x16x32_bf16 v[32:35], a[48:51], a[236:239], v[32:35]
  ds_read_b128 a[232:235], v3 offset:49152
  v_cmp_eq_u32 vcc, 0, v149
  s_nop 1
  v_cndmask_b32 v100, v150, 0, vcc
  v_mfma_f32_16x16x32_bf16 v[36:39], a[52:55], a[236:239], v[36:39]
  s_waitcnt lgkmcnt(5)
  v_add_u32 v149, -1, v148
  v_and_b32 v149, 0xfffffff1, v149
  v_mfma_f32_16x16x32_bf16 v[104:107], a[48:51], a[240:243], v[104:107]
  ds_read_b128 a[236:239], v3 offset:9216
  buffer_load_dwordx4 a[100:103], v3, s[4:7], s55 offen offset:0
  s_add_u32 s55, s31, 12288
  v_mfma_f32_16x16x32_bf16 v[108:111], a[52:55], a[240:243], v[108:111]
  v_cmp_eq_u32 vcc, 0, v149
  s_nop 1
  v_cndmask_b32 v101, v150, 0, vcc
  s_waitcnt vmcnt(12)
  v_mfma_f32_16x16x32_bf16 v[40:43], a[56:59], v[64:67], v[40:43]
  v_mfma_f32_16x16x32_bf16 v[44:47], a[60:63], v[64:67], v[44:47]
  v_mfma_f32_16x16x32_bf16 v[24:27], a[56:59], a[244:247], v[24:27]
  ds_read_b128 a[240:243], v3 offset:29696
  v_add_u32 v149, -2, v148
  v_and_b32 v149, 0xfffffff1, v149
  v_mfma_f32_16x16x32_bf16 v[28:31], a[60:63], a[244:247], v[28:31]
  s_waitcnt lgkmcnt(5)
  v_cmp_eq_u32 vcc, 0, v149
  s_nop 1
  v_cndmask_b32 v102, v150, 0, vcc
  v_mfma_f32_16x16x32_bf16 v[32:35], a[56:59], a[248:251], v[32:35]
  ds_read_b128 a[244:247], v3 offset:50176
  buffer_load_dwordx4 a[104:107], v3, s[4:7], s55 offen offset:1024
  s_add_u32 s55, s31, 32768
  v_mfma_f32_16x16x32_bf16 v[36:39], a[60:63], a[248:251], v[36:39]
  v_add_u32 v149, -3, v148
  v_and_b32 v149, 0xfffffff1, v149
  v_mfma_f32_16x16x32_bf16 v[104:107], a[56:59], a[252:255], v[104:107]
  ds_read_b128 a[248:251], v3 offset:10240
  v_cmp_eq_u32 vcc, 0, v149
  s_nop 1
  v_cndmask_b32 v103, v150, 0, vcc
  v_mfma_f32_16x16x32_bf16 v[108:111], a[60:63], a[252:255], v[108:111]
  s_waitcnt lgkmcnt(5)
  s_waitcnt vmcnt(11)
  v_mfma_f32_16x16x32_bf16 v[40:43], a[64:67], v[64:67], v[40:43]
  v_mfma_f32_16x16x32_bf16 v[44:47], a[68:71], v[64:67], v[44:47]
  v_mfma_f32_16x16x32_bf16 v[24:27], a[64:67], a[224:227], v[24:27]
  ds_read_b128 a[252:255], v3 offset:30720
  buffer_load_dwordx4 a[108:111], v3, s[4:7], s55 offen offset:1024
  s_add_u32 s55, s31, 12288
  v_mfma_f32_16x16x32_bf16 v[28:31], a[68:71], a[224:227], v[28:31]
  v_mfma_f32_16x16x32_bf16 v[32:35], a[64:67], a[228:231], v[32:35]
  ds_read_b128 a[224:227], v3 offset:51200
  v_mfma_f32_16x16x32_bf16 v[36:39], a[68:71], a[228:231], v[36:39]
  s_waitcnt lgkmcnt(5)
  v_mfma_f32_16x16x32_bf16 v[104:107], a[64:67], a[232:235], v[104:107]
  ds_read_b128 a[228:231], v3 offset:11264
  buffer_load_dwordx4 a[112:115], v3, s[4:7], s55 offen offset:2048
  s_add_u32 s55, s31, 32768
  v_mfma_f32_16x16x32_bf16 v[108:111], a[68:71], a[232:235], v[108:111]
  s_waitcnt vmcnt(11)
  v_mfma_f32_16x16x32_bf16 v[40:43], a[72:75], v[64:67], v[40:43]
  v_mfma_f32_16x16x32_bf16 v[44:47], a[76:79], v[64:67], v[44:47]
  v_mfma_f32_16x16x32_bf16 v[24:27], a[72:75], a[236:239], v[24:27]
  ds_read_b128 a[232:235], v3 offset:31744
  v_mfma_f32_16x16x32_bf16 v[28:31], a[76:79], a[236:239], v[28:31]
  s_waitcnt lgkmcnt(5)
  v_mfma_f32_16x16x32_bf16 v[32:35], a[72:75], a[240:243], v[32:35]
  ds_read_b128 a[236:239], v3 offset:52224
  buffer_load_dwordx4 a[116:119], v3, s[4:7], s55 offen offset:2048
  s_add_u32 s55, s31, 12288
  v_mfma_f32_16x16x32_bf16 v[36:39], a[76:79], a[240:243], v[36:39]
  v_mfma_f32_16x16x32_bf16 v[104:107], a[72:75], a[244:247], v[104:107]
  ds_read_b128 a[240:243], v3 offset:12288
  v_mfma_f32_16x16x32_bf16 v[108:111], a[76:79], a[244:247], v[108:111]
  s_waitcnt lgkmcnt(5)
  s_waitcnt vmcnt(10)
  v_mfma_f32_16x16x32_bf16 v[40:43], a[80:83], v[64:67], v[40:43]
  v_mfma_f32_16x16x32_bf16 v[44:47], a[84:87], v[64:67], v[44:47]
  v_mfma_f32_16x16x32_bf16 v[24:27], a[80:83], a[248:251], v[24:27]
  ds_read_b128 a[244:247], v3 offset:32768
  buffer_load_dwordx4 a[120:123], v3, s[4:7], s55 offen offset:3072
  s_add_u32 s55, s31, 32768
  v_mfma_f32_16x16x32_bf16 v[28:31], a[84:87], a[248:251], v[28:31]
  v_mfma_f32_16x16x32_bf16 v[32:35], a[80:83], a[252:255], v[32:35]
  ds_read_b128 a[248:251], v3 offset:53248
  v_mfma_f32_16x16x32_bf16 v[36:39], a[84:87], a[252:255], v[36:39]
  s_waitcnt lgkmcnt(5)
  v_mfma_f32_16x16x32_bf16 v[104:107], a[80:83], a[224:227], v[104:107]
  ds_read_b128 a[252:255], v3 offset:13312
  buffer_load_dwordx4 a[124:127], v3, s[4:7], s55 offen offset:3072
  s_add_u32 s55, s31, 16384
  v_mfma_f32_16x16x32_bf16 v[108:111], a[84:87], a[224:227], v[108:111]
  s_waitcnt vmcnt(8)
  v_mfma_f32_16x16x32_bf16 v[40:43], a[88:91], v[64:67], v[40:43]
  v_mfma_f32_16x16x32_bf16 v[44:47], a[92:95], v[64:67], v[44:47]
  v_mfma_f32_16x16x32_bf16 v[24:27], a[88:91], a[228:231], v[24:27]
  s_barrier
  s_mul_i32 s62, s33, 2560
  s_mul_i32 s61, s29, 20480
  s_add_u32 s62, s62, s61
  s_add_u32 s62, s62, 18874368
  v_min_u32 v88, 19, v2
  v_lshlrev_b32 v88, 7, v88
  buffer_load_dword v89, v88, s[4:7], s62 offen
  ds_read_b128 a[224:227], v3 offset:33792
  v_mfma_f32_16x16x32_bf16 v[28:31], a[92:95], a[228:231], v[28:31]
  s_waitcnt lgkmcnt(5)
  v_mfma_f32_16x16x32_bf16 v[32:35], a[88:91], a[232:235], v[32:35]
  ds_read_b128 a[228:231], v3 offset:54272
  buffer_load_dwordx4 a[128:131], v3, s[4:7], s55 offen offset:0
  s_add_u32 s55, s31, 36864
  v_mfma_f32_16x16x32_bf16 v[36:39], a[92:95], a[232:235], v[36:39]
  v_mfma_f32_16x16x32_bf16 v[104:107], a[88:91], a[236:239], v[104:107]
  ds_read_b128 a[232:235], v3 offset:14336
  v_mfma_f32_16x16x32_bf16 v[108:111], a[92:95], a[236:239], v[108:111]
  s_waitcnt lgkmcnt(5)
  s_waitcnt vmcnt(8)
  v_mfma_f32_16x16x32_bf16 v[40:43], a[96:99], v[64:67], v[40:43]
  v_mfma_f32_16x16x32_bf16 v[44:47], a[100:103], v[64:67], v[44:47]
  v_mfma_f32_16x16x32_bf16 v[24:27], a[96:99], a[240:243], v[24:27]
  ds_read_b128 a[236:239], v3 offset:34816
  buffer_load_dwordx4 a[132:135], v3, s[4:7], s55 offen offset:0
  s_add_u32 s55, s31, 16384
  v_mfma_f32_16x16x32_bf16 v[28:31], a[100:103], a[240:243], v[28:31]
  v_mfma_f32_16x16x32_bf16 v[32:35], a[96:99], a[244:247], v[32:35]
  ds_read_b128 a[240:243], v3 offset:55296
  v_mfma_f32_16x16x32_bf16 v[36:39], a[100:103], a[244:247], v[36:39]
  s_waitcnt lgkmcnt(5)
  v_add_f32 v72, v72, v74
  v_mfma_f32_16x16x32_bf16 v[104:107], a[96:99], a[248:251], v[104:107]
  ds_read_b128 a[244:247], v3 offset:15360
  buffer_load_dwordx4 a[136:139], v3, s[4:7], s55 offen offset:1024
  s_add_u32 s55, s31, 36864
  v_mfma_f32_16x16x32_bf16 v[108:111], a[100:103], a[248:251], v[108:111]
  v_add_f32 v73, v73, v75
  v_add_f32 v76, v76, v78
  s_waitcnt vmcnt(8)
  v_mfma_f32_16x16x32_bf16 v[40:43], a[104:107], v[64:67], v[40:43]
  v_mfma_f32_16x16x32_bf16 v[44:47], a[108:111], v[64:67], v[44:47]
  v_mfma_f32_16x16x32_bf16 v[24:27], a[104:107], a[252:255], v[24:27]
  ds_read_b128 a[248:251], v3 offset:35840
  v_add_f32 v77, v77, v79
  v_add_f32 v72, v72, v76
  v_mfma_f32_16x16x32_bf16 v[28:31], a[108:111], a[252:255], v[28:31]
  s_waitcnt lgkmcnt(5)
  v_add_f32 v73, v73, v77
  v_mov_b32 v74, v72
  v_mfma_f32_16x16x32_bf16 v[32:35], a[104:107], a[224:227], v[32:35]
  ds_read_b128 a[252:255], v3 offset:56320
  buffer_load_dwordx4 a[140:143], v3, s[4:7], s55 offen offset:1024
  s_add_u32 s55, s31, 16384
  v_mfma_f32_16x16x32_bf16 v[36:39], a[108:111], a[224:227], v[36:39]
  v_mov_b32 v75, v73
  v_permlane16_swap_b32 v72, v74
  v_mfma_f32_16x16x32_bf16 v[104:107], a[104:107], a[228:231], v[104:107]
  ds_read_b128 a[224:227], v3 offset:16384
  v_permlane16_swap_b32 v73, v75
  v_add_f32 v72, v72, v74
  v_mfma_f32_16x16x32_bf16 v[108:111], a[108:111], a[228:231], v[108:111]
  s_waitcnt lgkmcnt(5)
  v_add_f32 v73, v73, v75
  v_mov_b32 v74, v72
  s_waitcnt vmcnt(7)
  v_mfma_f32_16x16x32_bf16 v[40:43], a[112:115], v[64:67], v[40:43]
  v_mfma_f32_16x16x32_bf16 v[44:47], a[116:119], v[64:67], v[44:47]
  v_mfma_f32_16x16x32_bf16 v[24:27], a[112:115], a[232:235], v[24:27]
  ds_read_b128 a[228:231], v3 offset:36864
  buffer_load_dwordx4 a[144:147], v3, s[4:7], s55 offen offset:2048
  s_add_u32 s55, s31, 36864
  v_mfma_f32_16x16x32_bf16 v[28:31], a[116:119], a[232:235], v[28:31]
  v_mov_b32 v75, v73
  v_permlane32_swap_b32 v72, v74
  v_mfma_f32_16x16x32_bf16 v[32:35], a[112:115], a[236:239], v[32:35]
  ds_read_b128 a[232:235], v3 offset:57344
  v_permlane32_swap_b32 v73, v75
  v_add_f32 v72, v72, v74
  v_mfma_f32_16x16x32_bf16 v[36:39], a[116:119], a[236:239], v[36:39]
  s_waitcnt lgkmcnt(5)
  v_add_f32 v73, v73, v75
  v_mul_f32 v72, 0x3acccccd, v72
  v_mfma_f32_16x16x32_bf16 v[104:107], a[112:115], a[240:243], v[104:107]
  ds_read_b128 a[236:239], v3 offset:17408
  buffer_load_dwordx4 a[148:151], v3, s[4:7], s55 offen offset:2048
  s_add_u32 s55, s31, 16384
  v_mfma_f32_16x16x32_bf16 v[108:111], a[116:119], a[240:243], v[108:111]
  v_mul_f32 v73, 0x3acccccd, v73
  v_fma_f32 v73, -v72, v72, v73
  s_waitcnt vmcnt(7)
  v_mfma_f32_16x16x32_bf16 v[40:43], a[120:123], v[64:67], v[40:43]
  v_mfma_f32_16x16x32_bf16 v[44:47], a[124:127], v[64:67], v[44:47]
  v_mfma_f32_16x16x32_bf16 v[24:27], a[120:123], a[244:247], v[24:27]
  ds_read_b128 a[240:243], v3 offset:37888
  v_max_f32 v73, 0, v73
  v_cvt_pk_bf16_f32 v74, v72, v73
  v_mfma_f32_16x16x32_bf16 v[28:31], a[124:127], a[244:247], v[28:31]
  s_waitcnt lgkmcnt(5)
  v_lshlrev_b32 v72, 16, v74
  v_and_b32 v73, 0xffff0000, v74
  v_mfma_f32_16x16x32_bf16 v[32:35], a[120:123], a[248:251], v[32:35]
  ds_read_b128 a[244:247], v3 offset:58368
  buffer_load_dwordx4 a[152:155], v3, s[4:7], s55 offen offset:3072
  s_add_u32 s55, s31, 36864
  v_mfma_f32_16x16x32_bf16 v[36:39], a[124:127], a[248:251], v[36:39]
  v_add_f32 v73, 0x3727c5ac, v73
  v_cvt_pk_bf16_f32 v73, v73, v73
  v_mfma_f32_16x16x32_bf16 v[104:107], a[120:123], a[252:255], v[104:107]
  ds_read_b128 a[248:251], v3 offset:18432
  v_lshlrev_b32 v73, 16, v73
  v_sqrt_f32 v73, v73
  v_mfma_f32_16x16x32_bf16 v[108:111], a[124:127], a[252:255], v[108:111]
  s_waitcnt lgkmcnt(5)
  v_cvt_pk_bf16_f32 v73, v73, v73
  v_lshlrev_b32 v73, 16, v73
  s_waitcnt vmcnt(5)
  v_mfma_f32_16x16x32_bf16 v[40:43], a[128:131], v[64:67], v[40:43]
  v_mfma_f32_16x16x32_bf16 v[44:47], a[132:135], v[64:67], v[44:47]
  v_mfma_f32_16x16x32_bf16 v[24:27], a[128:131], a[224:227], v[24:27]
  ds_read_b128 a[252:255], v3 offset:38912
  buffer_load_dwordx4 a[156:159], v3, s[4:7], s55 offen offset:3072
  s_add_u32 s52, s69, s24
  v_mfma_f32_16x16x32_bf16 v[28:31], a[132:135], a[224:227], v[28:31]
  s_add_u32 s52, s52, 8450048
  s_add_u32 m0, s30, 81920
  v_mfma_f32_16x16x32_bf16 v[32:35], a[128:131], a[228:231], v[32:35]
  ds_read_b128 a[224:227], v3 offset:59392
  v_rcp_f32 v74, v73
  s_lshl_b32 s53, s20, 7
  v_add_u32 v76, s53, v23
  v_mfma_f32_16x16x32_bf16 v[36:39], a[132:135], a[228:231], v[36:39]
  s_waitcnt lgkmcnt(5)
  v_mul_f32 v75, v72, v74
  ds_write_b64 v76, v[74:75] offset:512
  v_mfma_f32_16x16x32_bf16 v[104:107], a[128:131], a[232:235], v[104:107]
  ds_read_b128 a[228:231], v3 offset:19456
  buffer_load_dwordx4 v3, s[4:7], s52 offen offset:0 sc1 lds
  v_mfma_f32_16x16x32_bf16 v[108:111], a[132:135], a[232:235], v[108:111]
  s_waitcnt vmcnt(5)
  v_mfma_f32_16x16x32_bf16 v[40:43], a[136:139], v[64:67], v[40:43]
  v_mfma_f32_16x16x32_bf16 v[44:47], a[140:143], v[64:67], v[44:47]
  v_mfma_f32_16x16x32_bf16 v[24:27], a[136:139], a[236:239], v[24:27]
  ds_read_b128 a[232:235], v3 offset:39936
  v_mfma_f32_16x16x32_bf16 v[28:31], a[140:143], a[236:239], v[28:31]
  s_waitcnt lgkmcnt(6)
  v_mfma_f32_16x16x32_bf16 v[32:35], a[136:139], a[240:243], v[32:35]
  ds_read_b128 a[236:239], v3 offset:60416
  buffer_load_dwordx4 v3, s[4:7], s52 offen offset:1024 sc1 lds
  v_mfma_f32_16x16x32_bf16 v[36:39], a[140:143], a[240:243], v[36:39]
  v_mfma_f32_16x16x32_bf16 v[104:107], a[136:139], a[244:247], v[104:107]
  s_waitcnt lgkmcnt(3)
  s_barrier
  s_add_u32 s62, s100, 17408
  buffer_load_dword v85, v5, s[4:7], s62 offen sc1
  ds_read_b128 a[240:243], v4 offset:0
  v_mfma_f32_16x16x32_bf16 v[108:111], a[140:143], a[244:247], v[108:111]
  s_waitcnt vmcnt(5)
  v_mfma_f32_16x16x32_bf16 v[40:43], a[144:147], v[64:67], v[40:43]
  v_mfma_f32_16x16x32_bf16 v[44:47], a[148:151], v[64:67], v[44:47]
  v_mfma_f32_16x16x32_bf16 v[24:27], a[144:147], a[248:251], v[24:27]
  ds_read_b128 a[244:247], v4 offset:1024
  buffer_load_dwordx4 v3, s[4:7], s52 offen offset:2048 sc1 lds
  v_mfma_f32_16x16x32_bf16 v[28:31], a[148:151], a[248:251], v[28:31]
  v_mfma_f32_16x16x32_bf16 v[32:35], a[144:147], a[252:255], v[32:35]
  ds_read_b128 a[248:251], v4 offset:2048
  v_mfma_f32_16x16x32_bf16 v[36:39], a[148:151], a[252:255], v[36:39]
  s_waitcnt lgkmcnt(5)
  v_mfma_f32_16x16x32_bf16 v[104:107], a[144:147], a[224:227], v[104:107]
  ds_read_b128 a[252:255], v4 offset:3072
  buffer_load_dwordx4 v3, s[4:7], s52 offen offset:3072 sc1 lds
  s_add_u32 s52, s52, 4096
  v_mfma_f32_16x16x32_bf16 v[108:111], a[148:151], a[224:227], v[108:111]
  s_add_u32 m0, s30, 86016
  s_waitcnt vmcnt(5)
  v_mfma_f32_16x16x32_bf16 v[40:43], a[152:155], v[64:67], v[40:43]
  v_mfma_f32_16x16x32_bf16 v[44:47], a[156:159], v[64:67], v[44:47]
  v_mfma_f32_16x16x32_bf16 v[24:27], a[152:155], a[228:231], v[24:27]
  ds_read_b128 a[224:227], v4 offset:4096
  v_mfma_f32_16x16x32_bf16 v[28:31], a[156:159], a[228:231], v[28:31]
  s_waitcnt lgkmcnt(5)
  v_mfma_f32_16x16x32_bf16 v[32:35], a[152:155], a[232:235], v[32:35]
  ds_read_b128 a[228:231], v4 offset:5120
  buffer_load_dwordx4 v3, s[4:7], s52 offen offset:0 sc1 lds
  v_mfma_f32_16x16x32_bf16 v[36:39], a[156:159], a[232:235], v[36:39]
  v_mfma_f32_16x16x32_bf16 v[104:107], a[152:155], a[236:239], v[104:107]
  ds_read_b128 a[232:235], v4 offset:6144
  v_mfma_f32_16x16x32_bf16 v[108:111], a[156:159], a[236:239], v[108:111]
  s_waitcnt lgkmcnt(5)
  v_mfma_f32_16x16x32_bf16 v[112:115], a[0:3], a[240:243], 0
  ds_read_b128 a[236:239], v4 offset:7168
  buffer_load_dwordx4 a[160:163], v3, s[4:7], s64 offen offset:0
  v_mfma_f32_16x16x32_bf16 v[116:119], a[4:7], a[240:243], 0
  ds_write_b128 v1, v[40:43]
  ds_write_b128 v1, v[44:47] offset:16
  v_mfma_f32_16x16x32_bf16 v[112:115], a[8:11], a[244:247], v[112:115]
  ds_read_b128 a[240:243], v4 offset:8192
  v_mfma_f32_16x16x32_bf16 v[116:119], a[12:15], a[244:247], v[116:119]
  s_waitcnt lgkmcnt(7)
  v_mfma_f32_16x16x32_bf16 v[112:115], a[16:19], a[248:251], v[112:115]
  ds_read_b128 a[244:247], v4 offset:9216
  buffer_load_dwordx4 a[164:167], v3, s[4:7], s65 offen offset:0
  ds_read_b64 v[68:69], v23 offset:0
  v_mfma_f32_16x16x32_bf16 v[116:119], a[20:23], a[248:251], v[116:119]
  v_mfma_f32_16x16x32_bf16 v[112:115], a[24:27], a[252:255], v[112:115]
  ds_read_b128 a[248:251], v4 offset:10240
  v_mfma_f32_16x16x32_bf16 v[116:119], a[28:31], a[252:255], v[116:119]
  s_waitcnt lgkmcnt(8)
  v_mfma_f32_16x16x32_bf16 v[112:115], a[32:35], a[224:227], v[112:115]
  ds_read_b128 a[252:255], v4 offset:11264
  buffer_load_dwordx4 a[168:171], v3, s[4:7], s66 offen offset:0
  v_mfma_f32_16x16x32_bf16 v[116:119], a[36:39], a[224:227], v[116:119]
  s_waitcnt lgkmcnt(2)
  v_mul_f32 v56, v69, v40
  v_mul_f32 v57, v69, v41
  v_mfma_f32_16x16x32_bf16 v[112:115], a[40:43], a[228:231], v[112:115]
  ds_read_b128 a[224:227], v4 offset:12288
  v_mul_f32 v58, v69, v42
  v_mul_f32 v59, v69, v43
  v_mfma_f32_16x16x32_bf16 v[116:119], a[44:47], a[228:231], v[116:119]
  v_mul_f32 v60, v69, v44
  v_mul_f32 v61, v69, v45
  v_mfma_f32_16x16x32_bf16 v[112:115], a[48:51], a[232:235], v[112:115]
  ds_read_b128 a[228:231], v4 offset:13312
  buffer_load_dwordx4 a[172:175], v3, s[4:7], s67 offen offset:0
  v_mul_f32 v62, v69, v46
  v_mfma_f32_16x16x32_bf16 v[116:119], a[52:55], a[232:235], v[116:119]
  v_mul_f32 v63, v69, v47
  v_fma_f32 v56, v24, v68, -v56
  v_mfma_f32_16x16x32_bf16 v[112:115], a[56:59], a[236:239], v[112:115]
  ds_read_b128 a[232:235], v4 offset:14336
  v_fma_f32 v57, v25, v68, -v57
  v_fma_f32 v58, v26, v68, -v58
  v_mfma_f32_16x16x32_bf16 v[116:119], a[60:63], a[236:239], v[116:119]
  v_fma_f32 v59, v27, v68, -v59
  v_fma_f32 v60, v28, v68, -v60
  v_mfma_f32_16x16x32_bf16 v[112:115], a[64:67], a[240:243], v[112:115]
  ds_read_b128 a[236:239], v4 offset:15360
  buffer_load_dwordx4 a[176:179], v3, s[4:7], s68 offen offset:0
  v_fma_f32 v61, v29, v68, -v61
  v_mfma_f32_16x16x32_bf16 v[116:119], a[68:71], a[240:243], v[116:119]
  v_fma_f32 v62, v30, v68, -v62
  v_fma_f32 v63, v31, v68, -v63
  v_cvt_pk_bf16_f32 v64, v56, v57
  v_cvt_pk_bf16_f32 v65, v58, v59
  v_cvt_pk_bf16_f32 v66, v60, v61
  v_cvt_pk_bf16_f32 v67, v62, v63
  ds_write_b128 v6, v[64:67] offset:30464
  s_waitcnt lgkmcnt(0)
  s_barrier
  v_mfma_f32_16x16x32_bf16 v[112:115], a[72:75], a[244:247], v[112:115]
  s_add_u32 s52, s69, s24
  ds_read_b128 a[240:243], v4 offset:16384
  s_lshl_b32 s58, s20, 10
  v_add_u32 v88, s58, v3
  s_lshl_b32 s58, s20, 6
  v_add_u32 v89, s58, v3
  v_add_u32 v90, 137216, v88
  v_add_u32 v91, 141312, v89
  ds_read_b128 v[80:83], v90
  s_mov_b64 exec, 0xf
  ds_read_b128 v[92:95], v91
  s_mov_b64 exec, -1
  v_mfma_f32_16x16x32_bf16 v[116:119], a[76:79], a[244:247], v[116:119]
  s_add_u32 s52, s52, 8429568
  s_add_u32 m0, s30, 0
  v_mfma_f32_16x16x32_bf16 v[112:115], a[80:83], a[248:251], v[112:115]
  ds_read_b128 a[244:247], v4 offset:17408
  buffer_load_dwordx4 v3, s[4:7], s52 offen offset:0 sc1 lds
  ds_read_b64 v[70:71], v23 offset:128
  v_mfma_f32_16x16x32_bf16 v[116:119], a[84:87], a[248:251], v[116:119]
  v_mfma_f32_16x16x32_bf16 v[112:115], a[88:91], a[252:255], v[112:115]
  ds_read_b128 a[248:251], v4 offset:18432
  s_waitcnt lgkmcnt(3)
  s_mul_i32 s58, s23, 1179648
  s_add_u32 s58, s58, s48
  buffer_store_dwordx4 v[80:83], v88, s[4:7], s58 offen sc1
  s_add_u32 s58, s58, 4096
  s_mov_b64 exec, 0xf
  buffer_store_dwordx4 v[92:95], v89, s[4:7], s58 offen sc1
  s_mov_b64 exec, -1
  v_mfma_f32_16x16x32_bf16 v[116:119], a[92:95], a[252:255], v[116:119]
  v_mfma_f32_16x16x32_bf16 v[112:115], a[96:99], a[224:227], v[112:115]
  ds_read_b128 a[252:255], v4 offset:19456
  buffer_load_dwordx4 v3, s[4:7], s52 offen offset:1024 sc1 lds
  v_mfma_f32_16x16x32_bf16 v[116:119], a[100:103], a[224:227], v[116:119]
  s_waitcnt lgkmcnt(2)
  v_mul_f32 v56, v71, v40
  v_mul_f32 v57, v71, v41
  v_mfma_f32_16x16x32_bf16 v[112:115], a[104:107], a[228:231], v[112:115]
  v_mul_f32 v58, v71, v42
  v_mul_f32 v59, v71, v43
  v_mul_f32 v60, v71, v44
  v_mul_f32 v61, v71, v45
  v_mul_f32 v62, v71, v46
  v_mul_f32 v63, v71, v47
  v_fma_f32 v56, v32, v70, -v56
  v_fma_f32 v57, v33, v70, -v57
  v_fma_f32 v58, v34, v70, -v58
  v_fma_f32 v59, v35, v70, -v59
  v_fma_f32 v60, v36, v70, -v60
  v_fma_f32 v61, v37, v70, -v61
  v_fma_f32 v62, v38, v70, -v62
  v_fma_f32 v63, v39, v70, -v63
  v_cvt_pk_bf16_f32 v64, v56, v57
  v_cvt_pk_bf16_f32 v65, v58, v59
  v_cvt_pk_bf16_f32 v66, v60, v61
  v_cvt_pk_bf16_f32 v67, v62, v63
  ds_write_b128 v6, v[64:67] offset:26112
  ds_read_b64 v[68:69], v23 offset:256
  s_waitcnt lgkmcnt(0)
  v_mul_f32 v56, v69, v40
  v_mul_f32 v57, v69, v41
  v_mul_f32 v58, v69, v42
  v_mul_f32 v59, v69, v43
  v_mul_f32 v60, v69, v44
  v_mul_f32 v61, v69, v45
  v_mul_f32 v62, v69, v46
  v_mul_f32 v63, v69, v47
  v_fma_f32 v56, v104, v68, -v56
  v_fma_f32 v57, v105, v68, -v57
  v_fma_f32 v58, v106, v68, -v58
  v_fma_f32 v59, v107, v68, -v59
  v_fma_f32 v60, v108, v68, -v60
  v_fma_f32 v61, v109, v68, -v61
  v_fma_f32 v62, v110, v68, -v62
  v_fma_f32 v63, v111, v68, -v63
  v_cvt_pk_bf16_f32 v64, v56, v57
  v_cvt_pk_bf16_f32 v65, v58, v59
  v_cvt_pk_bf16_f32 v66, v60, v61
  v_cvt_pk_bf16_f32 v67, v62, v63
  ds_write_b128 v6, v[64:67] offset:21760
  s_waitcnt vmcnt(12)
  s_mov_b32 s61, 0
Lm0:
  v_cmp_eq_u32 vcc, 0, v85
  s_cbranch_vccz Lmd0
  s_add_u32 s62, s100, 17408
  buffer_load_dword v85, v5, s[4:7], s62 offen sc1
  s_add_u32 s61, s61, 1
  s_waitcnt vmcnt(0)
  s_cmp_lt_u32 s61, 0x100000
  s_cbranch_scc1 Lm0
Lmd0:
  v_readfirstlane_b32 s61, v85
  s_nop 1
  v_cmp_ne_u32 vcc, s61, v85
  s_cmp_eq_u64 vcc, 0
  s_cselect_b32 s12, 1, 0
  s_cselect_b32 s61, 0, 2621440
  s_cselect_b32 s62, 0, 262144
  s_add_u32 s8, s24, s61
  s_add_u32 s9, s8, s61
  s_add_u32 s10, s25, s62
  s_add_u32 s11, s10, s62
  s_waitcnt lgkmcnt(0)
  s_waitcnt vmcnt(9)
  s_barrier
  ds_read_b128 a[224:227], v4 offset:20480
  v_mov_b32 v128, 0
  v_mov_b32 v129, 0
  v_mfma_f32_16x16x32_bf16 v[116:119], a[108:111], a[228:231], v[116:119]
  v_mov_b32 v130, 0
  v_mov_b32 v131, 0
  v_mfma_f32_16x16x32_bf16 v[112:115], a[112:115], a[232:235], v[112:115]
  ds_read_b128 a[228:231], v4 offset:21504
  buffer_load_dwordx4 v3, s[4:7], s52 offen offset:2048 sc1 lds
  s_mov_b32 exec_hi, 0xffff
  ds_read_b128 v[128:131], v8 offset:34816
  s_mov_b32 exec_hi, -1
  v_mfma_f32_16x16x32_bf16 v[116:119], a[116:119], a[232:235], v[116:119]
  ds_read_b128 v[132:135], v7 offset:30464
  ds_read_b128 v[136:139], v7 offset:34816
  v_mfma_f32_16x16x32_bf16 v[112:115], a[120:123], a[236:239], v[112:115]
  ds_read_b128 a[232:235], v4 offset:22528
  v_mfma_f32_16x16x32_bf16 v[116:119], a[124:127], a[236:239], v[116:119]
  v_mfma_f32_16x16x32_bf16 v[112:115], a[128:131], a[240:243], v[112:115]
  ds_read_b128 a[236:239], v4 offset:23552
  buffer_load_dwordx4 v3, s[4:7], s52 offen offset:3072 sc1 lds
  s_add_u32 s52, s52, 4096
  v_mfma_f32_16x16x32_bf16 v[116:119], a[132:135], a[240:243], v[116:119]
  s_add_u32 m0, s30, 4096
  v_mfma_f32_16x16x32_bf16 v[112:115], a[136:139], a[244:247], v[112:115]
  s_waitcnt lgkmcnt(2)
  ds_read_b128 a[240:243], v4 offset:24576
  v_mfma_f32_16x16x32_bf16 v[140:143], v[132:135], v[128:131], 0
  v_mfma_f32_16x16x32_bf16 v[116:119], a[140:143], a[244:247], v[116:119]
  v_mfma_f32_16x16x32_bf16 v[144:147], v[136:139], v[128:131], 0
  v_mfma_f32_16x16x32_bf16 v[112:115], a[144:147], a[248:251], v[112:115]
  ds_read_b128 a[244:247], v4 offset:25600
  buffer_load_dwordx4 v3, s[4:7], s52 offen offset:0 sc1 lds
  s_add_u32 s52, s69, s24
  v_mfma_f32_16x16x32_bf16 v[116:119], a[148:151], a[248:251], v[116:119]
  s_add_u32 s52, s52, 8409088
  s_add_u32 m0, s30, 20480
  v_mfma_f32_16x16x32_bf16 v[112:115], a[152:155], a[252:255], v[112:115]
  ds_read_b128 a[248:251], v4 offset:26624
  ds_read_b64_tr_b16 v[132:133], v9 offset:30464
  ds_read_b64_tr_b16 v[134:135], v9 offset:34816
  v_mfma_f32_16x16x32_bf16 v[116:119], a[156:159], a[252:255], v[116:119]
  ds_read_b64_tr_b16 v[136:137], v9 offset:30496
  ds_read_b64_tr_b16 v[138:139], v9 offset:34848
  v_mfma_f32_16x16x32_bf16 v[24:27], a[0:3], a[224:227], 0
  ds_read_b128 a[252:255], v4 offset:27648
  buffer_load_dwordx4 v3, s[4:7], s52 offen offset:0 sc1 lds
  s_mov_b32 s56, 0x3ea52b5c
  v_mfma_f32_16x16x32_bf16 v[28:31], a[4:7], a[224:227], 0
  v_mfma_f32_16x16x32_bf16 v[24:27], a[8:11], a[228:231], v[24:27]
  ds_read_b128 a[224:227], v4 offset:28672
  v_fma_f32 v140, v140, s56, v96
  v_fma_f32 v141, v141, s56, v97
  v_mfma_f32_16x16x32_bf16 v[28:31], a[12:15], a[228:231], v[28:31]
  s_waitcnt lgkmcnt(9)
  v_fma_f32 v142, v142, s56, v98
  v_fma_f32 v143, v143, s56, v99
  v_mfma_f32_16x16x32_bf16 v[24:27], a[16:19], a[232:235], v[24:27]
  ds_read_b128 a[228:231], v4 offset:29696
  buffer_load_dwordx4 v3, s[4:7], s52 offen offset:1024 sc1 lds
  ds_read_b64 v[70:71], v23 offset:384
  v_mfma_f32_16x16x32_bf16 v[28:31], a[20:23], a[232:235], v[28:31]
  v_fma_f32 v144, v144, s56, v100
  v_fma_f32 v145, v145, s56, v101
  v_mfma_f32_16x16x32_bf16 v[24:27], a[24:27], a[236:239], v[24:27]
  ds_read_b128 a[232:235], v4 offset:30720
  v_fma_f32 v146, v146, s56, v102
  v_fma_f32 v147, v147, s56, v103
  v_mfma_f32_16x16x32_bf16 v[28:31], a[28:31], a[236:239], v[28:31]
  s_waitcnt lgkmcnt(10)
  v_max3_f32 v148, v140, v141, v142
  v_max3_f32 v149, v143, v144, v145
  v_mfma_f32_16x16x32_bf16 v[24:27], a[32:35], a[240:243], v[24:27]
  ds_read_b128 a[236:239], v4 offset:31744
  buffer_load_dwordx4 v3, s[4:7], s52 offen offset:2048 sc1 lds
  v_max3_f32 v148, v148, v146, v147
  v_mfma_f32_16x16x32_bf16 v[28:31], a[36:39], a[240:243], v[28:31]
  s_waitcnt lgkmcnt(2)
  v_mul_f32 v56, v71, v40
  v_mul_f32 v57, v71, v41
  v_mfma_f32_16x16x32_bf16 v[24:27], a[40:43], a[244:247], v[24:27]
  ds_read_b128 a[240:243], v4 offset:32768
  v_mul_f32 v58, v71, v42
  v_mul_f32 v59, v71, v43
  v_mfma_f32_16x16x32_bf16 v[28:31], a[44:47], a[244:247], v[28:31]
  v_mul_f32 v60, v71, v44
  v_mul_f32 v61, v71, v45
  v_mfma_f32_16x16x32_bf16 v[24:27], a[48:51], a[248:251], v[24:27]
  ds_read_b128 a[244:247], v4 offset:33792
  buffer_load_dwordx4 v3, s[4:7], s52 offen offset:3072 sc1 lds
  s_add_u32 s52, s52, 4096
  v_mfma_f32_16x16x32_bf16 v[28:31], a[52:55], a[248:251], v[28:31]
  s_add_u32 m0, s30, 24576
  v_mul_f32 v62, v71, v46
  v_mfma_f32_16x16x32_bf16 v[24:27], a[56:59], a[252:255], v[24:27]
  ds_read_b128 a[248:251], v4 offset:34816
  v_mul_f32 v63, v71, v47
  v_fma_f32 v56, v112, v70, -v56
  v_mfma_f32_16x16x32_bf16 v[28:31], a[60:63], a[252:255], v[28:31]
  v_fma_f32 v57, v113, v70, -v57
  v_fma_f32 v58, v114, v70, -v58
  v_mfma_f32_16x16x32_bf16 v[24:27], a[64:67], a[224:227], v[24:27]
  ds_read_b128 a[252:255], v4 offset:35840
  buffer_load_dwordx4 v3, s[4:7], s52 offen offset:0 sc1 lds
  s_add_u32 s52, s69, s24
  v_mfma_f32_16x16x32_bf16 v[28:31], a[68:71], a[224:227], v[28:31]
  s_add_u32 s52, s52, 8388608
  s_add_u32 m0, s30, 40960
  v_mfma_f32_16x16x32_bf16 v[24:27], a[72:75], a[228:231], v[24:27]
  ds_read_b128 a[224:227], v4 offset:36864
  v_fma_f32 v59, v115, v70, -v59
  v_fma_f32 v60, v116, v70, -v60
  v_mfma_f32_16x16x32_bf16 v[28:31], a[76:79], a[228:231], v[28:31]
  s_waitcnt lgkmcnt(5)
  v_fma_f32 v61, v117, v70, -v61
  v_fma_f32 v62, v118, v70, -v62
  v_mfma_f32_16x16x32_bf16 v[24:27], a[80:83], a[232:235], v[24:27]
  ds_read_b128 a[228:231], v4 offset:37888
  buffer_load_dwordx4 v3, s[4:7], s52 offen offset:0 sc1 lds
  v_fma_f32 v63, v119, v70, -v63
  v_mfma_f32_16x16x32_bf16 v[28:31], a[84:87], a[232:235], v[28:31]
  v_cvt_pk_bf16_f32 v64, v56, v57
  v_cvt_pk_bf16_f32 v65, v58, v59
  v_mfma_f32_16x16x32_bf16 v[24:27], a[88:91], a[236:239], v[24:27]
  ds_read_b128 a[232:235], v4 offset:38912
  v_cvt_pk_bf16_f32 v66, v60, v61
  v_cvt_pk_bf16_f32 v67, v62, v63
  v_mfma_f32_16x16x32_bf16 v[28:31], a[92:95], a[236:239], v[28:31]
  s_waitcnt lgkmcnt(5)
  ds_write_b128 v6, v[64:67] offset:17408
  v_max_f32 v148, v148, v149
  v_mfma_f32_16x16x32_bf16 v[24:27], a[96:99], a[240:243], v[24:27]
  ds_read_b128 a[236:239], v4 offset:39936
  buffer_load_dwordx4 v3, s[4:7], s52 offen offset:1024 sc1 lds
  v_mov_b32 v149, v148
  v_mfma_f32_16x16x32_bf16 v[28:31], a[100:103], a[240:243], v[28:31]
  s_nop 0
  v_permlane16_swap_b32 v148, v149
  v_max_f32 v148, v148, v149
  v_mfma_f32_16x16x32_bf16 v[24:27], a[104:107], a[244:247], v[24:27]
  s_waitcnt vmcnt(11)
  s_waitcnt lgkmcnt(1)
  s_waitcnt vmcnt(7)
  s_barrier
  s_cmp_lg_u32 s20, 0
  s_cbranch_scc1 Lf1
  s_lshl_b32 s62, s23, 10
  s_add_u32 s62, s62, s49
  s_mov_b64 exec, 1
  buffer_store_dword v86, v87, s[4:7], s62 offen sc1
  s_mov_b64 exec, -1
Lf1:
  ds_read_b128 a[240:243], v3 offset:0
  v_mov_b32 v149, v148
  s_nop 1
  v_permlane32_swap_b32 v148, v149
  v_mfma_f32_16x16x32_bf16 v[28:31], a[108:111], a[244:247], v[28:31]
  v_max_f32 v148, v148, v149
  v_sub_f32 v140, v140, v148
  v_mfma_f32_16x16x32_bf16 v[24:27], a[112:115], a[248:251], v[24:27]
  ds_read_b128 a[244:247], v3 offset:1024
  buffer_load_dwordx4 v3, s[4:7], s52 offen offset:2048 sc1 lds
  v_sub_f32 v141, v141, v148
  v_mfma_f32_16x16x32_bf16 v[28:31], a[116:119], a[248:251], v[28:31]
  v_sub_f32 v142, v142, v148
  v_sub_f32 v143, v143, v148
  v_mfma_f32_16x16x32_bf16 v[24:27], a[120:123], a[252:255], v[24:27]
  ds_read_b128 a[248:251], v3 offset:2048
  v_sub_f32 v144, v144, v148
  v_sub_f32 v145, v145, v148
  v_mfma_f32_16x16x32_bf16 v[28:31], a[124:127], a[252:255], v[28:31]
  v_sub_f32 v146, v146, v148
  v_sub_f32 v147, v147, v148
  v_mfma_f32_16x16x32_bf16 v[24:27], a[128:131], a[224:227], v[24:27]
  ds_read_b128 a[252:255], v3 offset:3072
  buffer_load_dwordx4 v3, s[4:7], s52 offen offset:3072 sc1 lds
  s_add_u32 s52, s52, 4096
  v_mfma_f32_16x16x32_bf16 v[28:31], a[132:135], a[224:227], v[28:31]
  s_add_u32 m0, s30, 45056
  v_exp_f32 v140, v140
  v_mfma_f32_16x16x32_bf16 v[24:27], a[136:139], a[228:231], v[24:27]
  ds_read_b128 a[224:227], v3 offset:4096
  v_exp_f32 v141, v141
  v_exp_f32 v142, v142
  v_mfma_f32_16x16x32_bf16 v[28:31], a[140:143], a[228:231], v[28:31]
  s_waitcnt lgkmcnt(5)
  v_exp_f32 v143, v143
  v_exp_f32 v144, v144
  v_mfma_f32_16x16x32_bf16 v[24:27], a[144:147], a[232:235], v[24:27]
  ds_read_b128 a[228:231], v3 offset:5120
  buffer_load_dwordx4 v3, s[4:7], s52 offen offset:0 sc1 lds
  v_exp_f32 v145, v145
  v_mfma_f32_16x16x32_bf16 v[28:31], a[148:151], a[232:235], v[28:31]
  v_exp_f32 v146, v146
  v_exp_f32 v147, v147
  v_mfma_f32_16x16x32_bf16 v[24:27], a[152:155], a[236:239], v[24:27]
  ds_read_b128 a[232:235], v3 offset:6144
  v_cvt_pk_bf16_f32 v128, v140, v141
  v_cvt_pk_bf16_f32 v129, v142, v143
  v_mfma_f32_16x16x32_bf16 v[28:31], a[156:159], a[236:239], v[28:31]
  s_waitcnt lgkmcnt(5)
  v_cvt_pk_bf16_f32 v130, v144, v145
  v_cvt_pk_bf16_f32 v131, v146, v147
  v_mfma_f32_16x16x32_bf16 v[32:35], a[0:3], a[240:243], 0
  ds_read_b128 a[236:239], v3 offset:7168
  buffer_load_dwordx4 a[180:183], v3, s[4:7], s64 offen offset:1024
  v_add_f32 v148, v140, v141
  v_mfma_f32_16x16x32_bf16 v[36:39], a[4:7], a[240:243], 0
  v_add_f32 v149, v142, v143
  v_add_f32 v150, v144, v145
  v_mfma_f32_16x16x32_bf16 v[32:35], a[8:11], a[244:247], v[32:35]
  ds_read_b128 a[240:243], v3 offset:8192
  v_add_f32 v151, v146, v147
  v_add_f32 v148, v148, v149
  v_mfma_f32_16x16x32_bf16 v[36:39], a[12:15], a[244:247], v[36:39]
  s_waitcnt lgkmcnt(5)
  v_add_f32 v150, v150, v151
  v_add_f32 v148, v148, v150
  v_mfma_f32_16x16x32_bf16 v[32:35], a[16:19], a[248:251], v[32:35]
  ds_read_b128 a[244:247], v3 offset:9216
  buffer_load_dwordx4 a[184:187], v3, s[4:7], s65 offen offset:1024
  ds_read_b64 v[68:69], v23 offset:512
  v_mfma_f32_16x16x32_bf16 v[36:39], a[20:23], a[248:251], v[36:39]
  v_mfma_f32_16x16x32_bf16 v[140:143], v[132:135], v[128:131], 0
  v_mfma_f32_16x16x32_bf16 v[32:35], a[24:27], a[252:255], v[32:35]
  ds_read_b128 a[248:251], v3 offset:10240
  v_mfma_f32_16x16x32_bf16 v[144:147], v[136:139], v[128:131], 0
  v_mfma_f32_16x16x32_bf16 v[36:39], a[28:31], a[252:255], v[36:39]
  s_waitcnt lgkmcnt(6)
  v_mov_b32 v149, v148
  s_nop 1
  v_permlane16_swap_b32 v148, v149
  v_mfma_f32_16x16x32_bf16 v[32:35], a[32:35], a[224:227], v[32:35]
  ds_read_b128 a[252:255], v3 offset:11264
  buffer_load_dwordx4 a[188:191], v3, s[4:7], s66 offen offset:1024
  v_add_f32 v148, v148, v149
  v_mfma_f32_16x16x32_bf16 v[36:39], a[36:39], a[224:227], v[36:39]
  s_waitcnt lgkmcnt(2)
  v_mul_f32 v56, v69, v40
  v_mul_f32 v57, v69, v41
  v_mfma_f32_16x16x32_bf16 v[32:35], a[40:43], a[228:231], v[32:35]
  ds_read_b128 a[224:227], v3 offset:12288
  v_mul_f32 v58, v69, v42
  v_mul_f32 v59, v69, v43
  v_mfma_f32_16x16x32_bf16 v[36:39], a[44:47], a[228:231], v[36:39]
  v_mul_f32 v60, v69, v44
  v_mul_f32 v61, v69, v45
  v_mfma_f32_16x16x32_bf16 v[32:35], a[48:51], a[232:235], v[32:35]
  ds_read_b128 a[228:231], v3 offset:13312
  buffer_load_dwordx4 a[192:195], v3, s[4:7], s67 offen offset:1024
  v_mul_f32 v62, v69, v46
  v_mfma_f32_16x16x32_bf16 v[36:39], a[52:55], a[232:235], v[36:39]
  v_mul_f32 v63, v69, v47
  v_fma_f32 v56, v24, v68, -v56
  v_mfma_f32_16x16x32_bf16 v[32:35], a[56:59], a[236:239], v[32:35]
  ds_read_b128 a[232:235], v3 offset:14336
  v_fma_f32 v57, v25, v68, -v57
  v_fma_f32 v58, v26, v68, -v58
  v_mfma_f32_16x16x32_bf16 v[36:39], a[60:63], a[236:239], v[36:39]
  v_fma_f32 v59, v27, v68, -v59
  v_fma_f32 v60, v28, v68, -v60
  v_mfma_f32_16x16x32_bf16 v[32:35], a[64:67], a[240:243], v[32:35]
  ds_read_b128 a[236:239], v3 offset:15360
  buffer_load_dwordx4 a[196:199], v3, s[4:7], s68 offen offset:1024
  v_fma_f32 v61, v29, v68, -v61
  v_mfma_f32_16x16x32_bf16 v[36:39], a[68:71], a[240:243], v[36:39]
  v_fma_f32 v62, v30, v68, -v62
  v_fma_f32 v63, v31, v68, -v63
  v_mfma_f32_16x16x32_bf16 v[32:35], a[72:75], a[244:247], v[32:35]
  ds_read_b128 a[240:243], v3 offset:16384
  v_cvt_pk_bf16_f32 v64, v56, v57
  v_cvt_pk_bf16_f32 v65, v58, v59
  v_mfma_f32_16x16x32_bf16 v[36:39], a[76:79], a[244:247], v[36:39]
  s_waitcnt lgkmcnt(5)
  v_cvt_pk_bf16_f32 v66, v60, v61
  v_cvt_pk_bf16_f32 v67, v62, v63
  v_mfma_f32_16x16x32_bf16 v[32:35], a[80:83], a[248:251], v[32:35]
  ds_read_b128 a[244:247], v3 offset:17408
  buffer_load_dwordx4 a[200:203], v3, s[4:7], s64 offen offset:2048
  ds_write_b128 v6, v[64:67] offset:13056
  v_mfma_f32_16x16x32_bf16 v[36:39], a[84:87], a[248:251], v[36:39]
  v_mov_b32 v149, v148
  s_nop 1
  v_permlane32_swap_b32 v148, v149
  v_mfma_f32_16x16x32_bf16 v[32:35], a[88:91], a[252:255], v[32:35]
  ds_read_b128 a[248:251], v3 offset:18432
  v_add_f32 v148, v148, v149
  v_rcp_f32 v148, v148
  v_mfma_f32_16x16x32_bf16 v[36:39], a[92:95], a[252:255], v[36:39]
  s_waitcnt lgkmcnt(6)
  v_mul_f32 v140, v140, v148
  v_mul_f32 v141, v141, v148
  v_mfma_f32_16x16x32_bf16 v[32:35], a[96:99], a[224:227], v[32:35]
  ds_read_b128 a[252:255], v3 offset:19456
  buffer_load_dwordx4 a[204:207], v3, s[4:7], s65 offen offset:2048
  v_mul_f32 v142, v142, v148
  v_mfma_f32_16x16x32_bf16 v[36:39], a[100:103], a[224:227], v[36:39]
  v_mul_f32 v143, v143, v148
  v_mul_f32 v144, v144, v148
  v_mfma_f32_16x16x32_bf16 v[32:35], a[104:107], a[228:231], v[32:35]
  s_waitcnt lgkmcnt(2)
  s_waitcnt vmcnt(12)
  s_barrier
  ds_read_b128 a[224:227], v3 offset:20480
  v_mul_f32 v145, v145, v148
  v_mul_f32 v146, v146, v148
  v_mfma_f32_16x16x32_bf16 v[36:39], a[108:111], a[228:231], v[36:39]
  v_mul_f32 v147, v147, v148
  v_cvt_pk_bf16_f32 v128, v140, v141
  v_mfma_f32_16x16x32_bf16 v[32:35], a[112:115], a[232:235], v[32:35]
  ds_read_b128 a[228:231], v3 offset:21504
  buffer_load_dwordx4 a[208:211], v3, s[4:7], s66 offen offset:2048
  v_cvt_pk_bf16_f32 v129, v142, v143
  v_mfma_f32_16x16x32_bf16 v[36:39], a[116:119], a[232:235], v[36:39]
  v_cvt_pk_bf16_f32 v130, v144, v145
  v_cvt_pk_bf16_f32 v131, v146, v147
  v_mfma_f32_16x16x32_bf16 v[32:35], a[120:123], a[236:239], v[32:35]
  ds_read_b128 a[232:235], v3 offset:22528
  s_add_u32 s57, s71, s26
  s_add_u32 s57, s57, 143360
  s_cmp_eq_u32 s12, 1
  s_cbranch_scc1 Ldb2
  buffer_store_dwordx2 v[128:129], v10, s[4:7], s57 offen sc1
  buffer_store_dwordx2 v[130:131], v11, s[4:7], s57 offen sc1
  s_branch Lde2
Ldb2:
  buffer_store_dwordx2 v[128:129], v10, s[4:7], s57 offen
  buffer_store_dwordx2 v[130:131], v11, s[4:7], s57 offen
Lde2:
  v_mfma_f32_16x16x32_bf16 v[36:39], a[124:127], a[236:239], v[36:39]
  v_mov_b32 v104, 0
  v_mov_b32 v105, 0
  v_mfma_f32_16x16x32_bf16 v[32:35], a[128:131], a[240:243], v[32:35]
  ds_read_b128 a[236:239], v3 offset:23552
  buffer_load_dwordx4 a[212:215], v3, s[4:7], s67 offen offset:2048
  v_mov_b32 v106, 0
  v_mfma_f32_16x16x32_bf16 v[36:39], a[132:135], a[240:243], v[36:39]
  v_mov_b32 v107, 0
  s_mov_b32 exec_hi, 0xffff
  ds_read_b128 v[104:107], v8 offset:26112
  s_mov_b32 exec_hi, -1
  v_mfma_f32_16x16x32_bf16 v[32:35], a[136:139], a[244:247], v[32:35]
  ds_read_b128 a[240:243], v3 offset:24576
  ds_read_b128 v[108:111], v7 offset:21760
  ds_read_b128 v[112:115], v7 offset:26112
  v_mfma_f32_16x16x32_bf16 v[36:39], a[140:143], a[244:247], v[36:39]
  s_waitcnt lgkmcnt(8)
  v_mfma_f32_16x16x32_bf16 v[32:35], a[144:147], a[248:251], v[32:35]
  ds_read_b128 a[244:247], v3 offset:25600
  buffer_load_dwordx4 a[216:219], v3, s[4:7], s68 offen offset:2048
  v_mfma_f32_16x16x32_bf16 v[36:39], a[148:151], a[248:251], v[36:39]
  v_mfma_f32_16x16x32_bf16 v[32:35], a[152:155], a[252:255], v[32:35]
  ds_read_b128 a[248:251], v3 offset:26624
  v_mfma_f32_16x16x32_bf16 v[36:39], a[156:159], a[252:255], v[36:39]
  s_waitcnt lgkmcnt(8)
  s_waitcnt lgkmcnt(2)
  v_mfma_f32_16x16x32_bf16 v[116:119], v[108:111], v[104:107], 0
  v_mfma_f32_16x16x32_bf16 v[24:27], a[0:3], a[224:227], 0
  ds_read_b128 a[252:255], v3 offset:27648
  buffer_load_dwordx4 a[220:223], v3, s[4:7], s64 offen offset:3072
  s_add_u32 s63, s32, 0
  v_mfma_f32_16x16x32_bf16 v[28:31], a[4:7], a[224:227], 0
  v_mfma_f32_16x16x32_bf16 v[120:123], v[112:115], v[104:107], 0
  v_mfma_f32_16x16x32_bf16 v[24:27], a[8:11], a[228:231], v[24:27]
  ds_read_b128 a[224:227], v3 offset:28672
  v_mfma_f32_16x16x32_bf16 v[28:31], a[12:15], a[228:231], v[28:31]
  ds_read_b64_tr_b16 v[108:109], v9 offset:21760
  ds_read_b64_tr_b16 v[110:111], v9 offset:26112
  v_mfma_f32_16x16x32_bf16 v[24:27], a[16:19], a[232:235], v[24:27]
  ds_read_b128 a[228:231], v3 offset:29696
  buffer_load_dwordx4 v[252:255], v3, s[4:7], s63 offen offset:0
  s_add_u32 s63, s32, 20480
  v_mfma_f32_16x16x32_bf16 v[28:31], a[20:23], a[232:235], v[28:31]
  ds_read_b64 v[70:71], v23 offset:640
  ds_read_b64_tr_b16 v[112:113], v9 offset:21792
  v_mfma_f32_16x16x32_bf16 v[24:27], a[24:27], a[236:239], v[24:27]
  ds_read_b128 a[232:235], v3 offset:30720
  ds_read_b64_tr_b16 v[114:115], v9 offset:26144
  s_mov_b32 s56, 0x3ea52b5c
  v_mfma_f32_16x16x32_bf16 v[28:31], a[28:31], a[236:239], v[28:31]
  s_waitcnt lgkmcnt(10)
  v_mfma_f32_16x16x32_bf16 v[24:27], a[32:35], a[240:243], v[24:27]
  ds_read_b128 a[236:239], v3 offset:31744
  buffer_load_dwordx4 v[248:251], v3, s[4:7], s63 offen offset:0
  s_add_u32 s63, s32, 0
  v_mfma_f32_16x16x32_bf16 v[28:31], a[36:39], a[240:243], v[28:31]
  v_fma_f32 v116, v116, s56, v96
  v_fma_f32 v117, v117, s56, v97
  v_mfma_f32_16x16x32_bf16 v[24:27], a[40:43], a[244:247], v[24:27]
  s_waitcnt lgkmcnt(4)
  ds_read_b128 a[240:243], v3 offset:32768
  v_mul_f32 v56, v71, v40
  v_mul_f32 v57, v71, v41
  v_mfma_f32_16x16x32_bf16 v[28:31], a[44:47], a[244:247], v[28:31]
  v_mul_f32 v58, v71, v42
  v_mul_f32 v59, v71, v43
  v_mfma_f32_16x16x32_bf16 v[24:27], a[48:51], a[248:251], v[24:27]
  ds_read_b128 a[244:247], v3 offset:33792
  buffer_load_dwordx4 v[244:247], v3, s[4:7], s63 offen offset:1024
  s_add_u32 s63, s32, 20480
  v_mfma_f32_16x16x32_bf16 v[28:31], a[52:55], a[248:251], v[28:31]
  v_mul_f32 v60, v71, v44
  v_mul_f32 v61, v71, v45
  v_mfma_f32_16x16x32_bf16 v[24:27], a[56:59], a[252:255], v[24:27]
  ds_read_b128 a[248:251], v3 offset:34816
  v_mul_f32 v62, v71, v46
  v_mul_f32 v63, v71, v47
  v_mfma_f32_16x16x32_bf16 v[28:31], a[60:63], a[252:255], v[28:31]
  v_fma_f32 v56, v32, v70, -v56
  v_fma_f32 v57, v33, v70, -v57
  v_mfma_f32_16x16x32_bf16 v[24:27], a[64:67], a[224:227], v[24:27]
  ds_read_b128 a[252:255], v3 offset:35840
  buffer_load_dwordx4 v[240:243], v3, s[4:7], s63 offen offset:1024
  s_add_u32 s63, s32, 0
  v_mfma_f32_16x16x32_bf16 v[28:31], a[68:71], a[224:227], v[28:31]
  v_fma_f32 v58, v34, v70, -v58
  v_fma_f32 v59, v35, v70, -v59
  v_mfma_f32_16x16x32_bf16 v[24:27], a[72:75], a[228:231], v[24:27]
  ds_read_b128 a[224:227], v3 offset:36864
  v_fma_f32 v60, v36, v70, -v60
  v_fma_f32 v61, v37, v70, -v61
  v_mfma_f32_16x16x32_bf16 v[28:31], a[76:79], a[228:231], v[28:31]
  s_waitcnt lgkmcnt(5)
  v_fma_f32 v62, v38, v70, -v62
  v_fma_f32 v63, v39, v70, -v63
  v_mfma_f32_16x16x32_bf16 v[24:27], a[80:83], a[232:235], v[24:27]
  ds_read_b128 a[228:231], v3 offset:37888
  buffer_load_dwordx4 v[236:239], v3, s[4:7], s63 offen offset:2048
  s_add_u32 s63, s32, 20480
  v_mfma_f32_16x16x32_bf16 v[28:31], a[84:87], a[232:235], v[28:31]
  v_cvt_pk_bf16_f32 v64, v56, v57
  v_cvt_pk_bf16_f32 v65, v58, v59
  v_mfma_f32_16x16x32_bf16 v[24:27], a[88:91], a[236:239], v[24:27]
  ds_read_b128 a[232:235], v3 offset:38912
  v_cvt_pk_bf16_f32 v66, v60, v61
  v_cvt_pk_bf16_f32 v67, v62, v63
  v_mfma_f32_16x16x32_bf16 v[28:31], a[92:95], a[236:239], v[28:31]
  s_waitcnt lgkmcnt(5)
  ds_write_b128 v6, v[64:67] offset:8704
  v_fma_f32 v118, v118, s56, v98
  v_mfma_f32_16x16x32_bf16 v[24:27], a[96:99], a[240:243], v[24:27]
  ds_read_b128 a[236:239], v3 offset:39936
  buffer_load_dwordx4 v[232:235], v3, s[4:7], s63 offen offset:2048
  s_add_u32 s63, s32, 0
  v_mfma_f32_16x16x32_bf16 v[28:31], a[100:103], a[240:243], v[28:31]
  v_fma_f32 v119, v119, s56, v99
  v_fma_f32 v120, v120, s56, v100
  v_mfma_f32_16x16x32_bf16 v[24:27], a[104:107], a[244:247], v[24:27]
  s_waitcnt lgkmcnt(1)
  s_waitcnt vmcnt(19)
  s_barrier
  s_lshl_b32 s58, s34, 1
  s_add_u32 s58, s58, s45
  s_add_u32 s58, s58, s29
  s_add_u32 s58, s58, 4
  s_mul_i32 s58, s58, 20480
  s_add_u32 s58, s58, 8388608
  s_lshl_b32 s62, s20, 11
  s_lshl_b32 s59, s41, 10
  s_add_u32 s59, s59, s58
  s_add_u32 m0, s62, 142592
  s_nop 0
  buffer_load_dwordx4 v3, s[4:7], s59 offen lds
  s_lshl_b32 s59, s42, 10
  s_add_u32 s59, s59, s58
  s_add_u32 m0, s62, 143616
  s_nop 0
  buffer_load_dwordx4 v3, s[4:7], s59 offen lds
  s_lshl_b32 s58, s34, 1
  s_add_u32 s58, s58, s45
  s_add_u32 s58, s58, s29
  s_mul_i32 s58, s58, 20480
  s_add_u32 s58, s58, 8388608
  s_lshl_b32 s62, s20, 11
  s_lshl_b32 s59, s41, 10
  s_add_u32 s59, s59, s58
  s_add_u32 m0, s62, 150784
  s_nop 0
  buffer_load_dwordx4 v3, s[4:7], s59 offen lds
  s_lshl_b32 s59, s42, 10
  s_add_u32 s59, s59, s58
  s_add_u32 m0, s62, 151808
  s_nop 0
  buffer_load_dwordx4 v3, s[4:7], s59 offen lds
  s_xor_b32 s96, s45, 0
  s_lshl_b32 s59, s34, 1
  s_add_u32 s96, s96, s59
  s_add_u32 s96, s96, s29
  s_add_u32 s96, s96, 4
  s_mul_i32 s96, s96, 20480
  s_mul_i32 s59, s20, 5120
  s_add_u32 s96, s96, s59
  s_add_u32 s96, s96, s26
  s_add_u32 s96, s96, 18874368
  s_xor_b32 s97, s45, 1
  s_lshl_b32 s59, s34, 1
  s_add_u32 s97, s97, s59
  s_add_u32 s97, s97, s29
  s_add_u32 s97, s97, 4
  s_mul_i32 s97, s97, 20480
  s_mul_i32 s59, s20, 5120
  s_add_u32 s97, s97, s59
  s_add_u32 s97, s97, s26
  s_add_u32 s97, s97, 18874368
  s_xor_b32 s98, s45, 0
  s_lshl_b32 s59, s34, 1
  s_add_u32 s98, s98, s59
  s_add_u32 s98, s98, s29
  s_mul_i32 s98, s98, 20480
  s_mul_i32 s59, s20, 5120
  s_add_u32 s98, s98, s59
  s_add_u32 s98, s98, s26
  s_add_u32 s98, s98, 18874368
  s_xor_b32 s99, s45, 1
  s_lshl_b32 s59, s34, 1
  s_add_u32 s99, s99, s59
  s_add_u32 s99, s99, s29
  s_mul_i32 s99, s99, 20480
  s_mul_i32 s59, s20, 5120
  s_add_u32 s99, s99, s59
  s_add_u32 s99, s99, s26
  s_add_u32 s99, s99, 18874368
  ds_read_b128 a[240:243], v3 offset:40960
  v_fma_f32 v121, v121, s56, v101
  v_fma_f32 v122, v122, s56, v102
  v_mfma_f32_16x16x32_bf16 v[28:31], a[108:111], a[244:247], v[28:31]
  v_fma_f32 v123, v123, s56, v103
  v_max3_f32 v124, v116, v117, v118
  v_mfma_f32_16x16x32_bf16 v[24:27], a[112:115], a[248:251], v[24:27]
  ds_read_b128 a[244:247], v3 offset:41984
  buffer_load_dwordx4 v[228:231], v3, s[4:7], s63 offen offset:3072
  s_add_u32 s63, s32, 20480
  v_mfma_f32_16x16x32_bf16 v[28:31], a[116:119], a[248:251], v[28:31]
  v_max3_f32 v125, v119, v120, v121
  v_max3_f32 v124, v124, v122, v123
  v_mfma_f32_16x16x32_bf16 v[24:27], a[120:123], a[252:255], v[24:27]
  ds_read_b128 a[248:251], v3 offset:43008
  v_max_f32 v124, v124, v125
  v_mov_b32 v125, v124
  v_mfma_f32_16x16x32_bf16 v[28:31], a[124:127], a[252:255], v[28:31]
  s_nop 0
  v_permlane16_swap_b32 v124, v125
  v_max_f32 v124, v124, v125
  v_mfma_f32_16x16x32_bf16 v[24:27], a[128:131], a[224:227], v[24:27]
  ds_read_b128 a[252:255], v3 offset:44032
  buffer_load_dwordx4 v[224:227], v3, s[4:7], s63 offen offset:3072
  s_add_u32 s63, s32, 4096
  v_mfma_f32_16x16x32_bf16 v[28:31], a[132:135], a[224:227], v[28:31]
  v_mov_b32 v125, v124
  s_nop 1
  v_permlane32_swap_b32 v124, v125
  v_mfma_f32_16x16x32_bf16 v[24:27], a[136:139], a[228:231], v[24:27]
  ds_read_b128 a[224:227], v3 offset:45056
  v_max_f32 v124, v124, v125
  v_sub_f32 v116, v116, v124
  v_mfma_f32_16x16x32_bf16 v[28:31], a[140:143], a[228:231], v[28:31]
  s_waitcnt lgkmcnt(5)
  v_sub_f32 v117, v117, v124
  v_sub_f32 v118, v118, v124
  v_mfma_f32_16x16x32_bf16 v[24:27], a[144:147], a[232:235], v[24:27]
  ds_read_b128 a[228:231], v3 offset:46080
  buffer_load_dwordx4 v[220:223], v3, s[4:7], s63 offen offset:0
  s_add_u32 s63, s32, 24576
  v_mfma_f32_16x16x32_bf16 v[28:31], a[148:151], a[232:235], v[28:31]
  v_sub_f32 v119, v119, v124
  v_sub_f32 v120, v120, v124
  v_mfma_f32_16x16x32_bf16 v[24:27], a[152:155], a[236:239], v[24:27]
  ds_read_b128 a[232:235], v3 offset:47104
  v_sub_f32 v121, v121, v124
  v_sub_f32 v122, v122, v124
  v_mfma_f32_16x16x32_bf16 v[28:31], a[156:159], a[236:239], v[28:31]
  s_waitcnt lgkmcnt(5)
  v_sub_f32 v123, v123, v124
  v_exp_f32 v116, v116
  v_mfma_f32_16x16x32_bf16 v[32:35], a[0:3], a[240:243], 0
  ds_read_b128 a[236:239], v3 offset:48128
  buffer_load_dwordx4 v[216:219], v3, s[4:7], s63 offen offset:0
  s_add_u32 s63, s32, 4096
  v_mfma_f32_16x16x32_bf16 v[36:39], a[4:7], a[240:243], 0
  v_exp_f32 v117, v117
  v_exp_f32 v118, v118
  s_lshl_b32 s62, s23, 10
  s_add_u32 s62, s62, s47
  buffer_load_dword v85, v87, s[4:7], s62 offen sc1
  v_mfma_f32_16x16x32_bf16 v[32:35], a[8:11], a[244:247], v[32:35]
  ds_read_b128 a[240:243], v3 offset:49152
  v_exp_f32 v119, v119
  v_exp_f32 v120, v120
  v_mfma_f32_16x16x32_bf16 v[36:39], a[12:15], a[244:247], v[36:39]
  s_waitcnt lgkmcnt(5)
  v_exp_f32 v121, v121
  v_exp_f32 v122, v122
  v_mfma_f32_16x16x32_bf16 v[32:35], a[16:19], a[248:251], v[32:35]
  ds_read_b128 a[244:247], v3 offset:50176
  buffer_load_dwordx4 v[212:215], v3, s[4:7], s63 offen offset:1024
  s_add_u32 s63, s32, 24576
  v_mfma_f32_16x16x32_bf16 v[36:39], a[20:23], a[248:251], v[36:39]
  ds_read_b64 v[68:69], v23 offset:768
  v_exp_f32 v123, v123
  v_mfma_f32_16x16x32_bf16 v[32:35], a[24:27], a[252:255], v[32:35]
  ds_read_b128 a[248:251], v3 offset:51200
  v_cvt_pk_bf16_f32 v104, v116, v117
  v_cvt_pk_bf16_f32 v105, v118, v119
  v_mfma_f32_16x16x32_bf16 v[36:39], a[28:31], a[252:255], v[36:39]
  s_waitcnt lgkmcnt(6)
  v_cvt_pk_bf16_f32 v106, v120, v121
  v_cvt_pk_bf16_f32 v107, v122, v123
  v_mfma_f32_16x16x32_bf16 v[32:35], a[32:35], a[224:227], v[32:35]
  ds_read_b128 a[252:255], v3 offset:52224
  buffer_load_dwordx4 v[208:211], v3, s[4:7], s63 offen offset:1024
  s_add_u32 s63, s32, 4096
  v_mfma_f32_16x16x32_bf16 v[36:39], a[36:39], a[224:227], v[36:39]
  v_add_f32 v124, v116, v117
  v_add_f32 v125, v118, v119
  v_mfma_f32_16x16x32_bf16 v[32:35], a[40:43], a[228:231], v[32:35]
  s_waitcnt lgkmcnt(2)
  ds_read_b128 a[224:227], v3 offset:53248
  v_mul_f32 v56, v69, v40
  v_mul_f32 v57, v69, v41
  v_mfma_f32_16x16x32_bf16 v[36:39], a[44:47], a[228:231], v[36:39]
  v_mul_f32 v58, v69, v42
  v_mul_f32 v59, v69, v43
  v_mfma_f32_16x16x32_bf16 v[32:35], a[48:51], a[232:235], v[32:35]
  ds_read_b128 a[228:231], v3 offset:54272
  buffer_load_dwordx4 v[204:207], v3, s[4:7], s63 offen offset:2048
  s_add_u32 s63, s32, 24576
  v_mfma_f32_16x16x32_bf16 v[36:39], a[52:55], a[232:235], v[36:39]
  v_mul_f32 v60, v69, v44
  v_mul_f32 v61, v69, v45
  v_mfma_f32_16x16x32_bf16 v[32:35], a[56:59], a[236:239], v[32:35]
  ds_read_b128 a[232:235], v3 offset:55296
  v_mul_f32 v62, v69, v46
  v_mul_f32 v63, v69, v47
  v_mfma_f32_16x16x32_bf16 v[36:39], a[60:63], a[236:239], v[36:39]
  v_fma_f32 v56, v24, v68, -v56
  v_fma_f32 v57, v25, v68, -v57
  v_mfma_f32_16x16x32_bf16 v[32:35], a[64:67], a[240:243], v[32:35]
  ds_read_b128 a[236:239], v3 offset:56320
  buffer_load_dwordx4 v[200:203], v3, s[4:7], s63 offen offset:2048
  s_add_u32 s63, s32, 4096
  v_mfma_f32_16x16x32_bf16 v[36:39], a[68:71], a[240:243], v[36:39]
  v_fma_f32 v58, v26, v68, -v58
  v_fma_f32 v59, v27, v68, -v59
  v_mfma_f32_16x16x32_bf16 v[32:35], a[72:75], a[244:247], v[32:35]
  ds_read_b128 a[240:243], v3 offset:57344
  v_fma_f32 v60, v28, v68, -v60
  v_fma_f32 v61, v29, v68, -v61
  v_mfma_f32_16x16x32_bf16 v[36:39], a[76:79], a[244:247], v[36:39]
  s_waitcnt lgkmcnt(5)
  v_fma_f32 v62, v30, v68, -v62
  v_fma_f32 v63, v31, v68, -v63
  v_mfma_f32_16x16x32_bf16 v[32:35], a[80:83], a[248:251], v[32:35]
  ds_read_b128 a[244:247], v3 offset:58368
  buffer_load_dwordx4 v[196:199], v3, s[4:7], s63 offen offset:3072
  s_add_u32 s63, s32, 24576
  v_mfma_f32_16x16x32_bf16 v[36:39], a[84:87], a[248:251], v[36:39]
  v_cvt_pk_bf16_f32 v64, v56, v57
  v_cvt_pk_bf16_f32 v65, v58, v59
  v_mfma_f32_16x16x32_bf16 v[32:35], a[88:91], a[252:255], v[32:35]
  ds_read_b128 a[248:251], v3 offset:59392
  v_cvt_pk_bf16_f32 v66, v60, v61
  v_cvt_pk_bf16_f32 v67, v62, v63
  v_mfma_f32_16x16x32_bf16 v[36:39], a[92:95], a[252:255], v[36:39]
  s_waitcnt lgkmcnt(5)
  ds_write_b128 v6, v[64:67] offset:4352
  v_add_f32 v126, v120, v121
  v_mfma_f32_16x16x32_bf16 v[32:35], a[96:99], a[224:227], v[32:35]
  ds_read_b128 a[252:255], v3 offset:60416
  buffer_load_dwordx4 v[192:195], v3, s[4:7], s63 offen offset:3072
  s_add_u32 s63, s32, 8192
  v_mfma_f32_16x16x32_bf16 v[36:39], a[100:103], a[224:227], v[36:39]
  v_add_f32 v127, v122, v123
  v_add_f32 v124, v124, v125
  v_mfma_f32_16x16x32_bf16 v[32:35], a[104:107], a[228:231], v[32:35]
  s_waitcnt vmcnt(11)
  ds_read_b128 v[72:75], v0 offset:0
  v_add_u32 v78, s44, v0
  ds_read_b64 v[76:77], v78 offset:1024
  v_mfma_f32_16x16x32_bf16 v[36:39], a[108:111], a[228:231], v[36:39]
  s_waitcnt lgkmcnt(7)
  v_add_f32 v126, v126, v127
  v_add_f32 v124, v124, v126
  v_mfma_f32_16x16x32_bf16 v[32:35], a[112:115], a[232:235], v[32:35]
  buffer_load_dwordx4 v[188:191], v3, s[4:7], s63 offen offset:0
  s_add_u32 s63, s32, 28672
  v_mfma_f32_16x16x32_bf16 v[36:39], a[116:119], a[232:235], v[36:39]
  v_mfma_f32_16x16x32_bf16 v[116:119], v[108:111], v[104:107], 0
  s_cmp_lg_u32 s20, 0
  s_cbranch_scc1 Lpd3
  s_waitcnt vmcnt(7)
  v_cmp_ne_u32 vcc, 1, v85
  s_cbranch_vccz Lpd3
  s_lshl_b32 s62, s23, 10
  s_add_u32 s62, s62, s47
  s_mov_b32 s61, 0
Lp3:
  buffer_load_dword v85, v87, s[4:7], s62 offen sc1
  s_add_u32 s61, s61, 1
  s_cmp_gt_u32 s61, 0x100000
  s_cbranch_scc1 Lpd3
  s_waitcnt vmcnt(0)
  v_cmp_ne_u32 vcc, 1, v85
  s_cbranch_vccnz Lp3
Lpd3:
  s_barrier
  s_mul_i32 s58, s23, 1179648
  s_cmp_eq_u32 s21, 0
  s_cselect_b32 s58, 0, s58
  s_add_u32 s58, s58, s46
  s_lshl_b32 s59, s20, 10
  s_add_u32 s60, s58, s59
  s_add_u32 m0, s59, 102400
  s_nop 0
  buffer_load_dwordx4 v3, s[4:7], s60 offen sc1 lds
  s_lshl_b32 s59, s20, 6
  s_add_u32 s60, s58, s59
  s_add_u32 s60, s60, 4096
  s_add_u32 m0, s59, 106496
  s_mov_b64 exec, 0xf
  buffer_load_dwordx4 v3, s[4:7], s60 offen sc1 lds
  s_mov_b64 exec, -1
  v_mfma_f32_16x16x32_bf16 v[32:35], a[120:123], a[236:239], v[32:35]
  v_mfma_f32_16x16x32_bf16 v[120:123], v[112:115], v[104:107], 0
  v_mfma_f32_16x16x32_bf16 v[36:39], a[124:127], a[236:239], v[36:39]
  s_waitcnt lgkmcnt(5)
  s_waitcnt lgkmcnt(0)
  s_add_u32 s60, s43, -1
  v_and_b32 v76, s60, v76
  v_and_b32 v77, s60, v77
  v_mfma_f32_16x16x32_bf16 v[32:35], a[128:131], a[240:243], v[32:35]
  buffer_load_dwordx4 v[184:187], v3, s[4:7], s63 offen offset:0
  s_add_u32 s63, s32, 8192
  v_mfma_f32_16x16x32_bf16 v[36:39], a[132:135], a[240:243], v[36:39]
  v_lshlrev_b32 v79, 16, v72
  v_accvgpr_write_b32 a0, v79
  v_mfma_f32_16x16x32_bf16 v[32:35], a[136:139], a[244:247], v[32:35]
  v_and_b32 v80, 0xffff0000, v72
  v_accvgpr_write_b32 a1, v80
  v_mfma_f32_16x16x32_bf16 v[36:39], a[140:143], a[244:247], v[36:39]
  v_lshlrev_b32 v81, 16, v73
  v_accvgpr_write_b32 a2, v81
  v_mfma_f32_16x16x32_bf16 v[32:35], a[144:147], a[248:251], v[32:35]
  buffer_load_dwordx4 v[180:183], v3, s[4:7], s63 offen offset:1024
  s_add_u32 s63, s32, 28672
  v_mfma_f32_16x16x32_bf16 v[36:39], a[148:151], a[248:251], v[36:39]
  v_and_b32 v82, 0xffff0000, v73
  v_accvgpr_write_b32 a3, v82
  v_mfma_f32_16x16x32_bf16 v[32:35], a[152:155], a[252:255], v[32:35]
  v_lshlrev_b32 v79, 16, v74
  v_accvgpr_write_b32 a4, v79
  v_mfma_f32_16x16x32_bf16 v[36:39], a[156:159], a[252:255], v[36:39]
  v_and_b32 v80, 0xffff0000, v74
  v_accvgpr_write_b32 a5, v80
  v_mov_b32 v125, v124
  s_nop 1
  v_permlane16_swap_b32 v124, v125
  v_add_f32 v124, v124, v125
  v_mov_b32 v125, v124
  s_nop 1
  v_permlane32_swap_b32 v124, v125
  v_add_f32 v124, v124, v125
  v_rcp_f32 v124, v124
  s_nop 0
  v_mul_f32 v116, v116, v124
  v_mul_f32 v117, v117, v124
  v_mul_f32 v118, v118, v124
  v_mul_f32 v119, v119, v124
  v_mul_f32 v120, v120, v124
  v_mul_f32 v121, v121, v124
  v_mul_f32 v122, v122, v124
  v_mul_f32 v123, v123, v124
  v_cvt_pk_bf16_f32 v104, v116, v117
  v_cvt_pk_bf16_f32 v105, v118, v119
  v_cvt_pk_bf16_f32 v106, v120, v121
  v_cvt_pk_bf16_f32 v107, v122, v123
  s_add_u32 s57, s71, s26
  s_add_u32 s57, s57, 102400
  s_cmp_eq_u32 s12, 1
  s_cbranch_scc1 Ldb4
  buffer_store_dwordx2 v[104:105], v10, s[4:7], s57 offen sc1
  buffer_store_dwordx2 v[106:107], v11, s[4:7], s57 offen sc1
  s_branch Lde4
Ldb4:
  buffer_store_dwordx2 v[104:105], v10, s[4:7], s57 offen
  buffer_store_dwordx2 v[106:107], v11, s[4:7], s57 offen
Lde4:
  ds_read_b64 v[70:71], v23 offset:896
  s_waitcnt lgkmcnt(0)
  v_mul_f32 v56, v71, v40
  v_mul_f32 v57, v71, v41
  v_mul_f32 v58, v71, v42
  v_mul_f32 v59, v71, v43
  v_mul_f32 v60, v71, v44
  v_mul_f32 v61, v71, v45
  v_mul_f32 v62, v71, v46
  v_mul_f32 v63, v71, v47
  v_fma_f32 v56, v32, v70, -v56
  v_fma_f32 v57, v33, v70, -v57
  v_fma_f32 v58, v34, v70, -v58
  v_fma_f32 v59, v35, v70, -v59
  v_fma_f32 v60, v36, v70, -v60
  v_fma_f32 v61, v37, v70, -v61
  v_fma_f32 v62, v38, v70, -v62
  v_fma_f32 v63, v39, v70, -v63
  v_cvt_pk_bf16_f32 v64, v56, v57
  v_cvt_pk_bf16_f32 v65, v58, v59
  v_cvt_pk_bf16_f32 v66, v60, v61
  v_cvt_pk_bf16_f32 v67, v62, v63
  ds_write_b128 v6, v[64:67] offset:0
  s_waitcnt vmcnt(4)
  s_waitcnt lgkmcnt(0)
  s_barrier
  buffer_load_dwordx4 v[176:179], v3, s[4:7], s63 offen offset:1024
  s_add_u32 s63, s32, 8192
  buffer_load_dwordx4 v[172:175], v3, s[4:7], s63 offen offset:2048
  s_add_u32 s63, s32, 28672
  buffer_load_dwordx4 v[168:171], v3, s[4:7], s63 offen offset:2048
  s_add_u32 s63, s32, 8192
  buffer_load_dwordx4 v[164:167], v3, s[4:7], s63 offen offset:3072
  s_add_u32 s63, s32, 28672
  buffer_load_dwordx4 v[160:163], v3, s[4:7], s63 offen offset:3072
  s_add_u32 s63, s32, 12288
  buffer_load_dwordx4 v[156:159], v3, s[4:7], s63 offen offset:0
  s_add_u32 s63, s32, 32768
  buffer_load_dwordx4 v[152:155], v3, s[4:7], s63 offen offset:0
  v_mov_b32 v104, 0
  v_mov_b32 v128, 0
  v_mov_b32 v105, 0
  v_mov_b32 v129, 0
  v_mov_b32 v106, 0
  v_mov_b32 v130, 0
  v_mov_b32 v107, 0
  v_mov_b32 v131, 0
  s_mov_b32 exec_hi, 0xffff
  ds_read_b128 v[104:107], v8 offset:17408
  s_mov_b32 exec_hi, -1
  s_mov_b32 exec_hi, 0xffff
  ds_read_b128 v[128:131], v8 offset:8704
  s_mov_b32 exec_hi, -1
  ds_read_b128 v[108:111], v7 offset:13056
  ds_read_b128 v[132:135], v7 offset:4352
  ds_read_b128 v[112:115], v7 offset:17408
  ds_read_b128 v[136:139], v7 offset:8704
  s_waitcnt lgkmcnt(1)
  s_waitcnt lgkmcnt(0)
  v_mfma_f32_16x16x32_bf16 v[116:119], v[108:111], v[104:107], 0
  v_mfma_f32_16x16x32_bf16 v[140:143], v[132:135], v[128:131], 0
  v_mfma_f32_16x16x32_bf16 v[120:123], v[112:115], v[104:107], 0
  v_mfma_f32_16x16x32_bf16 v[144:147], v[136:139], v[128:131], 0
  ds_read_b64_tr_b16 v[108:109], v9 offset:13056
  ds_read_b64_tr_b16 v[132:133], v9 offset:4352
  ds_read_b64_tr_b16 v[110:111], v9 offset:17408
  ds_read_b64_tr_b16 v[134:135], v9 offset:8704
  ds_read_b64_tr_b16 v[112:113], v9 offset:13088
  ds_read_b64_tr_b16 v[136:137], v9 offset:4384
  ds_read_b64_tr_b16 v[114:115], v9 offset:17440
  ds_read_b64_tr_b16 v[138:139], v9 offset:8736
  s_mov_b32 s56, 0x3ea52b5c
  s_mov_b32 s56, 0x3ea52b5c
  v_fma_f32 v116, v116, s56, v96
  v_fma_f32 v140, v140, s56, v96
  v_fma_f32 v117, v117, s56, v97
  v_fma_f32 v141, v141, s56, v97
  v_fma_f32 v118, v118, s56, v98
  v_fma_f32 v142, v142, s56, v98
  v_fma_f32 v119, v119, s56, v99
  v_fma_f32 v143, v143, s56, v99
  v_fma_f32 v120, v120, s56, v100
  v_fma_f32 v144, v144, s56, v100
  v_fma_f32 v121, v121, s56, v101
  v_fma_f32 v145, v145, s56, v101
  v_fma_f32 v122, v122, s56, v102
  v_fma_f32 v146, v146, s56, v102
  v_fma_f32 v123, v123, s56, v103
  v_fma_f32 v147, v147, s56, v103
  v_max3_f32 v124, v116, v117, v118
  v_add_f32 v140, s51, v140
  v_max3_f32 v125, v119, v120, v121
  v_add_f32 v141, s51, v141
  v_max3_f32 v124, v124, v122, v123
  v_add_f32 v142, s51, v142
  v_max_f32 v124, v124, v125
  v_add_f32 v143, s51, v143
  v_mov_b32 v125, v124
  v_max3_f32 v148, v140, v141, v142
  s_nop 0
  v_permlane16_swap_b32 v124, v125
  v_max3_f32 v149, v143, v144, v145
  v_max_f32 v124, v124, v125
  v_max3_f32 v148, v148, v146, v147
  v_mov_b32 v125, v124
  v_max_f32 v148, v148, v149
  s_nop 0
  v_permlane32_swap_b32 v124, v125
  v_mov_b32 v149, v148
  v_max_f32 v124, v124, v125
  s_nop 0
  v_permlane16_swap_b32 v148, v149
  v_sub_f32 v116, v116, v124
  v_max_f32 v148, v148, v149
  v_sub_f32 v117, v117, v124
  v_mov_b32 v149, v148
  v_sub_f32 v118, v118, v124
  s_nop 0
  v_permlane32_swap_b32 v148, v149
  v_sub_f32 v119, v119, v124
  v_max_f32 v148, v148, v149
  v_sub_f32 v120, v120, v124
  v_sub_f32 v140, v140, v148
  v_sub_f32 v121, v121, v124
  v_sub_f32 v141, v141, v148
  v_sub_f32 v122, v122, v124
  v_sub_f32 v142, v142, v148
  v_sub_f32 v123, v123, v124
  v_sub_f32 v143, v143, v148
  v_exp_f32 v116, v116
  v_sub_f32 v144, v144, v148
  v_exp_f32 v117, v117
  v_sub_f32 v145, v145, v148
  v_exp_f32 v118, v118
  v_sub_f32 v146, v146, v148
  v_exp_f32 v119, v119
  v_sub_f32 v147, v147, v148
  s_waitcnt vmcnt(7)
  s_barrier
  s_cmp_lg_u32 s20, 0
  s_cbranch_scc1 Lf5
  s_add_u32 s62, s100, s28
  s_add_u32 s62, s62, 2048
  s_lshl_b32 s61, s22, 2
  s_add_u32 s62, s62, s61
  s_mov_b64 exec, 1
  s_cmp_eq_u32 s12, 1
  s_cbranch_scc1 Ldb6
  buffer_store_dword v86, v87, s[4:7], s62 offen sc1
  s_branch Lde6
Ldb6:
  buffer_store_dword v86, v87, s[4:7], s62 offen
Lde6:
  s_mov_b64 exec, -1
Lf5:
  v_exp_f32 v120, v120
  v_exp_f32 v140, v140
  v_exp_f32 v121, v121
  v_exp_f32 v141, v141
  v_exp_f32 v122, v122
  v_exp_f32 v142, v142
  v_exp_f32 v123, v123
  v_exp_f32 v143, v143
  v_cvt_pk_bf16_f32 v104, v116, v117
  v_exp_f32 v144, v144
  buffer_load_dwordx4 a[224:227], v3, s[4:7], s65 offen offset:3072
  v_cvt_pk_bf16_f32 v105, v118, v119
  v_exp_f32 v145, v145
  v_cvt_pk_bf16_f32 v106, v120, v121
  v_exp_f32 v146, v146
  v_cvt_pk_bf16_f32 v107, v122, v123
  v_exp_f32 v147, v147
  v_add_f32 v124, v116, v117
  v_cvt_pk_bf16_f32 v128, v140, v141
  v_add_f32 v125, v118, v119
  v_cvt_pk_bf16_f32 v129, v142, v143
  buffer_load_dwordx4 a[228:231], v3, s[4:7], s66 offen offset:3072
  v_add_f32 v126, v120, v121
  v_cvt_pk_bf16_f32 v130, v144, v145
  v_add_f32 v127, v122, v123
  v_cvt_pk_bf16_f32 v131, v146, v147
  v_add_f32 v124, v124, v125
  v_add_f32 v148, v140, v141
  v_add_f32 v126, v126, v127
  v_add_f32 v149, v142, v143
  v_add_f32 v124, v124, v126
  v_add_f32 v150, v144, v145
  buffer_load_dwordx4 a[232:235], v3, s[4:7], s67 offen offset:3072
  s_waitcnt lgkmcnt(1)
  v_add_f32 v151, v146, v147
  v_mfma_f32_16x16x32_bf16 v[116:119], v[108:111], v[104:107], 0
  v_add_f32 v148, v148, v149
  v_mfma_f32_16x16x32_bf16 v[120:123], v[112:115], v[104:107], 0
  v_add_f32 v150, v150, v151
  v_mov_b32 v125, v124
  v_add_f32 v148, v148, v150
  s_nop 0
  v_permlane16_swap_b32 v124, v125
  s_waitcnt lgkmcnt(0)
  buffer_load_dwordx4 a[236:239], v3, s[4:7], s68 offen offset:3072
  v_add_f32 v124, v124, v125
  v_mfma_f32_16x16x32_bf16 v[140:143], v[132:135], v[128:131], 0
  v_mov_b32 v125, v124
  v_mfma_f32_16x16x32_bf16 v[144:147], v[136:139], v[128:131], 0
  s_nop 0
  v_permlane32_swap_b32 v124, v125
  v_mov_b32 v149, v148
  v_add_f32 v124, v124, v125
  s_nop 0
  v_permlane16_swap_b32 v148, v149
  v_rcp_f32 v124, v124
  v_add_f32 v148, v148, v149
  s_add_u32 s63, s64, 4096
  buffer_load_dwordx4 a[240:243], v3, s[4:7], s63 offen offset:0
  v_mul_f32 v116, v116, v124
  v_mov_b32 v149, v148
  v_mul_f32 v117, v117, v124
  s_nop 0
  v_permlane32_swap_b32 v148, v149
  v_mul_f32 v118, v118, v124
  v_add_f32 v148, v148, v149
  v_mul_f32 v119, v119, v124
  v_rcp_f32 v148, v148
  v_mul_f32 v120, v120, v124
  v_mul_f32 v140, v140, v148
  s_add_u32 s63, s65, 4096
  buffer_load_dwordx4 a[244:247], v3, s[4:7], s63 offen offset:0
  v_mul_f32 v121, v121, v124
  v_mul_f32 v141, v141, v148
  v_mul_f32 v122, v122, v124
  v_mul_f32 v142, v142, v148
  v_mul_f32 v123, v123, v124
  v_mul_f32 v143, v143, v148
  v_cvt_pk_bf16_f32 v104, v116, v117
  v_mul_f32 v144, v144, v148
  v_cvt_pk_bf16_f32 v105, v118, v119
  v_mul_f32 v145, v145, v148
  s_add_u32 s63, s66, 4096
  buffer_load_dwordx4 a[248:251], v3, s[4:7], s63 offen offset:0
  v_cvt_pk_bf16_f32 v106, v120, v121
  v_mul_f32 v146, v146, v148
  v_cvt_pk_bf16_f32 v107, v122, v123
  v_mul_f32 v147, v147, v148
  s_add_u32 s57, s71, s26
  s_add_u32 s57, s57, 61440
  s_cmp_eq_u32 s12, 1
  s_cbranch_scc1 Ldb7
  buffer_store_dwordx2 v[104:105], v10, s[4:7], s57 offen sc1
  buffer_store_dwordx2 v[106:107], v11, s[4:7], s57 offen sc1
  s_branch Lde7
Ldb7:
  buffer_store_dwordx2 v[104:105], v10, s[4:7], s57 offen
  buffer_store_dwordx2 v[106:107], v11, s[4:7], s57 offen
Lde7:
  v_cvt_pk_bf16_f32 v128, v140, v141
  v_cvt_pk_bf16_f32 v129, v142, v143
  v_cvt_pk_bf16_f32 v130, v144, v145
  v_cvt_pk_bf16_f32 v131, v146, v147
  s_add_u32 s57, s71, s26
  s_add_u32 s57, s57, 20480
  s_cmp_eq_u32 s12, 1
  s_cbranch_scc1 Ldb8
  buffer_store_dwordx2 v[128:129], v10, s[4:7], s57 offen sc1
  buffer_store_dwordx2 v[130:131], v11, s[4:7], s57 offen sc1
  s_branch Lde8
Ldb8:
  buffer_store_dwordx2 v[128:129], v10, s[4:7], s57 offen
  buffer_store_dwordx2 v[130:131], v11, s[4:7], s57 offen
Lde8:
  s_add_u32 s63, s67, 4096
  buffer_load_dwordx4 a[252:255], v3, s[4:7], s63 offen offset:0
  s_add_u32 s62, s100, s28
  s_add_u32 s62, s62, 2048
  buffer_load_dword v84, v5, s[4:7], s62 offen sc1
  s_add_u32 s63, s68, 4096
  buffer_load_dwordx4 a[120:123], v3, s[4:7], s63 offen offset:0
  v_lshlrev_b32 v81, 16, v75
  v_accvgpr_write_b32 a6, v81
  v_and_b32 v82, 0xffff0000, v75
  v_accvgpr_write_b32 a7, v82
  v_lshlrev_b32 v79, 16, v76
  v_accvgpr_write_b32 a16, v79
  v_and_b32 v80, 0xffff0000, v76
  v_accvgpr_write_b32 a17, v80
  v_lshlrev_b32 v81, 16, v77
  v_accvgpr_write_b32 a18, v81
  v_and_b32 v82, 0xffff0000, v77
  v_accvgpr_write_b32 a19, v82
  ds_read_b128 v[72:75], v0 offset:8192
  v_add_u32 v78, s44, v0
  ds_read_b64 v[76:77], v78 offset:9216
  s_waitcnt lgkmcnt(0)
  s_add_u32 s60, s43, -1
  v_and_b32 v76, s60, v76
  v_and_b32 v77, s60, v77
  v_lshlrev_b32 v79, 16, v72
  v_accvgpr_write_b32 a40, v79
  v_and_b32 v80, 0xffff0000, v72
  v_accvgpr_write_b32 a41, v80
  v_lshlrev_b32 v81, 16, v73
  v_accvgpr_write_b32 a42, v81
  v_and_b32 v82, 0xffff0000, v73
  v_accvgpr_write_b32 a43, v82
  v_lshlrev_b32 v79, 16, v74
  v_accvgpr_write_b32 a44, v79
  v_and_b32 v80, 0xffff0000, v74
  v_accvgpr_write_b32 a45, v80
  v_lshlrev_b32 v81, 16, v75
  v_accvgpr_write_b32 a46, v81
  v_and_b32 v82, 0xffff0000, v75
  v_accvgpr_write_b32 a47, v82
  v_lshlrev_b32 v79, 16, v76
  v_accvgpr_write_b32 a56, v79
  v_and_b32 v80, 0xffff0000, v76
  v_accvgpr_write_b32 a57, v80
  v_lshlrev_b32 v81, 16, v77
  v_accvgpr_write_b32 a58, v81
  v_and_b32 v82, 0xffff0000, v77
  v_accvgpr_write_b32 a59, v82
  s_add_u32 s63, s32, 12288
  buffer_load_dwordx4 v[148:151], v3, s[4:7], s63 offen offset:1024
  s_add_u32 s63, s32, 32768
  buffer_load_dwordx4 v[144:147], v3, s[4:7], s63 offen offset:1024
  s_add_u32 s63, s32, 12288
  buffer_load_dwordx4 v[140:143], v3, s[4:7], s63 offen offset:2048
  s_add_u32 s63, s32, 32768
  buffer_load_dwordx4 v[136:139], v3, s[4:7], s63 offen offset:2048
  s_cmp_lg_u32 s20, 0
  s_cbranch_scc1 Lpd9
  s_waitcnt vmcnt(5)
  v_cmp_ne_u32 vcc, 1, v84
  s_cbranch_vccz Lpd9
  s_add_u32 s62, s100, s28
  s_add_u32 s62, s62, 2048
  s_mov_b32 s61, 0
Lp9:
  buffer_load_dword v84, v5, s[4:7], s62 offen sc1
  s_add_u32 s61, s61, 1
  s_cmp_gt_u32 s61, 0x100000
  s_cbranch_scc1 Lpd9
  s_waitcnt vmcnt(0)
  v_cmp_ne_u32 vcc, 1, v84
  s_cbranch_vccnz Lp9
Lpd9:
  s_waitcnt vmcnt(7)
  s_barrier
  s_cmp_lg_u32 s20, 0
  s_cbranch_scc1 Lf10
  s_add_u32 s62, s100, s28
  s_add_u32 s62, s62, 3072
  s_lshl_b32 s61, s22, 2
  s_add_u32 s62, s62, s61
  s_mov_b64 exec, 1
  s_cmp_eq_u32 s12, 1
  s_cbranch_scc1 Ldb11
  buffer_store_dword v86, v87, s[4:7], s62 offen sc1
  s_branch Lde11
Ldb11:
  buffer_store_dword v86, v87, s[4:7], s62 offen
Lde11:
  s_mov_b64 exec, -1
Lf10:
  buffer_load_dwordx4 a[80:83], v3, s[4:7], s96 offen offset:0 sc1
  buffer_load_dwordx4 a[84:87], v3, s[4:7], s97 offen offset:0 sc1
  buffer_load_dwordx4 a[88:91], v3, s[4:7], s96 offen offset:1024 sc1
  buffer_load_dwordx4 a[92:95], v3, s[4:7], s97 offen offset:1024 sc1
  buffer_load_dwordx4 a[96:99], v3, s[4:7], s96 offen offset:2048 sc1
  buffer_load_dwordx4 a[100:103], v3, s[4:7], s97 offen offset:2048 sc1
  buffer_load_dwordx4 a[104:107], v3, s[4:7], s96 offen offset:3072 sc1
  buffer_load_dwordx4 a[108:111], v3, s[4:7], s97 offen offset:3072 sc1
  s_add_u32 s96, s96, 4096
  buffer_load_dwordx4 a[112:115], v3, s[4:7], s96 offen offset:0 sc1
  s_add_u32 s97, s97, 4096
  buffer_load_dwordx4 a[116:119], v3, s[4:7], s97 offen offset:0 sc1
  s_load_dwordx2 s[52:53], s[0:1], 40
  s_load_dwordx2 s[54:55], s[0:1], 56
  s_waitcnt lgkmcnt(0)
  s_mov_b32 s56, s52
  s_and_b32 s57, s53, 0xffff
  s_mov_b32 s58, 0xd80
  s_mov_b32 s59, 0x00020000
  s_lshl_b32 s60, s33, 6
  buffer_load_dwordx4 v[72:75], v13, s[56:59], s60 offen
  s_mov_b32 s56, s54
  s_and_b32 s57, s55, 0xffff
  s_mov_b32 s58, 0x500
  s_mov_b32 s59, 0x00020000
  s_lshl_b32 s60, s41, 6
  buffer_load_dwordx4 v[76:79], v13, s[56:59], s60 offen
  s_lshl_b32 s60, s42, 6
  s_add_u32 s60, s60, s44
  s_cmp_eq_u32 s43, 1
  s_cselect_b32 s60, 0x7ff00000, s60
  buffer_load_dwordx2 v[80:81], v13, s[56:59], s60 offen
  s_add_u32 s63, s32, 12288
  buffer_load_dwordx4 v[132:135], v3, s[4:7], s63 offen offset:3072
  s_add_u32 s63, s32, 32768
  buffer_load_dwordx4 v[128:131], v3, s[4:7], s63 offen offset:3072
  s_add_u32 s63, s32, 16384
  buffer_load_dwordx4 v[124:127], v3, s[4:7], s63 offen offset:0
  s_add_u32 s63, s32, 36864
  buffer_load_dwordx4 v[120:123], v3, s[4:7], s63 offen offset:0
  s_add_u32 s63, s32, 16384
  buffer_load_dwordx4 v[116:119], v3, s[4:7], s63 offen offset:1024
  s_add_u32 s63, s32, 36864
  buffer_load_dwordx4 v[112:115], v3, s[4:7], s63 offen offset:1024
  s_waitcnt vmcnt(17)
  v_mfma_f32_16x16x32_bf16 a[0:3], a[160:163], a[80:83], a[0:3]
  s_add_u32 s63, s32, 16384
  v_mfma_f32_16x16x32_bf16 a[4:7], a[164:167], a[80:83], a[4:7]
  v_mfma_f32_16x16x32_bf16 a[8:11], a[168:171], a[80:83], 0
  v_mfma_f32_16x16x32_bf16 a[12:15], a[172:175], a[80:83], 0
  buffer_load_dwordx4 v[108:111], v3, s[4:7], s63 offen offset:2048
  v_mfma_f32_16x16x32_bf16 a[16:19], a[176:179], a[80:83], a[16:19]
  s_add_u32 s63, s32, 36864
  v_mfma_f32_16x16x32_bf16 a[20:23], a[160:163], a[84:87], 0
  v_mfma_f32_16x16x32_bf16 a[24:27], a[164:167], a[84:87], 0
  v_mfma_f32_16x16x32_bf16 a[28:31], a[168:171], a[84:87], 0
  buffer_load_dwordx4 v[104:107], v3, s[4:7], s63 offen offset:2048
  v_mfma_f32_16x16x32_bf16 a[32:35], a[172:175], a[84:87], 0
  s_add_u32 s63, s32, 16384
  v_mfma_f32_16x16x32_bf16 a[36:39], a[176:179], a[84:87], 0
  s_waitcnt vmcnt(17)
  v_mfma_f32_16x16x32_bf16 a[0:3], a[180:183], a[88:91], a[0:3]
  v_mfma_f32_16x16x32_bf16 a[4:7], a[184:187], a[88:91], a[4:7]
  buffer_load_dwordx4 v[100:103], v3, s[4:7], s63 offen offset:3072
  v_mfma_f32_16x16x32_bf16 a[8:11], a[188:191], a[88:91], a[8:11]
  s_add_u32 s63, s32, 36864
  v_mfma_f32_16x16x32_bf16 a[12:15], a[192:195], a[88:91], a[12:15]
  v_mfma_f32_16x16x32_bf16 a[16:19], a[196:199], a[88:91], a[16:19]
  v_mfma_f32_16x16x32_bf16 a[20:23], a[180:183], a[92:95], a[20:23]
  buffer_load_dwordx4 v[96:99], v3, s[4:7], s63 offen offset:3072
  v_mfma_f32_16x16x32_bf16 a[24:27], a[184:187], a[92:95], a[24:27]
  v_mfma_f32_16x16x32_bf16 a[28:31], a[188:191], a[92:95], a[28:31]
  v_mfma_f32_16x16x32_bf16 a[32:35], a[192:195], a[92:95], a[32:35]
  v_mfma_f32_16x16x32_bf16 a[36:39], a[196:199], a[92:95], a[36:39]
  s_add_u32 s62, s100, s28
  s_add_u32 s62, s62, 3072
  buffer_load_dword v84, v5, s[4:7], s62 offen sc1
  s_waitcnt vmcnt(18)
  v_mfma_f32_16x16x32_bf16 a[0:3], a[200:203], a[96:99], a[0:3]
  v_mfma_f32_16x16x32_bf16 a[4:7], a[204:207], a[96:99], a[4:7]
  v_mfma_f32_16x16x32_bf16 a[8:11], a[208:211], a[96:99], a[8:11]
  v_mfma_f32_16x16x32_bf16 a[12:15], a[212:215], a[96:99], a[12:15]
  v_mfma_f32_16x16x32_bf16 a[16:19], a[216:219], a[96:99], a[16:19]
  v_mfma_f32_16x16x32_bf16 a[20:23], a[200:203], a[100:103], a[20:23]
  v_mfma_f32_16x16x32_bf16 a[24:27], a[204:207], a[100:103], a[24:27]
  v_mfma_f32_16x16x32_bf16 a[28:31], a[208:211], a[100:103], a[28:31]
  v_mfma_f32_16x16x32_bf16 a[32:35], a[212:215], a[100:103], a[32:35]
  v_mfma_f32_16x16x32_bf16 a[36:39], a[216:219], a[100:103], a[36:39]
  s_waitcnt vmcnt(16)
  v_mfma_f32_16x16x32_bf16 a[0:3], a[220:223], a[104:107], a[0:3]
  v_mfma_f32_16x16x32_bf16 a[4:7], a[224:227], a[104:107], a[4:7]
  v_mfma_f32_16x16x32_bf16 a[8:11], a[228:231], a[104:107], a[8:11]
  v_mfma_f32_16x16x32_bf16 a[12:15], a[232:235], a[104:107], a[12:15]
  v_mfma_f32_16x16x32_bf16 a[16:19], a[236:239], a[104:107], a[16:19]
  v_mfma_f32_16x16x32_bf16 a[20:23], a[220:223], a[108:111], a[20:23]
  v_mfma_f32_16x16x32_bf16 a[24:27], a[224:227], a[108:111], a[24:27]
  v_mfma_f32_16x16x32_bf16 a[28:31], a[228:231], a[108:111], a[28:31]
  v_mfma_f32_16x16x32_bf16 a[32:35], a[232:235], a[108:111], a[32:35]
  v_mfma_f32_16x16x32_bf16 a[36:39], a[236:239], a[108:111], a[36:39]
  s_waitcnt vmcnt(14)
  v_mfma_f32_16x16x32_bf16 a[0:3], a[240:243], a[112:115], a[0:3]
  v_mfma_f32_16x16x32_bf16 a[4:7], a[244:247], a[112:115], a[4:7]
  v_mfma_f32_16x16x32_bf16 a[8:11], a[248:251], a[112:115], a[8:11]
  v_mfma_f32_16x16x32_bf16 a[12:15], a[252:255], a[112:115], a[12:15]
  v_mfma_f32_16x16x32_bf16 a[16:19], a[120:123], a[112:115], a[16:19]
  v_mfma_f32_16x16x32_bf16 a[20:23], a[240:243], a[116:119], a[20:23]
  v_mfma_f32_16x16x32_bf16 a[24:27], a[244:247], a[116:119], a[24:27]
  v_mfma_f32_16x16x32_bf16 a[28:31], a[248:251], a[116:119], a[28:31]
  v_mfma_f32_16x16x32_bf16 a[32:35], a[252:255], a[116:119], a[32:35]
  v_mfma_f32_16x16x32_bf16 a[36:39], a[120:123], a[116:119], a[36:39]
  s_nop 3
  ds_write_b128 v16, a[20:23] offset:0
  ds_write_b128 v16, a[24:27] offset:1024
  ds_write_b128 v17, a[8:11] offset:0
  ds_write_b128 v17, a[12:15] offset:1024
  ds_write_b128 v18, a[28:31] offset:0
  ds_write_b128 v18, a[32:35] offset:1024
  ds_write_b128 v17, a[16:19] offset:2048
  ds_write_b128 v19, a[36:39] offset:2048
  s_cmp_lg_u32 s20, 0
  s_cbranch_scc1 Lpd12
  s_waitcnt vmcnt(0)
  v_cmp_ne_u32 vcc, 1, v84
  s_cbranch_vccz Lpd12
  s_add_u32 s62, s100, s28
  s_add_u32 s62, s62, 3072
  s_mov_b32 s61, 0
Lp12:
  buffer_load_dword v84, v5, s[4:7], s62 offen sc1
  s_add_u32 s61, s61, 1
  s_cmp_gt_u32 s61, 0x100000
  s_cbranch_scc1 Lpd12
  s_waitcnt vmcnt(0)
  v_cmp_ne_u32 vcc, 1, v84
  s_cbranch_vccnz Lp12
Lpd12:
  s_waitcnt lgkmcnt(0)
  s_barrier
  buffer_load_dwordx4 a[80:83], v3, s[4:7], s98 offen offset:0 sc1
  buffer_load_dwordx4 a[84:87], v3, s[4:7], s99 offen offset:0 sc1
  buffer_load_dwordx4 a[88:91], v3, s[4:7], s98 offen offset:1024 sc1
  buffer_load_dwordx4 a[92:95], v3, s[4:7], s99 offen offset:1024 sc1
  buffer_load_dwordx4 a[96:99], v3, s[4:7], s98 offen offset:2048 sc1
  buffer_load_dwordx4 a[100:103], v3, s[4:7], s99 offen offset:2048 sc1
  buffer_load_dwordx4 a[104:107], v3, s[4:7], s98 offen offset:3072 sc1
  buffer_load_dwordx4 a[108:111], v3, s[4:7], s99 offen offset:3072 sc1
  s_add_u32 s98, s98, 4096
  buffer_load_dwordx4 a[112:115], v3, s[4:7], s98 offen offset:0 sc1
  s_add_u32 s99, s99, 4096
  buffer_load_dwordx4 a[116:119], v3, s[4:7], s99 offen offset:0 sc1
  ds_read_b128 v[36:39], v20 offset:0
  ds_read_b128 v[40:43], v20 offset:1024
  ds_read_b128 v[44:47], v20 offset:2048
  ds_read_b128 v[48:51], v20 offset:3072
  ds_read_b128 v[52:55], v20 offset:4096
  ds_read_b128 v[56:59], v20 offset:5120
  v_accvgpr_read_b32 v24, a0
  v_accvgpr_read_b32 v25, a1
  v_accvgpr_read_b32 v26, a2
  v_accvgpr_read_b32 v27, a3
  v_accvgpr_read_b32 v28, a4
  v_accvgpr_read_b32 v29, a5
  v_accvgpr_read_b32 v30, a6
  v_accvgpr_read_b32 v31, a7
  v_accvgpr_read_b32 v32, a16
  v_accvgpr_read_b32 v33, a17
  v_accvgpr_read_b32 v34, a18
  v_accvgpr_read_b32 v35, a19
  v_mov_b32 v68, 0x3f803f80
  v_mov_b32 v66, 0
  v_mov_b32 v67, 0
  s_waitcnt lgkmcnt(3)
  v_pk_add_f32 v[24:25], v[24:25], v[36:37]
  v_pk_add_f32 v[26:27], v[26:27], v[38:39]
  v_pk_add_f32 v[28:29], v[28:29], v[40:41]
  v_pk_add_f32 v[30:31], v[30:31], v[42:43]
  v_pk_add_f32 v[32:33], v[32:33], v[44:45]
  v_pk_add_f32 v[34:35], v[34:35], v[46:47]
  ds_read_b128 v[36:39], v20 offset:6144
  ds_read_b128 v[40:43], v20 offset:7168
  ds_read_b128 v[44:47], v20 offset:8192
  s_waitcnt lgkmcnt(3)
  v_pk_add_f32 v[24:25], v[24:25], v[48:49]
  v_pk_add_f32 v[26:27], v[26:27], v[50:51]
  v_pk_add_f32 v[28:29], v[28:29], v[52:53]
  v_pk_add_f32 v[30:31], v[30:31], v[54:55]
  v_pk_add_f32 v[32:33], v[32:33], v[56:57]
  v_pk_add_f32 v[34:35], v[34:35], v[58:59]
  s_waitcnt lgkmcnt(0)
  v_pk_add_f32 v[24:25], v[24:25], v[36:37]
  v_pk_add_f32 v[26:27], v[26:27], v[38:39]
  v_pk_add_f32 v[28:29], v[28:29], v[40:41]
  v_pk_add_f32 v[30:31], v[30:31], v[42:43]
  v_pk_add_f32 v[32:33], v[32:33], v[44:45]
  v_pk_add_f32 v[34:35], v[34:35], v[46:47]
  v_cvt_pk_bf16_f32 v60, v24, v25
  v_cvt_pk_bf16_f32 v61, v26, v27
  v_cvt_pk_bf16_f32 v62, v28, v29
  v_cvt_pk_bf16_f32 v63, v30, v31
  v_cvt_pk_bf16_f32 v64, v32, v33
  v_cvt_pk_bf16_f32 v65, v34, v35
  s_add_u32 s60, s43, -1
  v_and_b32 v64, s60, v64
  v_and_b32 v65, s60, v65
  s_lshl_b32 s59, s34, 1
  s_add_u32 s59, s59, s45
  s_add_u32 s59, s59, s29
  s_add_u32 s59, s59, 4
  s_mul_i32 s60, s59, 20480
  s_add_u32 s60, s60, s8
  s_add_u32 s60, s60, 8388608
  s_lshl_b32 s59, s41, 10
  s_add_u32 s59, s59, s60
  s_lshl_b32 s58, s42, 10
  s_add_u32 s58, s58, s60
  s_add_u32 s58, s58, s44
  s_cmp_eq_u32 s43, 1
  s_cselect_b32 s58, 0x7ff00000, s58
  s_cmp_eq_u32 s12, 1
  s_cbranch_scc1 Ldb14
  buffer_store_dwordx4 v[60:63], v3, s[4:7], s59 offen sc1
  buffer_store_dwordx2 v[64:65], v3, s[4:7], s58 offen sc1
  s_branch Lde14
Ldb14:
  buffer_store_dwordx4 v[60:63], v3, s[4:7], s59 offen
  buffer_store_dwordx2 v[64:65], v3, s[4:7], s58 offen
Lde14:
  v_dot2c_f32_bf16 v66, v60, v68
  v_dot2c_f32_bf16 v67, v60, v60
  v_dot2c_f32_bf16 v66, v61, v68
  v_dot2c_f32_bf16 v67, v61, v61
  v_dot2c_f32_bf16 v66, v62, v68
  v_dot2c_f32_bf16 v67, v62, v62
  v_dot2c_f32_bf16 v66, v63, v68
  v_dot2c_f32_bf16 v67, v63, v63
  v_dot2c_f32_bf16 v66, v64, v68
  v_dot2c_f32_bf16 v67, v64, v64
  v_dot2c_f32_bf16 v66, v65, v68
  v_dot2c_f32_bf16 v67, v65, v65
  s_nop 1
  v_mov_b32 v68, v66
  v_mov_b32 v69, v67
  s_nop 0
  v_permlane16_swap_b32 v66, v68
  v_permlane16_swap_b32 v67, v69
  v_add_f32 v66, v66, v68
  v_add_f32 v67, v67, v69
  v_mov_b32 v68, v66
  v_mov_b32 v69, v67
  s_nop 0
  v_permlane32_swap_b32 v66, v68
  v_permlane32_swap_b32 v67, v69
  v_add_f32 v66, v66, v68
  v_add_f32 v67, v67, v69
  s_lshl_b32 s59, s34, 1
  s_add_u32 s59, s59, s45
  s_add_u32 s59, s59, s29
  s_add_u32 s59, s59, 4
  s_lshl_b32 s59, s59, 11
  s_lshl_b32 s60, s35, 4
  s_add_u32 s59, s59, s60
  s_lshl_b32 s60, s43, 3
  s_add_u32 s59, s59, s60
  s_add_u32 s59, s59, s10
  s_add_u32 s59, s59, 39845888
  s_mov_b64 exec, 0xffff
  s_cmp_eq_u32 s12, 1
  s_cbranch_scc1 Ldb15
  buffer_store_dwordx2 v[66:67], v21, s[4:7], s59 offen sc1
  s_branch Lde15
Ldb15:
  buffer_store_dwordx2 v[66:67], v21, s[4:7], s59 offen
Lde15:
  s_mov_b64 exec, -1
  ds_write_b128 v0, v[60:63] offset:0
  v_add_u32 v68, s44, v0
  ds_write_b64 v68, v[64:65] offset:1024
  s_waitcnt vmcnt(11)
  v_mfma_f32_16x16x32_bf16 a[40:43], a[160:163], a[80:83], a[40:43]
  v_mfma_f32_16x16x32_bf16 a[44:47], a[164:167], a[80:83], a[44:47]
  v_mfma_f32_16x16x32_bf16 a[48:51], a[168:171], a[80:83], 0
  v_mfma_f32_16x16x32_bf16 a[52:55], a[172:175], a[80:83], 0
  v_mfma_f32_16x16x32_bf16 a[56:59], a[176:179], a[80:83], a[56:59]
  v_mfma_f32_16x16x32_bf16 a[60:63], a[160:163], a[84:87], 0
  v_mfma_f32_16x16x32_bf16 a[64:67], a[164:167], a[84:87], 0
  v_mfma_f32_16x16x32_bf16 a[68:71], a[168:171], a[84:87], 0
  v_mfma_f32_16x16x32_bf16 a[72:75], a[172:175], a[84:87], 0
  v_mfma_f32_16x16x32_bf16 a[76:79], a[176:179], a[84:87], 0
  s_waitcnt vmcnt(9)
  v_mfma_f32_16x16x32_bf16 a[40:43], a[180:183], a[88:91], a[40:43]
  v_mfma_f32_16x16x32_bf16 a[44:47], a[184:187], a[88:91], a[44:47]
  v_mfma_f32_16x16x32_bf16 a[48:51], a[188:191], a[88:91], a[48:51]
  v_mfma_f32_16x16x32_bf16 a[52:55], a[192:195], a[88:91], a[52:55]
  v_mfma_f32_16x16x32_bf16 a[56:59], a[196:199], a[88:91], a[56:59]
  v_mfma_f32_16x16x32_bf16 a[60:63], a[180:183], a[92:95], a[60:63]
  v_mfma_f32_16x16x32_bf16 a[64:67], a[184:187], a[92:95], a[64:67]
  v_mfma_f32_16x16x32_bf16 a[68:71], a[188:191], a[92:95], a[68:71]
  v_mfma_f32_16x16x32_bf16 a[72:75], a[192:195], a[92:95], a[72:75]
  v_mfma_f32_16x16x32_bf16 a[76:79], a[196:199], a[92:95], a[76:79]
  s_waitcnt vmcnt(0)
  s_barrier
  s_cmp_lg_u32 s20, 0
  s_cbranch_scc1 Lf16
  s_add_u32 s62, s100, s28
  s_add_u32 s62, s62, 4096
  s_lshl_b32 s61, s22, 2
  s_add_u32 s62, s62, s61
  s_mov_b64 exec, 1
  s_cmp_eq_u32 s12, 1
  s_cbranch_scc1 Ldb17
  buffer_store_dword v86, v87, s[4:7], s62 offen sc1
  s_branch Lde17
Ldb17:
  buffer_store_dword v86, v87, s[4:7], s62 offen
Lde17:
  s_mov_b64 exec, -1
Lf16:
  v_mfma_f32_16x16x32_bf16 a[40:43], a[200:203], a[96:99], a[40:43]
  v_mfma_f32_16x16x32_bf16 a[44:47], a[204:207], a[96:99], a[44:47]
  v_mfma_f32_16x16x32_bf16 a[48:51], a[208:211], a[96:99], a[48:51]
  v_mfma_f32_16x16x32_bf16 a[52:55], a[212:215], a[96:99], a[52:55]
  v_mfma_f32_16x16x32_bf16 a[56:59], a[216:219], a[96:99], a[56:59]
  v_mfma_f32_16x16x32_bf16 a[60:63], a[200:203], a[100:103], a[60:63]
  v_mfma_f32_16x16x32_bf16 a[64:67], a[204:207], a[100:103], a[64:67]
  v_mfma_f32_16x16x32_bf16 a[68:71], a[208:211], a[100:103], a[68:71]
  v_mfma_f32_16x16x32_bf16 a[72:75], a[212:215], a[100:103], a[72:75]
  v_mfma_f32_16x16x32_bf16 a[76:79], a[216:219], a[100:103], a[76:79]
  v_mfma_f32_16x16x32_bf16 a[40:43], a[220:223], a[104:107], a[40:43]
  v_mfma_f32_16x16x32_bf16 a[44:47], a[224:227], a[104:107], a[44:47]
  v_mfma_f32_16x16x32_bf16 a[48:51], a[228:231], a[104:107], a[48:51]
  v_mfma_f32_16x16x32_bf16 a[52:55], a[232:235], a[104:107], a[52:55]
  v_mfma_f32_16x16x32_bf16 a[56:59], a[236:239], a[104:107], a[56:59]
  v_mfma_f32_16x16x32_bf16 a[60:63], a[220:223], a[108:111], a[60:63]
  v_mfma_f32_16x16x32_bf16 a[64:67], a[224:227], a[108:111], a[64:67]
  v_mfma_f32_16x16x32_bf16 a[68:71], a[228:231], a[108:111], a[68:71]
  v_mfma_f32_16x16x32_bf16 a[72:75], a[232:235], a[108:111], a[72:75]
  v_mfma_f32_16x16x32_bf16 a[76:79], a[236:239], a[108:111], a[76:79]
  v_mfma_f32_16x16x32_bf16 a[40:43], a[240:243], a[112:115], a[40:43]
  v_mfma_f32_16x16x32_bf16 a[44:47], a[244:247], a[112:115], a[44:47]
  v_mfma_f32_16x16x32_bf16 a[48:51], a[248:251], a[112:115], a[48:51]
  v_mfma_f32_16x16x32_bf16 a[52:55], a[252:255], a[112:115], a[52:55]
  v_mfma_f32_16x16x32_bf16 a[56:59], a[120:123], a[112:115], a[56:59]
  v_mfma_f32_16x16x32_bf16 a[60:63], a[240:243], a[116:119], a[60:63]
  v_mfma_f32_16x16x32_bf16 a[64:67], a[244:247], a[116:119], a[64:67]
  v_mfma_f32_16x16x32_bf16 a[68:71], a[248:251], a[116:119], a[68:71]
  v_mfma_f32_16x16x32_bf16 a[72:75], a[252:255], a[116:119], a[72:75]
  v_mfma_f32_16x16x32_bf16 a[76:79], a[120:123], a[116:119], a[76:79]
  s_nop 3
  ds_write_b128 v16, a[60:63] offset:0
  ds_write_b128 v16, a[64:67] offset:1024
  ds_write_b128 v17, a[48:51] offset:0
  ds_write_b128 v17, a[52:55] offset:1024
  ds_write_b128 v18, a[68:71] offset:0
  ds_write_b128 v18, a[72:75] offset:1024
  ds_write_b128 v17, a[56:59] offset:2048
  ds_write_b128 v19, a[76:79] offset:2048
  s_waitcnt lgkmcnt(0)
  s_barrier
  ds_read_b128 v[36:39], v20 offset:0
  ds_read_b128 v[40:43], v20 offset:1024
  ds_read_b128 v[44:47], v20 offset:2048
  ds_read_b128 v[48:51], v20 offset:3072
  ds_read_b128 v[52:55], v20 offset:4096
  ds_read_b128 v[56:59], v20 offset:5120
  v_accvgpr_read_b32 v24, a40
  v_accvgpr_read_b32 v25, a41
  v_accvgpr_read_b32 v26, a42
  v_accvgpr_read_b32 v27, a43
  v_accvgpr_read_b32 v28, a44
  v_accvgpr_read_b32 v29, a45
  v_accvgpr_read_b32 v30, a46
  v_accvgpr_read_b32 v31, a47
  v_accvgpr_read_b32 v32, a56
  v_accvgpr_read_b32 v33, a57
  v_accvgpr_read_b32 v34, a58
  v_accvgpr_read_b32 v35, a59
  v_mov_b32 v68, 0x3f803f80
  v_mov_b32 v66, 0
  v_mov_b32 v67, 0
  s_waitcnt lgkmcnt(3)
  v_pk_add_f32 v[24:25], v[24:25], v[36:37]
  v_pk_add_f32 v[26:27], v[26:27], v[38:39]
  v_pk_add_f32 v[28:29], v[28:29], v[40:41]
  v_pk_add_f32 v[30:31], v[30:31], v[42:43]
  v_pk_add_f32 v[32:33], v[32:33], v[44:45]
  v_pk_add_f32 v[34:35], v[34:35], v[46:47]
  ds_read_b128 v[36:39], v20 offset:6144
  ds_read_b128 v[40:43], v20 offset:7168
  s_add_u32 s62, s100, s28
  s_add_u32 s62, s62, 4096
  buffer_load_dword v84, v5, s[4:7], s62 offen sc1
  ds_read_b128 v[44:47], v20 offset:8192
  s_waitcnt lgkmcnt(3)
  v_pk_add_f32 v[24:25], v[24:25], v[48:49]
  v_pk_add_f32 v[26:27], v[26:27], v[50:51]
  v_pk_add_f32 v[28:29], v[28:29], v[52:53]
  v_pk_add_f32 v[30:31], v[30:31], v[54:55]
  v_pk_add_f32 v[32:33], v[32:33], v[56:57]
  v_pk_add_f32 v[34:35], v[34:35], v[58:59]
  s_waitcnt lgkmcnt(0)
  v_pk_add_f32 v[24:25], v[24:25], v[36:37]
  v_pk_add_f32 v[26:27], v[26:27], v[38:39]
  v_pk_add_f32 v[28:29], v[28:29], v[40:41]
  v_pk_add_f32 v[30:31], v[30:31], v[42:43]
  v_pk_add_f32 v[32:33], v[32:33], v[44:45]
  v_pk_add_f32 v[34:35], v[34:35], v[46:47]
  v_cvt_pk_bf16_f32 v60, v24, v25
  v_cvt_pk_bf16_f32 v61, v26, v27
  v_cvt_pk_bf16_f32 v62, v28, v29
  v_cvt_pk_bf16_f32 v63, v30, v31
  v_cvt_pk_bf16_f32 v64, v32, v33
  v_cvt_pk_bf16_f32 v65, v34, v35
  s_add_u32 s60, s43, -1
  v_and_b32 v64, s60, v64
  v_and_b32 v65, s60, v65
  s_lshl_b32 s59, s34, 1
  s_add_u32 s59, s59, s45
  s_add_u32 s59, s59, s29
  s_mul_i32 s60, s59, 20480
  s_add_u32 s60, s60, s8
  s_add_u32 s60, s60, 8388608
  s_lshl_b32 s59, s41, 10
  s_add_u32 s59, s59, s60
  s_lshl_b32 s58, s42, 10
  s_add_u32 s58, s58, s60
  s_add_u32 s58, s58, s44
  s_cmp_eq_u32 s43, 1
  s_cselect_b32 s58, 0x7ff00000, s58
  s_cmp_eq_u32 s12, 1
  s_cbranch_scc1 Ldb19
  buffer_store_dwordx4 v[60:63], v3, s[4:7], s59 offen sc1
  buffer_store_dwordx2 v[64:65], v3, s[4:7], s58 offen sc1
  s_branch Lde19
Ldb19:
  buffer_store_dwordx4 v[60:63], v3, s[4:7], s59 offen
  buffer_store_dwordx2 v[64:65], v3, s[4:7], s58 offen
Lde19:
  v_dot2c_f32_bf16 v66, v60, v68
  v_dot2c_f32_bf16 v67, v60, v60
  v_dot2c_f32_bf16 v66, v61, v68
  v_dot2c_f32_bf16 v67, v61, v61
  v_dot2c_f32_bf16 v66, v62, v68
  v_dot2c_f32_bf16 v67, v62, v62
  v_dot2c_f32_bf16 v66, v63, v68
  v_dot2c_f32_bf16 v67, v63, v63
  v_dot2c_f32_bf16 v66, v64, v68
  v_dot2c_f32_bf16 v67, v64, v64
  v_dot2c_f32_bf16 v66, v65, v68
  v_dot2c_f32_bf16 v67, v65, v65
  s_nop 1
  v_mov_b32 v68, v66
  v_mov_b32 v69, v67
  s_nop 0
  v_permlane16_swap_b32 v66, v68
  v_permlane16_swap_b32 v67, v69
  v_add_f32 v66, v66, v68
  v_add_f32 v67, v67, v69
  v_mov_b32 v68, v66
  v_mov_b32 v69, v67
  s_nop 0
  v_permlane32_swap_b32 v66, v68
  v_permlane32_swap_b32 v67, v69
  v_add_f32 v66, v66, v68
  v_add_f32 v67, v67, v69
  s_lshl_b32 s59, s34, 1
  s_add_u32 s59, s59, s45
  s_add_u32 s59, s59, s29
  s_lshl_b32 s59, s59, 11
  s_lshl_b32 s60, s35, 4
  s_add_u32 s59, s59, s60
  s_lshl_b32 s60, s43, 3
  s_add_u32 s59, s59, s60
  s_add_u32 s59, s59, s10
  s_add_u32 s59, s59, 39845888
  s_mov_b64 exec, 0xffff
  s_cmp_eq_u32 s12, 1
  s_cbranch_scc1 Ldb20
  buffer_store_dwordx2 v[66:67], v21, s[4:7], s59 offen sc1
  s_branch Lde20
Ldb20:
  buffer_store_dwordx2 v[66:67], v21, s[4:7], s59 offen
Lde20:
  s_mov_b64 exec, -1
  ds_write_b128 v0, v[60:63] offset:8192
  v_add_u32 v68, s44, v0
  ds_write_b64 v68, v[64:65] offset:9216
  v_lshlrev_b32 v24, 16, v72
  v_and_b32 v25, 0xffff0000, v72
  v_lshlrev_b32 v26, 16, v73
  v_and_b32 v27, 0xffff0000, v73
  v_lshlrev_b32 v28, 16, v74
  v_and_b32 v29, 0xffff0000, v74
  v_lshlrev_b32 v30, 16, v75
  v_and_b32 v31, 0xffff0000, v75
  ds_write_b128 v1, v[24:27] offset:256
  ds_write_b128 v1, v[28:31] offset:272
  v_lshlrev_b32 v32, 16, v76
  v_and_b32 v33, 0xffff0000, v76
  v_lshlrev_b32 v34, 16, v77
  v_and_b32 v35, 0xffff0000, v77
  v_lshlrev_b32 v36, 16, v78
  v_and_b32 v37, 0xffff0000, v78
  v_lshlrev_b32 v38, 16, v79
  v_and_b32 v39, 0xffff0000, v79
  v_lshlrev_b32 v40, 16, v80
  v_and_b32 v41, 0xffff0000, v80
  v_lshlrev_b32 v42, 16, v81
  v_and_b32 v43, 0xffff0000, v81
  v_lshl_add_u32 v44, v13, 1, v1
  ds_write_b128 v44, v[32:35] offset:384
  ds_write_b128 v44, v[36:39] offset:400
  ds_write_b128 v44, v[40:43] offset:416
  s_mul_i32 s63, s20, 14336
  s_add_u32 s63, s63, 5767168
  s_mul_i32 s64, s36, 55296
  s_add_u32 s64, s64, s63
  s_mul_i32 s65, s37, 55296
  s_add_u32 s65, s65, s63
  s_mul_i32 s66, s38, 55296
  s_add_u32 s66, s66, s63
  s_mul_i32 s67, s39, 55296
  s_add_u32 s67, s67, s63
  s_mul_i32 s68, s40, 55296
  s_add_u32 s68, s68, s63
  buffer_load_dwordx4 a[0:3], v3, s[4:7], s64 offen offset:0
  buffer_load_dwordx4 a[4:7], v3, s[4:7], s65 offen offset:0
  buffer_load_dwordx4 a[8:11], v3, s[4:7], s66 offen offset:0
  buffer_load_dwordx4 a[12:15], v3, s[4:7], s67 offen offset:0
  buffer_load_dwordx4 a[16:19], v3, s[4:7], s68 offen offset:0
  buffer_load_dwordx4 a[20:23], v3, s[4:7], s64 offen offset:1024
  s_cmp_lg_u32 s20, 0
  s_cbranch_scc1 Lpd21
  s_waitcnt vmcnt(9)
  v_cmp_ne_u32 vcc, 1, v84
  s_cbranch_vccz Lpd21
  s_add_u32 s62, s100, s28
  s_add_u32 s62, s62, 4096
  s_mov_b32 s61, 0
Lp21:
  buffer_load_dword v84, v5, s[4:7], s62 offen sc1
  s_add_u32 s61, s61, 1
  s_cmp_gt_u32 s61, 0x100000
  s_cbranch_scc1 Lpd21
  s_waitcnt vmcnt(0)
  v_cmp_ne_u32 vcc, 1, v84
  s_cbranch_vccnz Lp21
Lpd21:
  s_waitcnt vmcnt(6)
  s_barrier
  s_cmp_lg_u32 s20, 0
  s_cbranch_scc1 Lf22
  s_add_u32 s62, s100, s28
  s_add_u32 s62, s62, 5120
  s_lshl_b32 s61, s22, 2
  s_add_u32 s62, s62, s61
  s_mov_b64 exec, 1
  s_cmp_eq_u32 s12, 1
  s_cbranch_scc1 Ldb23
  buffer_store_dword v86, v87, s[4:7], s62 offen sc1
  s_branch Lde23
Ldb23:
  buffer_store_dword v86, v87, s[4:7], s62 offen
Lde23:
  s_mov_b64 exec, -1
Lf22:
  s_sub_u32 s53, s29, s20
  s_lshl_b32 s53, s53, 11
  s_add_u32 s53, s53, s10
  s_add_u32 s53, s53, 39860224
  buffer_load_dwordx4 v[72:75], v12, s[4:7], s53 offen sc1
  buffer_load_dwordx4 v[76:79], v12, s[4:7], s53 offen offset:16 sc1
  s_add_u32 s52, s3, s8
  s_add_u32 s52, s52, 8531968
  s_add_u32 m0, s30, 0
  s_nop 0
  buffer_load_dwordx4 v3, s[4:7], s52 offen offset:0 sc1 lds
  buffer_load_dwordx4 v3, s[4:7], s52 offen offset:1024 sc1 lds
  buffer_load_dwordx4 v3, s[4:7], s52 offen offset:2048 sc1 lds
  buffer_load_dwordx4 v3, s[4:7], s52 offen offset:3072 sc1 lds
  s_add_u32 s52, s52, 4096
  s_add_u32 m0, s30, 4096
  s_nop 0
  buffer_load_dwordx4 v3, s[4:7], s52 offen offset:0 sc1 lds
  s_add_u32 s52, s3, s8
  s_add_u32 s52, s52, 8511488
  s_add_u32 m0, s30, 20480
  s_nop 0
  buffer_load_dwordx4 v3, s[4:7], s52 offen offset:0 sc1 lds
  buffer_load_dwordx4 v3, s[4:7], s52 offen offset:1024 sc1 lds
  buffer_load_dwordx4 v3, s[4:7], s52 offen offset:2048 sc1 lds
  buffer_load_dwordx4 v3, s[4:7], s52 offen offset:3072 sc1 lds
  s_add_u32 s52, s52, 4096
  s_add_u32 m0, s30, 24576
  s_nop 0
  buffer_load_dwordx4 v3, s[4:7], s52 offen offset:0 sc1 lds
  buffer_load_dwordx4 a[24:27], v3, s[4:7], s65 offen offset:1024
  buffer_load_dwordx4 a[28:31], v3, s[4:7], s66 offen offset:1024
  buffer_load_dwordx4 a[32:35], v3, s[4:7], s67 offen offset:1024
  buffer_load_dwordx4 a[36:39], v3, s[4:7], s68 offen offset:1024
  buffer_load_dwordx4 a[40:43], v3, s[4:7], s64 offen offset:2048
  buffer_load_dwordx4 a[44:47], v3, s[4:7], s65 offen offset:2048
  v_mov_b32 v64, 0x3f803f80
  v_mov_b32 v65, 0x3f803f80
  v_mov_b32 v66, 0x3f803f80
  v_mov_b32 v67, 0x3f803f80
  s_nop 1
  v_mfma_f32_16x16x32_bf16 v[56:59], v[252:255], v[64:67], 0
  v_mfma_f32_16x16x32_bf16 v[60:63], v[248:251], v[64:67], 0
  v_mfma_f32_16x16x32_bf16 v[56:59], v[244:247], v[64:67], v[56:59]
  v_mfma_f32_16x16x32_bf16 v[60:63], v[240:243], v[64:67], v[60:63]
  v_mfma_f32_16x16x32_bf16 v[56:59], v[236:239], v[64:67], v[56:59]
  v_mfma_f32_16x16x32_bf16 v[60:63], v[232:235], v[64:67], v[60:63]
  v_mfma_f32_16x16x32_bf16 v[56:59], v[228:231], v[64:67], v[56:59]
  v_mfma_f32_16x16x32_bf16 v[60:63], v[224:227], v[64:67], v[60:63]
  v_mfma_f32_16x16x32_bf16 v[56:59], v[220:223], v[64:67], v[56:59]
  v_mfma_f32_16x16x32_bf16 v[60:63], v[216:219], v[64:67], v[60:63]
  v_mfma_f32_16x16x32_bf16 v[56:59], v[212:215], v[64:67], v[56:59]
  v_mfma_f32_16x16x32_bf16 v[60:63], v[208:211], v[64:67], v[60:63]
  v_mfma_f32_16x16x32_bf16 v[56:59], v[204:207], v[64:67], v[56:59]
  v_mfma_f32_16x16x32_bf16 v[60:63], v[200:203], v[64:67], v[60:63]
  v_mfma_f32_16x16x32_bf16 v[56:59], v[196:199], v[64:67], v[56:59]
  v_mfma_f32_16x16x32_bf16 v[60:63], v[192:195], v[64:67], v[60:63]
  v_mfma_f32_16x16x32_bf16 v[56:59], v[188:191], v[64:67], v[56:59]
  v_mfma_f32_16x16x32_bf16 v[60:63], v[184:187], v[64:67], v[60:63]
  v_mfma_f32_16x16x32_bf16 v[56:59], v[180:183], v[64:67], v[56:59]
  v_mfma_f32_16x16x32_bf16 v[60:63], v[176:179], v[64:67], v[60:63]
  v_mfma_f32_16x16x32_bf16 v[56:59], v[172:175], v[64:67], v[56:59]
  v_mfma_f32_16x16x32_bf16 v[60:63], v[168:171], v[64:67], v[60:63]
  v_mfma_f32_16x16x32_bf16 v[56:59], v[164:167], v[64:67], v[56:59]
  v_mfma_f32_16x16x32_bf16 v[60:63], v[160:163], v[64:67], v[60:63]
  v_mfma_f32_16x16x32_bf16 v[56:59], v[156:159], v[64:67], v[56:59]
  v_mfma_f32_16x16x32_bf16 v[60:63], v[152:155], v[64:67], v[60:63]
  v_mfma_f32_16x16x32_bf16 v[56:59], v[148:151], v[64:67], v[56:59]
  v_mfma_f32_16x16x32_bf16 v[60:63], v[144:147], v[64:67], v[60:63]
  v_mfma_f32_16x16x32_bf16 v[56:59], v[140:143], v[64:67], v[56:59]
  v_mfma_f32_16x16x32_bf16 v[60:63], v[136:139], v[64:67], v[60:63]
  v_mfma_f32_16x16x32_bf16 v[56:59], v[132:135], v[64:67], v[56:59]
  v_mfma_f32_16x16x32_bf16 v[60:63], v[128:131], v[64:67], v[60:63]
  v_mfma_f32_16x16x32_bf16 v[56:59], v[124:127], v[64:67], v[56:59]
  v_mfma_f32_16x16x32_bf16 v[60:63], v[120:123], v[64:67], v[60:63]
  v_mfma_f32_16x16x32_bf16 v[56:59], v[116:119], v[64:67], v[56:59]
  v_mfma_f32_16x16x32_bf16 v[60:63], v[112:115], v[64:67], v[60:63]
  v_mfma_f32_16x16x32_bf16 v[56:59], v[108:111], v[64:67], v[56:59]
  v_mfma_f32_16x16x32_bf16 v[60:63], v[104:107], v[64:67], v[60:63]
  v_mfma_f32_16x16x32_bf16 v[56:59], v[100:103], v[64:67], v[56:59]
  v_mfma_f32_16x16x32_bf16 v[60:63], v[96:99], v[64:67], v[60:63]
  s_nop 6
  ds_write_b128 v1, v[56:59] offset:128
  ds_write_b128 v1, v[60:63] offset:144
  s_waitcnt vmcnt(11)
  s_barrier
  ds_read_b128 a[224:227], v3 offset:0
  ds_read_b128 a[228:231], v3 offset:1024
  ds_read_b128 a[232:235], v3 offset:2048
  ds_read_b128 a[236:239], v3 offset:3072
  ds_read_b128 a[240:243], v3 offset:4096
  ds_read_b128 a[244:247], v3 offset:5120
  ds_read_b128 a[248:251], v3 offset:6144
  s_waitcnt lgkmcnt(5)
  v_mfma_f32_16x16x32_bf16 v[24:27], v[252:255], a[224:227], 0
  s_add_u32 s52, s3, s8
  ds_read_b128 a[252:255], v3 offset:7168
  s_add_u32 s52, s52, 8491008
  s_add_u32 m0, s30, 40960
  v_mfma_f32_16x16x32_bf16 v[28:31], v[248:251], a[224:227], 0
  v_add_f32 v72, v72, v74
  v_add_f32 v73, v73, v75
  v_mfma_f32_16x16x32_bf16 v[24:27], v[244:247], a[228:231], v[24:27]
  ds_read_b128 a[224:227], v3 offset:8192
  v_add_f32 v76, v76, v78
  v_add_f32 v77, v77, v79
  v_mfma_f32_16x16x32_bf16 v[28:31], v[240:243], a[228:231], v[28:31]
  s_waitcnt lgkmcnt(5)
  buffer_load_dwordx4 v3, s[4:7], s52 offen offset:0 sc1 lds
  v_add_f32 v72, v72, v76
  v_mfma_f32_16x16x32_bf16 v[24:27], v[236:239], a[232:235], v[24:27]
  ds_read_b128 a[228:231], v3 offset:9216
  v_add_f32 v73, v73, v77
  v_mov_b32 v74, v72
  v_mfma_f32_16x16x32_bf16 v[28:31], v[232:235], a[232:235], v[28:31]
  v_mov_b32 v75, v73
  v_permlane16_swap_b32 v72, v74
  v_mfma_f32_16x16x32_bf16 v[24:27], v[228:231], a[236:239], v[24:27]
  ds_read_b128 a[232:235], v3 offset:10240
  v_permlane16_swap_b32 v73, v75
  v_add_f32 v72, v72, v74
  v_mfma_f32_16x16x32_bf16 v[28:31], v[224:227], a[236:239], v[28:31]
  s_waitcnt lgkmcnt(5)
  buffer_load_dwordx4 v3, s[4:7], s52 offen offset:1024 sc1 lds
  v_add_f32 v73, v73, v75
  v_mfma_f32_16x16x32_bf16 v[24:27], v[220:223], a[240:243], v[24:27]
  ds_read_b128 a[236:239], v3 offset:11264
  v_mov_b32 v74, v72
  v_mov_b32 v75, v73
  v_mfma_f32_16x16x32_bf16 v[28:31], v[216:219], a[240:243], v[28:31]
  v_permlane32_swap_b32 v72, v74
  v_permlane32_swap_b32 v73, v75
  v_mfma_f32_16x16x32_bf16 v[24:27], v[212:215], a[244:247], v[24:27]
  ds_read_b128 a[240:243], v3 offset:12288
  v_add_f32 v72, v72, v74
  v_add_f32 v73, v73, v75
  v_mfma_f32_16x16x32_bf16 v[28:31], v[208:211], a[244:247], v[28:31]
  s_waitcnt lgkmcnt(5)
  buffer_load_dwordx4 v3, s[4:7], s52 offen offset:2048 sc1 lds
  v_mul_f32 v72, 0x3acccccd, v72
  v_mfma_f32_16x16x32_bf16 v[24:27], v[204:207], a[248:251], v[24:27]
  ds_read_b128 a[244:247], v3 offset:13312
  v_mul_f32 v73, 0x3acccccd, v73
  v_fma_f32 v73, -v72, v72, v73
  v_mfma_f32_16x16x32_bf16 v[28:31], v[200:203], a[248:251], v[28:31]
  v_max_f32 v73, 0, v73
  v_cvt_pk_bf16_f32 v74, v72, v73
  v_mfma_f32_16x16x32_bf16 v[24:27], v[196:199], a[252:255], v[24:27]
  ds_read_b128 a[248:251], v3 offset:14336
  v_lshlrev_b32 v72, 16, v74
  v_and_b32 v73, 0xffff0000, v74
  v_mfma_f32_16x16x32_bf16 v[28:31], v[192:195], a[252:255], v[28:31]
  s_waitcnt lgkmcnt(5)
  buffer_load_dwordx4 v3, s[4:7], s52 offen offset:3072 sc1 lds
  s_add_u32 s52, s52, 4096
  v_mfma_f32_16x16x32_bf16 v[24:27], v[188:191], a[224:227], v[24:27]
  ds_read_b128 a[252:255], v3 offset:15360
  s_add_u32 m0, s30, 45056
  v_add_f32 v73, 0x3727c5ac, v73
  v_mfma_f32_16x16x32_bf16 v[28:31], v[184:187], a[224:227], v[28:31]
  v_cvt_pk_bf16_f32 v73, v73, v73
  v_lshlrev_b32 v73, 16, v73
  v_mfma_f32_16x16x32_bf16 v[24:27], v[180:183], a[228:231], v[24:27]
  ds_read_b128 a[224:227], v3 offset:16384
  v_sqrt_f32 v73, v73
  s_nop 0
  v_cvt_pk_bf16_f32 v73, v73, v73
  v_mfma_f32_16x16x32_bf16 v[28:31], v[176:179], a[228:231], v[28:31]
  s_waitcnt lgkmcnt(5)
  buffer_load_dwordx4 v3, s[4:7], s52 offen offset:0 sc1 lds
  s_add_u32 s52, s3, s8
  v_mfma_f32_16x16x32_bf16 v[24:27], v[172:175], a[232:235], v[24:27]
  ds_read_b128 a[228:231], v3 offset:17408
  s_add_u32 s52, s52, 8470528
  s_add_u32 m0, s30, 61440
  v_mfma_f32_16x16x32_bf16 v[28:31], v[168:171], a[232:235], v[28:31]
  v_lshlrev_b32 v73, 16, v73
  v_rcp_f32 v74, v73
  v_mfma_f32_16x16x32_bf16 v[24:27], v[164:167], a[236:239], v[24:27]
  ds_read_b128 a[232:235], v3 offset:18432
  s_lshl_b32 s53, s20, 7
  v_add_u32 v76, s53, v23
  v_mfma_f32_16x16x32_bf16 v[28:31], v[160:163], a[236:239], v[28:31]
  s_waitcnt lgkmcnt(5)
  buffer_load_dwordx4 v3, s[4:7], s52 offen offset:0 sc1 lds
  v_mul_f32 v75, v72, v74
  v_mfma_f32_16x16x32_bf16 v[24:27], v[156:159], a[240:243], v[24:27]
  ds_read_b128 a[236:239], v3 offset:19456
  ds_write_b64 v76, v[74:75] offset:0
  v_mfma_f32_16x16x32_bf16 v[28:31], v[152:155], a[240:243], v[28:31]
  v_mfma_f32_16x16x32_bf16 v[24:27], v[148:151], a[244:247], v[24:27]
  s_waitcnt lgkmcnt(0)
  s_waitcnt vmcnt(12)
  s_barrier
  s_add_u32 s62, s100, s28
  s_add_u32 s62, s62, 5120
  buffer_load_dword v84, v5, s[4:7], s62 offen sc1
  ds_read_b128 a[240:243], v3 offset:20480
  v_mfma_f32_16x16x32_bf16 v[28:31], v[144:147], a[244:247], v[28:31]
  buffer_load_dwordx4 v3, s[4:7], s52 offen offset:1024 sc1 lds
  v_mfma_f32_16x16x32_bf16 v[24:27], v[140:143], a[248:251], v[24:27]
  ds_read_b128 a[244:247], v3 offset:21504
  v_mfma_f32_16x16x32_bf16 v[28:31], v[136:139], a[248:251], v[28:31]
  v_mfma_f32_16x16x32_bf16 v[24:27], v[132:135], a[252:255], v[24:27]
  ds_read_b128 a[248:251], v3 offset:22528
  v_mfma_f32_16x16x32_bf16 v[28:31], v[128:131], a[252:255], v[28:31]
  buffer_load_dwordx4 v3, s[4:7], s52 offen offset:2048 sc1 lds
  v_mfma_f32_16x16x32_bf16 v[24:27], v[124:127], a[224:227], v[24:27]
  ds_read_b128 a[252:255], v3 offset:23552
  v_mfma_f32_16x16x32_bf16 v[28:31], v[120:123], a[224:227], v[28:31]
  v_mfma_f32_16x16x32_bf16 v[24:27], v[116:119], a[228:231], v[24:27]
  ds_read_b128 a[224:227], v3 offset:24576
  v_mfma_f32_16x16x32_bf16 v[28:31], v[112:115], a[228:231], v[28:31]
  buffer_load_dwordx4 v3, s[4:7], s52 offen offset:3072 sc1 lds
  s_add_u32 s52, s52, 4096
  v_mfma_f32_16x16x32_bf16 v[24:27], v[108:111], a[232:235], v[24:27]
  ds_read_b128 a[228:231], v3 offset:25600
  s_add_u32 m0, s30, 65536
  v_mfma_f32_16x16x32_bf16 v[28:31], v[104:107], a[232:235], v[28:31]
  v_mfma_f32_16x16x32_bf16 v[24:27], v[100:103], a[236:239], v[24:27]
  ds_read_b128 a[232:235], v3 offset:26624
  v_mfma_f32_16x16x32_bf16 v[28:31], v[96:99], a[236:239], v[28:31]
  s_waitcnt lgkmcnt(5)
  buffer_load_dwordx4 v3, s[4:7], s52 offen offset:0 sc1 lds
  ds_read_b128 v[40:43], v1 offset:128
  ds_read_b128 v[44:47], v1 offset:144
  ds_read_b128 v[48:51], v1 offset:256
  ds_read_b128 v[52:55], v1 offset:272
  v_mfma_f32_16x16x32_bf16 v[32:35], v[252:255], a[240:243], 0
  ds_read_b128 a[236:239], v3 offset:27648
  v_mfma_f32_16x16x32_bf16 v[36:39], v[248:251], a[240:243], 0
  v_mfma_f32_16x16x32_bf16 v[32:35], v[244:247], a[244:247], v[32:35]
  ds_read_b128 a[240:243], v3 offset:28672
  v_mfma_f32_16x16x32_bf16 v[36:39], v[240:243], a[244:247], v[36:39]
  s_waitcnt lgkmcnt(9)
  buffer_load_dwordx4 a[48:51], v3, s[4:7], s66 offen offset:2048
  v_mfma_f32_16x16x32_bf16 v[32:35], v[236:239], a[248:251], v[32:35]
  ds_read_b128 a[244:247], v3 offset:29696
  ds_read_b64 v[68:69], v23 offset:0
  v_mfma_f32_16x16x32_bf16 v[36:39], v[232:235], a[248:251], v[36:39]
  v_mfma_f32_16x16x32_bf16 v[32:35], v[228:231], a[252:255], v[32:35]
  ds_read_b128 a[248:251], v3 offset:30720
  v_mfma_f32_16x16x32_bf16 v[36:39], v[224:227], a[252:255], v[36:39]
  s_waitcnt lgkmcnt(10)
  buffer_load_dwordx4 a[52:55], v3, s[4:7], s67 offen offset:2048
  v_mfma_f32_16x16x32_bf16 v[32:35], v[220:223], a[224:227], v[32:35]
  ds_read_b128 a[252:255], v3 offset:31744
  v_mfma_f32_16x16x32_bf16 v[36:39], v[216:219], a[224:227], v[36:39]
  s_waitcnt lgkmcnt(2)
  s_add_u32 s54, s70, s27
  s_add_u32 s54, s54, 401408
  v_mfma_f32_16x16x32_bf16 v[32:35], v[212:215], a[228:231], v[32:35]
  ds_read_b128 a[224:227], v3 offset:32768
  v_fma_f32 v56, -v69, v40, v48
  v_fma_f32 v57, -v69, v41, v49
  v_mfma_f32_16x16x32_bf16 v[36:39], v[208:211], a[228:231], v[36:39]
  buffer_load_dwordx4 a[56:59], v3, s[4:7], s68 offen offset:2048
  v_fma_f32 v58, -v69, v42, v50
  v_mfma_f32_16x16x32_bf16 v[32:35], v[204:207], a[232:235], v[32:35]
  ds_read_b128 a[228:231], v3 offset:33792
  v_fma_f32 v59, -v69, v43, v51
  v_fma_f32 v60, -v69, v44, v52
  v_mfma_f32_16x16x32_bf16 v[36:39], v[200:203], a[232:235], v[36:39]
  v_fma_f32 v61, -v69, v45, v53
  v_fma_f32 v62, -v69, v46, v54
  v_mfma_f32_16x16x32_bf16 v[32:35], v[196:199], a[236:239], v[32:35]
  ds_read_b128 a[232:235], v3 offset:34816
  v_fma_f32 v63, -v69, v47, v55
  v_fma_f32 v56, v24, v68, v56
  v_mfma_f32_16x16x32_bf16 v[36:39], v[192:195], a[236:239], v[36:39]
  buffer_load_dwordx4 a[60:63], v3, s[4:7], s64 offen offset:3072
  v_fma_f32 v57, v25, v68, v57
  v_mfma_f32_16x16x32_bf16 v[32:35], v[188:191], a[240:243], v[32:35]
  ds_read_b128 a[236:239], v3 offset:35840
  v_fma_f32 v58, v26, v68, v58
  v_fma_f32 v59, v27, v68, v59
  v_mfma_f32_16x16x32_bf16 v[36:39], v[184:187], a[240:243], v[36:39]
  v_fma_f32 v60, v28, v68, v60
  v_fma_f32 v61, v29, v68, v61
  v_mfma_f32_16x16x32_bf16 v[32:35], v[180:183], a[244:247], v[32:35]
  ds_read_b128 a[240:243], v3 offset:36864
  v_fma_f32 v62, v30, v68, v62
  v_fma_f32 v63, v31, v68, v63
  v_mfma_f32_16x16x32_bf16 v[36:39], v[176:179], a[244:247], v[36:39]
  s_waitcnt lgkmcnt(5)
  buffer_load_dwordx4 a[64:67], v3, s[4:7], s65 offen offset:3072
  v_mul_f32 v56, v56, |v56|
  v_mfma_f32_16x16x32_bf16 v[32:35], v[172:175], a[248:251], v[32:35]
  ds_read_b128 a[244:247], v3 offset:37888
  v_mul_f32 v57, v57, |v57|
  v_mul_f32 v58, v58, |v58|
  v_mfma_f32_16x16x32_bf16 v[36:39], v[168:171], a[248:251], v[36:39]
  v_mul_f32 v59, v59, |v59|
  v_mul_f32 v60, v60, |v60|
  v_mfma_f32_16x16x32_bf16 v[32:35], v[164:167], a[252:255], v[32:35]
  ds_read_b128 a[248:251], v3 offset:38912
  v_mul_f32 v61, v61, |v61|
  v_mul_f32 v62, v62, |v62|
  v_mfma_f32_16x16x32_bf16 v[36:39], v[160:163], a[252:255], v[36:39]
  s_waitcnt lgkmcnt(5)
  buffer_load_dwordx4 a[68:71], v3, s[4:7], s66 offen offset:3072
  v_mul_f32 v63, v63, |v63|
  v_mfma_f32_16x16x32_bf16 v[32:35], v[156:159], a[224:227], v[32:35]
  ds_read_b128 a[252:255], v3 offset:39936
  v_cvt_pk_bf16_f32 v64, v56, v57
  v_cvt_pk_bf16_f32 v65, v58, v59
  v_mfma_f32_16x16x32_bf16 v[36:39], v[152:155], a[224:227], v[36:39]
  v_cvt_pk_bf16_f32 v66, v60, v61
  v_cvt_pk_bf16_f32 v67, v62, v63
  v_mfma_f32_16x16x32_bf16 v[32:35], v[148:151], a[228:231], v[32:35]
  s_cmp_lg_u32 s20, 0
  s_cbranch_scc1 Lpd24
  s_waitcnt vmcnt(10)
  v_cmp_ne_u32 vcc, 1, v84
  s_cbranch_vccz Lpd24
  s_add_u32 s62, s100, s28
  s_add_u32 s62, s62, 5120
  s_mov_b32 s61, 0
Lp24:
  buffer_load_dword v84, v5, s[4:7], s62 offen sc1
  s_add_u32 s61, s61, 1
  s_cmp_gt_u32 s61, 0x100000
  s_cbranch_scc1 Lpd24
  s_waitcnt vmcnt(0)
  v_cmp_ne_u32 vcc, 1, v84
  s_cbranch_vccnz Lp24
Lpd24:
  s_waitcnt vmcnt(12)
  s_barrier
  s_sub_u32 s53, s29, s20
  s_lshl_b32 s53, s53, 11
  s_add_u32 s53, s53, s10
  s_add_u32 s53, s53, 39852032
  buffer_load_dwordx4 v[72:75], v12, s[4:7], s53 offen sc1
  buffer_load_dwordx4 v[76:79], v12, s[4:7], s53 offen offset:16 sc1
  s_add_u32 s52, s3, s8
  ds_read_b128 a[224:227], v3 offset:40960
  s_add_u32 s52, s52, 8450048
  s_add_u32 m0, s30, 81920
  v_mfma_f32_16x16x32_bf16 v[36:39], v[144:147], a[228:231], v[36:39]
  s_waitcnt lgkmcnt(5)
  buffer_load_dwordx4 v3, s[4:7], s52 offen offset:0 sc1 lds
  v_pk_max_i16 v64, v64, 0
  v_mfma_f32_16x16x32_bf16 v[32:35], v[140:143], a[232:235], v[32:35]
  ds_read_b128 a[228:231], v3 offset:41984
  v_pk_max_i16 v65, v65, 0
  v_pk_max_i16 v66, v66, 0
  v_mfma_f32_16x16x32_bf16 v[36:39], v[136:139], a[232:235], v[36:39]
  v_pk_max_i16 v67, v67, 0
  buffer_store_dwordx4 v[64:67], v3, s[4:7], s54 offen sc1
  v_mfma_f32_16x16x32_bf16 v[32:35], v[132:135], a[236:239], v[32:35]
  ds_read_b128 a[232:235], v3 offset:43008
  v_mfma_f32_16x16x32_bf16 v[36:39], v[128:131], a[236:239], v[36:39]
  s_waitcnt lgkmcnt(5)
  buffer_load_dwordx4 v3, s[4:7], s52 offen offset:1024 sc1 lds
  v_mfma_f32_16x16x32_bf16 v[32:35], v[124:127], a[240:243], v[32:35]
  ds_read_b128 a[236:239], v3 offset:44032
  v_mfma_f32_16x16x32_bf16 v[36:39], v[120:123], a[240:243], v[36:39]
  v_mfma_f32_16x16x32_bf16 v[32:35], v[116:119], a[244:247], v[32:35]
  ds_read_b128 a[240:243], v3 offset:45056
  v_mfma_f32_16x16x32_bf16 v[36:39], v[112:115], a[244:247], v[36:39]
  s_waitcnt lgkmcnt(5)
  buffer_load_dwordx4 v3, s[4:7], s52 offen offset:2048 sc1 lds
  v_mfma_f32_16x16x32_bf16 v[32:35], v[108:111], a[248:251], v[32:35]
  ds_read_b128 a[244:247], v3 offset:46080
  v_mfma_f32_16x16x32_bf16 v[36:39], v[104:107], a[248:251], v[36:39]
  v_mfma_f32_16x16x32_bf16 v[32:35], v[100:103], a[252:255], v[32:35]
  ds_read_b128 a[248:251], v3 offset:47104
  v_mfma_f32_16x16x32_bf16 v[36:39], v[96:99], a[252:255], v[36:39]
  s_waitcnt lgkmcnt(5)
  buffer_load_dwordx4 v3, s[4:7], s52 offen offset:3072 sc1 lds
  s_add_u32 s52, s52, 4096
  v_mfma_f32_16x16x32_bf16 v[24:27], v[252:255], a[224:227], 0
  ds_read_b128 a[252:255], v3 offset:48128
  s_add_u32 m0, s30, 86016
  v_mfma_f32_16x16x32_bf16 v[28:31], v[248:251], a[224:227], 0
  v_mfma_f32_16x16x32_bf16 v[24:27], v[244:247], a[228:231], v[24:27]
  ds_read_b128 a[224:227], v3 offset:49152
  v_mfma_f32_16x16x32_bf16 v[28:31], v[240:243], a[228:231], v[28:31]
  s_waitcnt lgkmcnt(5)
  buffer_load_dwordx4 v3, s[4:7], s52 offen offset:0 sc1 lds
  s_add_u32 s52, s3, s8
  v_mfma_f32_16x16x32_bf16 v[24:27], v[236:239], a[232:235], v[24:27]
  ds_read_b128 a[228:231], v3 offset:50176
  s_add_u32 s52, s52, 8429568
  s_add_u32 m0, s30, 0
  v_mfma_f32_16x16x32_bf16 v[28:31], v[232:235], a[232:235], v[28:31]
  ds_read_b64 v[70:71], v23 offset:128
  v_mfma_f32_16x16x32_bf16 v[24:27], v[228:231], a[236:239], v[24:27]
  ds_read_b128 a[232:235], v3 offset:51200
  v_mfma_f32_16x16x32_bf16 v[28:31], v[224:227], a[236:239], v[28:31]
  s_waitcnt lgkmcnt(6)
  buffer_load_dwordx4 v3, s[4:7], s52 offen offset:0 sc1 lds
  v_mfma_f32_16x16x32_bf16 v[24:27], v[220:223], a[240:243], v[24:27]
  ds_read_b128 a[236:239], v3 offset:52224
  v_mfma_f32_16x16x32_bf16 v[28:31], v[216:219], a[240:243], v[28:31]
  v_mfma_f32_16x16x32_bf16 v[24:27], v[212:215], a[244:247], v[24:27]
  s_waitcnt lgkmcnt(2)
  ds_read_b128 a[240:243], v3 offset:53248
  s_add_u32 s54, s70, s27
  s_add_u32 s54, s54, 344064
  v_mfma_f32_16x16x32_bf16 v[28:31], v[208:211], a[244:247], v[28:31]
  buffer_load_dwordx4 v3, s[4:7], s52 offen offset:1024 sc1 lds
  v_fma_f32 v56, -v71, v40, v48
  v_mfma_f32_16x16x32_bf16 v[24:27], v[204:207], a[248:251], v[24:27]
  ds_read_b128 a[244:247], v3 offset:54272
  v_fma_f32 v57, -v71, v41, v49
  v_fma_f32 v58, -v71, v42, v50
  v_mfma_f32_16x16x32_bf16 v[28:31], v[200:203], a[248:251], v[28:31]
  v_fma_f32 v59, -v71, v43, v51
  v_fma_f32 v60, -v71, v44, v52
  v_mfma_f32_16x16x32_bf16 v[24:27], v[196:199], a[252:255], v[24:27]
  ds_read_b128 a[248:251], v3 offset:55296
  v_fma_f32 v61, -v71, v45, v53
  v_fma_f32 v62, -v71, v46, v54
  v_mfma_f32_16x16x32_bf16 v[28:31], v[192:195], a[252:255], v[28:31]
  buffer_load_dwordx4 v3, s[4:7], s52 offen offset:2048 sc1 lds
  v_fma_f32 v63, -v71, v47, v55
  v_mfma_f32_16x16x32_bf16 v[24:27], v[188:191], a[224:227], v[24:27]
  ds_read_b128 a[252:255], v3 offset:56320
  v_fma_f32 v56, v32, v70, v56
  v_fma_f32 v57, v33, v70, v57
  v_mfma_f32_16x16x32_bf16 v[28:31], v[184:187], a[224:227], v[28:31]
  v_fma_f32 v58, v34, v70, v58
  v_fma_f32 v59, v35, v70, v59
  v_mfma_f32_16x16x32_bf16 v[24:27], v[180:183], a[228:231], v[24:27]
  ds_read_b128 a[224:227], v3 offset:57344
  v_fma_f32 v60, v36, v70, v60
  v_fma_f32 v61, v37, v70, v61
  v_mfma_f32_16x16x32_bf16 v[28:31], v[176:179], a[228:231], v[28:31]
  s_waitcnt lgkmcnt(5)
  buffer_load_dwordx4 v3, s[4:7], s52 offen offset:3072 sc1 lds
  s_add_u32 s52, s52, 4096
  v_mfma_f32_16x16x32_bf16 v[24:27], v[172:175], a[232:235], v[24:27]
  ds_read_b128 a[228:231], v3 offset:58368
  s_add_u32 m0, s30, 4096
  v_fma_f32 v62, v38, v70, v62
  v_mfma_f32_16x16x32_bf16 v[28:31], v[168:171], a[232:235], v[28:31]
  v_fma_f32 v63, v39, v70, v63
  v_mul_f32 v56, v56, |v56|
  v_mfma_f32_16x16x32_bf16 v[24:27], v[164:167], a[236:239], v[24:27]
  ds_read_b128 a[232:235], v3 offset:59392
  v_mul_f32 v57, v57, |v57|
  v_mul_f32 v58, v58, |v58|
  v_mfma_f32_16x16x32_bf16 v[28:31], v[160:163], a[236:239], v[28:31]
  s_waitcnt lgkmcnt(5)
  buffer_load_dwordx4 v3, s[4:7], s52 offen offset:0 sc1 lds
  v_mul_f32 v59, v59, |v59|
  v_mfma_f32_16x16x32_bf16 v[24:27], v[156:159], a[240:243], v[24:27]
  ds_read_b128 a[236:239], v3 offset:60416
  v_mul_f32 v60, v60, |v60|
  v_mul_f32 v61, v61, |v61|
  v_mfma_f32_16x16x32_bf16 v[28:31], v[152:155], a[240:243], v[28:31]
  v_mul_f32 v62, v62, |v62|
  v_mul_f32 v63, v63, |v63|
  v_mfma_f32_16x16x32_bf16 v[24:27], v[148:151], a[244:247], v[24:27]
  s_waitcnt vmcnt(19)
  s_barrier
  s_add_u32 s52, s3, s8
  ds_read_b128 a[240:243], v4 offset:0
  s_add_u32 s52, s52, 8409088
  s_add_u32 m0, s30, 20480
  v_mfma_f32_16x16x32_bf16 v[28:31], v[144:147], a[244:247], v[28:31]
  s_waitcnt lgkmcnt(5)
  buffer_load_dwordx4 v3, s[4:7], s52 offen offset:0 sc1 lds
  v_cvt_pk_bf16_f32 v64, v56, v57
  v_mfma_f32_16x16x32_bf16 v[24:27], v[140:143], a[248:251], v[24:27]
  ds_read_b128 a[244:247], v4 offset:1024
  v_cvt_pk_bf16_f32 v65, v58, v59
  v_cvt_pk_bf16_f32 v66, v60, v61
  v_mfma_f32_16x16x32_bf16 v[28:31], v[136:139], a[248:251], v[28:31]
  v_cvt_pk_bf16_f32 v67, v62, v63
  v_pk_max_i16 v64, v64, 0
  v_mfma_f32_16x16x32_bf16 v[24:27], v[132:135], a[252:255], v[24:27]
  ds_read_b128 a[248:251], v4 offset:2048
  v_pk_max_i16 v65, v65, 0
  v_pk_max_i16 v66, v66, 0
  v_mfma_f32_16x16x32_bf16 v[28:31], v[128:131], a[252:255], v[28:31]
  s_waitcnt lgkmcnt(5)
  buffer_load_dwordx4 v3, s[4:7], s52 offen offset:1024 sc1 lds
  v_pk_max_i16 v67, v67, 0
  v_mfma_f32_16x16x32_bf16 v[24:27], v[124:127], a[224:227], v[24:27]
  ds_read_b128 a[252:255], v4 offset:3072
  buffer_store_dwordx4 v[64:67], v3, s[4:7], s54 offen sc1
  v_mfma_f32_16x16x32_bf16 v[28:31], v[120:123], a[224:227], v[28:31]
  v_mfma_f32_16x16x32_bf16 v[24:27], v[116:119], a[228:231], v[24:27]
  ds_read_b128 a[224:227], v4 offset:4096
  v_mfma_f32_16x16x32_bf16 v[28:31], v[112:115], a[228:231], v[28:31]
  s_waitcnt lgkmcnt(5)
  buffer_load_dwordx4 v3, s[4:7], s52 offen offset:2048 sc1 lds
  s_waitcnt vmcnt(15)
  v_mfma_f32_16x16x32_bf16 v[24:27], v[108:111], a[232:235], v[24:27]
  ds_read_b128 a[228:231], v4 offset:5120
  v_add_f32 v72, v72, v74
  v_add_f32 v73, v73, v75
  v_mfma_f32_16x16x32_bf16 v[28:31], v[104:107], a[232:235], v[28:31]
  v_add_f32 v76, v76, v78
  v_add_f32 v77, v77, v79
  v_mfma_f32_16x16x32_bf16 v[24:27], v[100:103], a[236:239], v[24:27]
  ds_read_b128 a[232:235], v4 offset:6144
  v_add_f32 v72, v72, v76
  v_add_f32 v73, v73, v77
  v_mfma_f32_16x16x32_bf16 v[28:31], v[96:99], a[236:239], v[28:31]
  s_waitcnt lgkmcnt(5)
  buffer_load_dwordx4 v3, s[4:7], s52 offen offset:3072 sc1 lds
  s_add_u32 s52, s52, 4096
  v_mfma_f32_16x16x32_bf16 v[32:35], v[252:255], a[240:243], 0
  ds_read_b128 a[236:239], v4 offset:7168
  s_add_u32 m0, s30, 24576
  v_mov_b32 v74, v72
  v_mfma_f32_16x16x32_bf16 v[36:39], v[248:251], a[240:243], 0
  v_mov_b32 v75, v73
  v_permlane16_swap_b32 v72, v74
  v_mfma_f32_16x16x32_bf16 v[32:35], v[244:247], a[244:247], v[32:35]
  ds_read_b128 a[240:243], v4 offset:8192
  v_permlane16_swap_b32 v73, v75
  v_add_f32 v72, v72, v74
  v_mfma_f32_16x16x32_bf16 v[36:39], v[240:243], a[244:247], v[36:39]
  s_waitcnt lgkmcnt(5)
  buffer_load_dwordx4 v3, s[4:7], s52 offen offset:0 sc1 lds
  v_add_f32 v73, v73, v75
  v_mfma_f32_16x16x32_bf16 v[32:35], v[236:239], a[248:251], v[32:35]
  ds_read_b128 a[244:247], v4 offset:9216
  ds_read_b64 v[68:69], v23 offset:256
  v_mov_b32 v74, v72
  v_mfma_f32_16x16x32_bf16 v[36:39], v[232:235], a[248:251], v[36:39]
  v_mov_b32 v75, v73
  v_permlane32_swap_b32 v72, v74
  v_mfma_f32_16x16x32_bf16 v[32:35], v[228:231], a[252:255], v[32:35]
  ds_read_b128 a[248:251], v4 offset:10240
  v_permlane32_swap_b32 v73, v75
  v_add_f32 v72, v72, v74
  v_mfma_f32_16x16x32_bf16 v[36:39], v[224:227], a[252:255], v[36:39]
  s_waitcnt lgkmcnt(6)
  buffer_load_dwordx4 a[72:75], v3, s[4:7], s67 offen offset:3072
  v_add_f32 v73, v73, v75
  v_mfma_f32_16x16x32_bf16 v[32:35], v[220:223], a[224:227], v[32:35]
  ds_read_b128 a[252:255], v4 offset:11264
  v_mul_f32 v72, 0x3acccccd, v72
  v_mul_f32 v73, 0x3acccccd, v73
  v_mfma_f32_16x16x32_bf16 v[36:39], v[216:219], a[224:227], v[36:39]
  s_waitcnt lgkmcnt(2)
  s_add_u32 s54, s70, s27
  s_add_u32 s54, s54, 286720
  v_mfma_f32_16x16x32_bf16 v[32:35], v[212:215], a[228:231], v[32:35]
  ds_read_b128 a[224:227], v4 offset:12288
  v_fma_f32 v56, -v69, v40, v48
  v_fma_f32 v57, -v69, v41, v49
  v_mfma_f32_16x16x32_bf16 v[36:39], v[208:211], a[228:231], v[36:39]
  buffer_load_dwordx4 a[76:79], v3, s[4:7], s68 offen offset:3072
  s_add_u32 s63, s64, 4096
  v_mfma_f32_16x16x32_bf16 v[32:35], v[204:207], a[232:235], v[32:35]
  ds_read_b128 a[228:231], v4 offset:13312
  v_fma_f32 v58, -v69, v42, v50
  v_fma_f32 v59, -v69, v43, v51
  v_mfma_f32_16x16x32_bf16 v[36:39], v[200:203], a[232:235], v[36:39]
  v_fma_f32 v60, -v69, v44, v52
  v_fma_f32 v61, -v69, v45, v53
  v_mfma_f32_16x16x32_bf16 v[32:35], v[196:199], a[236:239], v[32:35]
  ds_read_b128 a[232:235], v4 offset:14336
  v_fma_f32 v62, -v69, v46, v54
  v_fma_f32 v63, -v69, v47, v55
  v_mfma_f32_16x16x32_bf16 v[36:39], v[192:195], a[236:239], v[36:39]
  buffer_load_dwordx4 a[80:83], v3, s[4:7], s63 offen offset:0
  s_add_u32 s63, s65, 4096
  v_mfma_f32_16x16x32_bf16 v[32:35], v[188:191], a[240:243], v[32:35]
  ds_read_b128 a[236:239], v4 offset:15360
  v_fma_f32 v56, v24, v68, v56
  v_fma_f32 v57, v25, v68, v57
  v_mfma_f32_16x16x32_bf16 v[36:39], v[184:187], a[240:243], v[36:39]
  v_fma_f32 v58, v26, v68, v58
  v_fma_f32 v59, v27, v68, v59
  v_mfma_f32_16x16x32_bf16 v[32:35], v[180:183], a[244:247], v[32:35]
  ds_read_b128 a[240:243], v4 offset:16384
  v_fma_f32 v60, v28, v68, v60
  v_fma_f32 v61, v29, v68, v61
  v_mfma_f32_16x16x32_bf16 v[36:39], v[176:179], a[244:247], v[36:39]
  s_waitcnt lgkmcnt(5)
  buffer_load_dwordx4 a[84:87], v3, s[4:7], s63 offen offset:0
  s_add_u32 s63, s66, 4096
  v_mfma_f32_16x16x32_bf16 v[32:35], v[172:175], a[248:251], v[32:35]
  ds_read_b128 a[244:247], v4 offset:17408
  v_fma_f32 v62, v30, v68, v62
  v_fma_f32 v63, v31, v68, v63
  v_mfma_f32_16x16x32_bf16 v[36:39], v[168:171], a[248:251], v[36:39]
  v_mul_f32 v56, v56, |v56|
  v_mul_f32 v57, v57, |v57|
  v_mfma_f32_16x16x32_bf16 v[32:35], v[164:167], a[252:255], v[32:35]
  ds_read_b128 a[248:251], v4 offset:18432
  v_mul_f32 v58, v58, |v58|
  v_mul_f32 v59, v59, |v59|
  v_mfma_f32_16x16x32_bf16 v[36:39], v[160:163], a[252:255], v[36:39]
  s_waitcnt lgkmcnt(5)
  buffer_load_dwordx4 a[88:91], v3, s[4:7], s63 offen offset:0
  s_add_u32 s63, s67, 4096
  v_mfma_f32_16x16x32_bf16 v[32:35], v[156:159], a[224:227], v[32:35]
  ds_read_b128 a[252:255], v4 offset:19456
  v_mul_f32 v60, v60, |v60|
  v_mul_f32 v61, v61, |v61|
  v_mfma_f32_16x16x32_bf16 v[36:39], v[152:155], a[224:227], v[36:39]
  v_mul_f32 v62, v62, |v62|
  v_mul_f32 v63, v63, |v63|
  v_mfma_f32_16x16x32_bf16 v[32:35], v[148:151], a[228:231], v[32:35]
  s_waitcnt vmcnt(16)
  s_barrier
  s_add_u32 s52, s3, s8
  ds_read_b128 a[224:227], v4 offset:20480
  s_add_u32 s52, s52, 8388608
  s_add_u32 m0, s30, 40960
  v_mfma_f32_16x16x32_bf16 v[36:39], v[144:147], a[228:231], v[36:39]
  s_waitcnt lgkmcnt(5)
  buffer_load_dwordx4 v3, s[4:7], s52 offen offset:0 sc1 lds
  v_cvt_pk_bf16_f32 v64, v56, v57
  v_mfma_f32_16x16x32_bf16 v[32:35], v[140:143], a[232:235], v[32:35]
  ds_read_b128 a[228:231], v4 offset:21504
  v_cvt_pk_bf16_f32 v65, v58, v59
  v_cvt_pk_bf16_f32 v66, v60, v61
  v_mfma_f32_16x16x32_bf16 v[36:39], v[136:139], a[232:235], v[36:39]
  v_cvt_pk_bf16_f32 v67, v62, v63
  v_pk_max_i16 v64, v64, 0
  v_mfma_f32_16x16x32_bf16 v[32:35], v[132:135], a[236:239], v[32:35]
  ds_read_b128 a[232:235], v4 offset:22528
  v_pk_max_i16 v65, v65, 0
  v_pk_max_i16 v66, v66, 0
  v_mfma_f32_16x16x32_bf16 v[36:39], v[128:131], a[236:239], v[36:39]
  s_waitcnt lgkmcnt(5)
  buffer_load_dwordx4 v3, s[4:7], s52 offen offset:1024 sc1 lds
  v_pk_max_i16 v67, v67, 0
  v_mfma_f32_16x16x32_bf16 v[32:35], v[124:127], a[240:243], v[32:35]
  ds_read_b128 a[236:239], v4 offset:23552
  buffer_store_dwordx4 v[64:67], v3, s[4:7], s54 offen sc1
  v_fma_f32 v73, -v72, v72, v73
  v_mfma_f32_16x16x32_bf16 v[36:39], v[120:123], a[240:243], v[36:39]
  v_max_f32 v73, 0, v73
  v_cvt_pk_bf16_f32 v74, v72, v73
  v_mfma_f32_16x16x32_bf16 v[32:35], v[116:119], a[244:247], v[32:35]
  ds_read_b128 a[240:243], v4 offset:24576
  v_lshlrev_b32 v72, 16, v74
  v_and_b32 v73, 0xffff0000, v74
  v_mfma_f32_16x16x32_bf16 v[36:39], v[112:115], a[244:247], v[36:39]
  s_waitcnt lgkmcnt(5)
  buffer_load_dwordx4 v3, s[4:7], s52 offen offset:2048 sc1 lds
  v_add_f32 v73, 0x3727c5ac, v73
  v_mfma_f32_16x16x32_bf16 v[32:35], v[108:111], a[248:251], v[32:35]
  ds_read_b128 a[244:247], v4 offset:25600
  v_cvt_pk_bf16_f32 v73, v73, v73
  v_lshlrev_b32 v73, 16, v73
  v_mfma_f32_16x16x32_bf16 v[36:39], v[104:107], a[248:251], v[36:39]
  v_sqrt_f32 v73, v73
  s_nop 0
  v_cvt_pk_bf16_f32 v73, v73, v73
  v_mfma_f32_16x16x32_bf16 v[32:35], v[100:103], a[252:255], v[32:35]
  ds_read_b128 a[248:251], v4 offset:26624
  v_lshlrev_b32 v73, 16, v73
  v_rcp_f32 v74, v73
  v_mfma_f32_16x16x32_bf16 v[36:39], v[96:99], a[252:255], v[36:39]
  s_waitcnt lgkmcnt(5)
  buffer_load_dwordx4 v3, s[4:7], s52 offen offset:3072 sc1 lds
  s_add_u32 s52, s52, 4096
  v_mfma_f32_16x16x32_bf16 v[24:27], v[252:255], a[224:227], 0
  ds_read_b128 a[252:255], v4 offset:27648
  s_add_u32 m0, s30, 45056
  s_lshl_b32 s53, s20, 7
  v_add_u32 v76, s53, v23
  v_mfma_f32_16x16x32_bf16 v[28:31], v[248:251], a[224:227], 0
  v_mul_f32 v75, v72, v74
  ds_write_b64 v76, v[74:75] offset:512
  v_mfma_f32_16x16x32_bf16 v[24:27], v[244:247], a[228:231], v[24:27]
  ds_read_b128 a[224:227], v4 offset:28672
  v_mfma_f32_16x16x32_bf16 v[28:31], v[240:243], a[228:231], v[28:31]
  s_waitcnt lgkmcnt(6)
  buffer_load_dwordx4 v3, s[4:7], s52 offen offset:0 sc1 lds
  v_mfma_f32_16x16x32_bf16 v[24:27], v[236:239], a[232:235], v[24:27]
  ds_read_b128 a[228:231], v4 offset:29696
  ds_read_b64 v[70:71], v23 offset:384
  v_mfma_f32_16x16x32_bf16 v[28:31], v[232:235], a[232:235], v[28:31]
  v_mfma_f32_16x16x32_bf16 v[24:27], v[228:231], a[236:239], v[24:27]
  ds_read_b128 a[232:235], v4 offset:30720
  v_mfma_f32_16x16x32_bf16 v[28:31], v[224:227], a[236:239], v[28:31]
  s_waitcnt lgkmcnt(7)
  buffer_load_dwordx4 a[92:95], v3, s[4:7], s63 offen offset:0
  s_add_u32 s63, s68, 4096
  v_mfma_f32_16x16x32_bf16 v[24:27], v[220:223], a[240:243], v[24:27]
  ds_read_b128 a[236:239], v4 offset:31744
  v_mfma_f32_16x16x32_bf16 v[28:31], v[216:219], a[240:243], v[28:31]
  s_waitcnt lgkmcnt(2)
  s_add_u32 s54, s70, s27
  s_add_u32 s54, s54, 229376
  v_mfma_f32_16x16x32_bf16 v[24:27], v[212:215], a[244:247], v[24:27]
  ds_read_b128 a[240:243], v4 offset:32768
  v_fma_f32 v56, -v71, v40, v48
  v_fma_f32 v57, -v71, v41, v49
  v_mfma_f32_16x16x32_bf16 v[28:31], v[208:211], a[244:247], v[28:31]
  buffer_load_dwordx4 a[96:99], v3, s[4:7], s63 offen offset:0
  s_add_u32 s63, s64, 4096
  v_mfma_f32_16x16x32_bf16 v[24:27], v[204:207], a[248:251], v[24:27]
  ds_read_b128 a[244:247], v4 offset:33792
  v_fma_f32 v58, -v71, v42, v50
  v_fma_f32 v59, -v71, v43, v51
  v_mfma_f32_16x16x32_bf16 v[28:31], v[200:203], a[248:251], v[28:31]
  v_fma_f32 v60, -v71, v44, v52
  v_fma_f32 v61, -v71, v45, v53
  v_mfma_f32_16x16x32_bf16 v[24:27], v[196:199], a[252:255], v[24:27]
  ds_read_b128 a[248:251], v4 offset:34816
  v_fma_f32 v62, -v71, v46, v54
  v_fma_f32 v63, -v71, v47, v55
  v_mfma_f32_16x16x32_bf16 v[28:31], v[192:195], a[252:255], v[28:31]
  buffer_load_dwordx4 a[100:103], v3, s[4:7], s63 offen offset:1024
  s_add_u32 s63, s65, 4096
  v_mfma_f32_16x16x32_bf16 v[24:27], v[188:191], a[224:227], v[24:27]
  ds_read_b128 a[252:255], v4 offset:35840
  v_fma_f32 v56, v32, v70, v56
  v_fma_f32 v57, v33, v70, v57
  v_mfma_f32_16x16x32_bf16 v[28:31], v[184:187], a[224:227], v[28:31]
  v_fma_f32 v58, v34, v70, v58
  v_fma_f32 v59, v35, v70, v59
  v_mfma_f32_16x16x32_bf16 v[24:27], v[180:183], a[228:231], v[24:27]
  ds_read_b128 a[224:227], v4 offset:36864
  v_fma_f32 v60, v36, v70, v60
  v_fma_f32 v61, v37, v70, v61
  v_mfma_f32_16x16x32_bf16 v[28:31], v[176:179], a[228:231], v[28:31]
  s_waitcnt lgkmcnt(5)
  buffer_load_dwordx4 a[104:107], v3, s[4:7], s63 offen offset:1024
  s_add_u32 s63, s66, 4096
  v_mfma_f32_16x16x32_bf16 v[24:27], v[172:175], a[232:235], v[24:27]
  ds_read_b128 a[228:231], v4 offset:37888
  v_fma_f32 v62, v38, v70, v62
  v_fma_f32 v63, v39, v70, v63
  v_mfma_f32_16x16x32_bf16 v[28:31], v[168:171], a[232:235], v[28:31]
  v_mul_f32 v56, v56, |v56|
  v_mul_f32 v57, v57, |v57|
  v_mfma_f32_16x16x32_bf16 v[24:27], v[164:167], a[236:239], v[24:27]
  ds_read_b128 a[232:235], v4 offset:38912
  v_mul_f32 v58, v58, |v58|
  v_mul_f32 v59, v59, |v59|
  v_mfma_f32_16x16x32_bf16 v[28:31], v[160:163], a[236:239], v[28:31]
  s_waitcnt lgkmcnt(5)
  buffer_load_dwordx4 a[108:111], v3, s[4:7], s63 offen offset:1024
  s_add_u32 s63, s67, 4096
  v_mfma_f32_16x16x32_bf16 v[24:27], v[156:159], a[240:243], v[24:27]
  ds_read_b128 a[236:239], v4 offset:39936
  v_mul_f32 v60, v60, |v60|
  v_mul_f32 v61, v61, |v61|
  v_mfma_f32_16x16x32_bf16 v[28:31], v[152:155], a[240:243], v[28:31]
  v_mul_f32 v62, v62, |v62|
  v_mul_f32 v63, v63, |v63|
  v_mfma_f32_16x16x32_bf16 v[24:27], v[148:151], a[244:247], v[24:27]
  s_waitcnt vmcnt(22)
  s_barrier
  ds_read_b128 a[240:243], v3 offset:0
  v_cvt_pk_bf16_f32 v64, v56, v57
  v_cvt_pk_bf16_f32 v65, v58, v59
  v_mfma_f32_16x16x32_bf16 v[28:31], v[144:147], a[244:247], v[28:31]
  s_waitcnt lgkmcnt(5)
  buffer_load_dwordx4 a[112:115], v3, s[4:7], s63 offen offset:1024
  s_add_u32 s63, s68, 4096
  v_mfma_f32_16x16x32_bf16 v[24:27], v[140:143], a[248:251], v[24:27]
  ds_read_b128 a[244:247], v3 offset:1024
  v_cvt_pk_bf16_f32 v66, v60, v61
  v_cvt_pk_bf16_f32 v67, v62, v63
  v_mfma_f32_16x16x32_bf16 v[28:31], v[136:139], a[248:251], v[28:31]
  v_pk_max_i16 v64, v64, 0
  v_pk_max_i16 v65, v65, 0
  v_mfma_f32_16x16x32_bf16 v[24:27], v[132:135], a[252:255], v[24:27]
  ds_read_b128 a[248:251], v3 offset:2048
  v_pk_max_i16 v66, v66, 0
  v_pk_max_i16 v67, v67, 0
  v_mfma_f32_16x16x32_bf16 v[28:31], v[128:131], a[252:255], v[28:31]
  s_waitcnt lgkmcnt(5)
  buffer_load_dwordx4 a[116:119], v3, s[4:7], s63 offen offset:1024
  s_add_u32 s63, s64, 4096
  v_mfma_f32_16x16x32_bf16 v[24:27], v[124:127], a[224:227], v[24:27]
  ds_read_b128 a[252:255], v3 offset:3072
  buffer_store_dwordx4 v[64:67], v3, s[4:7], s54 offen sc1
  v_mfma_f32_16x16x32_bf16 v[28:31], v[120:123], a[224:227], v[28:31]
  v_mfma_f32_16x16x32_bf16 v[24:27], v[116:119], a[228:231], v[24:27]
  ds_read_b128 a[224:227], v3 offset:4096
  v_mfma_f32_16x16x32_bf16 v[28:31], v[112:115], a[228:231], v[28:31]
  s_waitcnt lgkmcnt(5)
  buffer_load_dwordx4 a[120:123], v3, s[4:7], s63 offen offset:2048
  s_add_u32 s63, s65, 4096
  v_mfma_f32_16x16x32_bf16 v[24:27], v[108:111], a[232:235], v[24:27]
  ds_read_b128 a[228:231], v3 offset:5120
  v_mfma_f32_16x16x32_bf16 v[28:31], v[104:107], a[232:235], v[28:31]
  v_mfma_f32_16x16x32_bf16 v[24:27], v[100:103], a[236:239], v[24:27]
  ds_read_b128 a[232:235], v3 offset:6144
  v_mfma_f32_16x16x32_bf16 v[28:31], v[96:99], a[236:239], v[28:31]
  s_waitcnt lgkmcnt(5)
  buffer_load_dwordx4 a[124:127], v3, s[4:7], s63 offen offset:2048
  s_add_u32 s63, s66, 4096
  v_mfma_f32_16x16x32_bf16 v[32:35], v[252:255], a[240:243], 0
  ds_read_b128 a[236:239], v3 offset:7168
  v_mfma_f32_16x16x32_bf16 v[36:39], v[248:251], a[240:243], 0
  v_mfma_f32_16x16x32_bf16 v[32:35], v[244:247], a[244:247], v[32:35]
  ds_read_b128 a[240:243], v3 offset:8192
  v_mfma_f32_16x16x32_bf16 v[36:39], v[240:243], a[244:247], v[36:39]
  s_waitcnt lgkmcnt(5)
  buffer_load_dwordx4 a[128:131], v3, s[4:7], s63 offen offset:2048
  s_add_u32 s63, s67, 4096
  v_mfma_f32_16x16x32_bf16 v[32:35], v[236:239], a[248:251], v[32:35]
  ds_read_b128 a[244:247], v3 offset:9216
  ds_read_b64 v[68:69], v23 offset:512
  v_mfma_f32_16x16x32_bf16 v[36:39], v[232:235], a[248:251], v[36:39]
  v_mfma_f32_16x16x32_bf16 v[32:35], v[228:231], a[252:255], v[32:35]
  ds_read_b128 a[248:251], v3 offset:10240
  v_mfma_f32_16x16x32_bf16 v[36:39], v[224:227], a[252:255], v[36:39]
  s_waitcnt lgkmcnt(6)
  buffer_load_dwordx4 a[132:135], v3, s[4:7], s63 offen offset:2048
  s_add_u32 s63, s68, 4096
  v_mfma_f32_16x16x32_bf16 v[32:35], v[220:223], a[224:227], v[32:35]
  ds_read_b128 a[252:255], v3 offset:11264
  v_mfma_f32_16x16x32_bf16 v[36:39], v[216:219], a[224:227], v[36:39]
  s_waitcnt lgkmcnt(2)
  s_add_u32 s54, s70, s27
  s_add_u32 s54, s54, 172032
  v_mfma_f32_16x16x32_bf16 v[32:35], v[212:215], a[228:231], v[32:35]
  ds_read_b128 a[224:227], v3 offset:12288
  v_fma_f32 v56, -v69, v40, v48
  v_fma_f32 v57, -v69, v41, v49
  v_mfma_f32_16x16x32_bf16 v[36:39], v[208:211], a[228:231], v[36:39]
  buffer_load_dwordx4 a[136:139], v3, s[4:7], s63 offen offset:2048
  s_add_u32 s63, s64, 4096
  v_mfma_f32_16x16x32_bf16 v[32:35], v[204:207], a[232:235], v[32:35]
  ds_read_b128 a[228:231], v3 offset:13312
  v_fma_f32 v58, -v69, v42, v50
  v_fma_f32 v59, -v69, v43, v51
  v_mfma_f32_16x16x32_bf16 v[36:39], v[200:203], a[232:235], v[36:39]
  v_fma_f32 v60, -v69, v44, v52
  v_fma_f32 v61, -v69, v45, v53
  v_mfma_f32_16x16x32_bf16 v[32:35], v[196:199], a[236:239], v[32:35]
  ds_read_b128 a[232:235], v3 offset:14336
  v_fma_f32 v62, -v69, v46, v54
  v_fma_f32 v63, -v69, v47, v55
  v_mfma_f32_16x16x32_bf16 v[36:39], v[192:195], a[236:239], v[36:39]
  buffer_load_dwordx4 a[140:143], v3, s[4:7], s63 offen offset:3072
  s_add_u32 s63, s65, 4096
  v_mfma_f32_16x16x32_bf16 v[32:35], v[188:191], a[240:243], v[32:35]
  ds_read_b128 a[236:239], v3 offset:15360
  v_fma_f32 v56, v24, v68, v56
  v_fma_f32 v57, v25, v68, v57
  v_mfma_f32_16x16x32_bf16 v[36:39], v[184:187], a[240:243], v[36:39]
  v_fma_f32 v58, v26, v68, v58
  v_fma_f32 v59, v27, v68, v59
  v_mfma_f32_16x16x32_bf16 v[32:35], v[180:183], a[244:247], v[32:35]
  ds_read_b128 a[240:243], v3 offset:16384
  v_fma_f32 v60, v28, v68, v60
  v_fma_f32 v61, v29, v68, v61
  v_mfma_f32_16x16x32_bf16 v[36:39], v[176:179], a[244:247], v[36:39]
  s_waitcnt lgkmcnt(5)
  buffer_load_dwordx4 a[144:147], v3, s[4:7], s63 offen offset:3072
  s_add_u32 s63, s66, 4096
  v_mfma_f32_16x16x32_bf16 v[32:35], v[172:175], a[248:251], v[32:35]
  ds_read_b128 a[244:247], v3 offset:17408
  v_fma_f32 v62, v30, v68, v62
  v_fma_f32 v63, v31, v68, v63
  v_mfma_f32_16x16x32_bf16 v[36:39], v[168:171], a[248:251], v[36:39]
  v_mul_f32 v56, v56, |v56|
  v_mul_f32 v57, v57, |v57|
  v_mfma_f32_16x16x32_bf16 v[32:35], v[164:167], a[252:255], v[32:35]
  ds_read_b128 a[248:251], v3 offset:18432
  v_mul_f32 v58, v58, |v58|
  v_mul_f32 v59, v59, |v59|
  v_mfma_f32_16x16x32_bf16 v[36:39], v[160:163], a[252:255], v[36:39]
  s_waitcnt lgkmcnt(5)
  buffer_load_dwordx4 a[148:151], v3, s[4:7], s63 offen offset:3072
  s_add_u32 s63, s67, 4096
  v_mfma_f32_16x16x32_bf16 v[32:35], v[156:159], a[224:227], v[32:35]
  ds_read_b128 a[252:255], v3 offset:19456
  v_mul_f32 v60, v60, |v60|
  v_mul_f32 v61, v61, |v61|
  v_mfma_f32_16x16x32_bf16 v[36:39], v[152:155], a[224:227], v[36:39]
  v_mul_f32 v62, v62, |v62|
  v_mul_f32 v63, v63, |v63|
  v_mfma_f32_16x16x32_bf16 v[32:35], v[148:151], a[228:231], v[32:35]
  s_waitcnt vmcnt(8)
  s_barrier
  s_cmp_lg_u32 s20, 0
  s_cbranch_scc1 Lf25
  s_add_u32 s62, s100, s28
  s_add_u32 s62, s62, 6144
  s_lshl_b32 s61, s22, 2
  s_add_u32 s62, s62, s61
  s_mov_b64 exec, 1
  s_cmp_eq_u32 s12, 1
  s_cbranch_scc1 Ldb26
  buffer_store_dword v86, v87, s[4:7], s62 offen sc1
  s_branch Lde26
Ldb26:
  buffer_store_dword v86, v87, s[4:7], s62 offen
Lde26:
  s_mov_b64 exec, -1
Lf25:
  ds_read_b128 a[224:227], v3 offset:20480
  v_cvt_pk_bf16_f32 v64, v56, v57
  v_cvt_pk_bf16_f32 v65, v58, v59
  v_mfma_f32_16x16x32_bf16 v[36:39], v[144:147], a[228:231], v[36:39]
  s_waitcnt lgkmcnt(5)
  buffer_load_dwordx4 a[152:155], v3, s[4:7], s63 offen offset:3072
  s_add_u32 s63, s68, 4096
  v_mfma_f32_16x16x32_bf16 v[32:35], v[140:143], a[232:235], v[32:35]
  ds_read_b128 a[228:231], v3 offset:21504
  v_cvt_pk_bf16_f32 v66, v60, v61
  v_cvt_pk_bf16_f32 v67, v62, v63
  v_mfma_f32_16x16x32_bf16 v[36:39], v[136:139], a[232:235], v[36:39]
  v_pk_max_i16 v64, v64, 0
  v_pk_max_i16 v65, v65, 0
  v_mfma_f32_16x16x32_bf16 v[32:35], v[132:135], a[236:239], v[32:35]
  ds_read_b128 a[232:235], v3 offset:22528
  v_pk_max_i16 v66, v66, 0
  v_pk_max_i16 v67, v67, 0
  v_mfma_f32_16x16x32_bf16 v[36:39], v[128:131], a[236:239], v[36:39]
  s_waitcnt lgkmcnt(5)
  buffer_load_dwordx4 a[156:159], v3, s[4:7], s63 offen offset:3072
  s_add_u32 s63, s64, 8192
  v_mfma_f32_16x16x32_bf16 v[32:35], v[124:127], a[240:243], v[32:35]
  ds_read_b128 a[236:239], v3 offset:23552
  buffer_store_dwordx4 v[64:67], v3, s[4:7], s54 offen sc1
  v_mfma_f32_16x16x32_bf16 v[36:39], v[120:123], a[240:243], v[36:39]
  v_mfma_f32_16x16x32_bf16 v[32:35], v[116:119], a[244:247], v[32:35]
  ds_read_b128 a[240:243], v3 offset:24576
  v_mfma_f32_16x16x32_bf16 v[36:39], v[112:115], a[244:247], v[36:39]
  s_waitcnt lgkmcnt(5)
  buffer_load_dwordx4 a[160:163], v3, s[4:7], s63 offen offset:0
  s_add_u32 s63, s65, 8192
  v_mfma_f32_16x16x32_bf16 v[32:35], v[108:111], a[248:251], v[32:35]
  ds_read_b128 a[244:247], v3 offset:25600
  v_mfma_f32_16x16x32_bf16 v[36:39], v[104:107], a[248:251], v[36:39]
  v_mfma_f32_16x16x32_bf16 v[32:35], v[100:103], a[252:255], v[32:35]
  ds_read_b128 a[248:251], v3 offset:26624
  v_mfma_f32_16x16x32_bf16 v[36:39], v[96:99], a[252:255], v[36:39]
  s_waitcnt lgkmcnt(5)
  buffer_load_dwordx4 a[164:167], v3, s[4:7], s63 offen offset:0
  s_add_u32 s63, s66, 8192
  v_mfma_f32_16x16x32_bf16 v[24:27], v[252:255], a[224:227], 0
  ds_read_b128 a[252:255], v3 offset:27648
  v_mfma_f32_16x16x32_bf16 v[28:31], v[248:251], a[224:227], 0
  v_mfma_f32_16x16x32_bf16 v[24:27], v[244:247], a[228:231], v[24:27]
  ds_read_b128 a[224:227], v3 offset:28672
  v_mfma_f32_16x16x32_bf16 v[28:31], v[240:243], a[228:231], v[28:31]
  s_waitcnt lgkmcnt(5)
  buffer_load_dwordx4 a[168:171], v3, s[4:7], s63 offen offset:0
  s_add_u32 s63, s67, 8192
  v_mfma_f32_16x16x32_bf16 v[24:27], v[236:239], a[232:235], v[24:27]
  ds_read_b128 a[228:231], v3 offset:29696
  ds_read_b64 v[70:71], v23 offset:640
  v_mfma_f32_16x16x32_bf16 v[28:31], v[232:235], a[232:235], v[28:31]
  v_mfma_f32_16x16x32_bf16 v[24:27], v[228:231], a[236:239], v[24:27]
  ds_read_b128 a[232:235], v3 offset:30720
  v_mfma_f32_16x16x32_bf16 v[28:31], v[224:227], a[236:239], v[28:31]
  s_waitcnt lgkmcnt(6)
  buffer_load_dwordx4 a[172:175], v3, s[4:7], s63 offen offset:0
  s_add_u32 s63, s68, 8192
  v_mfma_f32_16x16x32_bf16 v[24:27], v[220:223], a[240:243], v[24:27]
  ds_read_b128 a[236:239], v3 offset:31744
  v_mfma_f32_16x16x32_bf16 v[28:31], v[216:219], a[240:243], v[28:31]
  s_waitcnt lgkmcnt(2)
  s_add_u32 s54, s70, s27
  s_add_u32 s54, s54, 114688
  v_mfma_f32_16x16x32_bf16 v[24:27], v[212:215], a[244:247], v[24:27]
  ds_read_b128 a[240:243], v3 offset:32768
  v_fma_f32 v56, -v71, v40, v48
  v_fma_f32 v57, -v71, v41, v49
  v_mfma_f32_16x16x32_bf16 v[28:31], v[208:211], a[244:247], v[28:31]
  buffer_load_dwordx4 a[176:179], v3, s[4:7], s63 offen offset:0
  s_add_u32 s63, s64, 8192
  v_mfma_f32_16x16x32_bf16 v[24:27], v[204:207], a[248:251], v[24:27]
  ds_read_b128 a[244:247], v3 offset:33792
  v_fma_f32 v58, -v71, v42, v50
  v_fma_f32 v59, -v71, v43, v51
  v_mfma_f32_16x16x32_bf16 v[28:31], v[200:203], a[248:251], v[28:31]
  v_fma_f32 v60, -v71, v44, v52
  v_fma_f32 v61, -v71, v45, v53
  v_mfma_f32_16x16x32_bf16 v[24:27], v[196:199], a[252:255], v[24:27]
  ds_read_b128 a[248:251], v3 offset:34816
  v_fma_f32 v62, -v71, v46, v54
  v_fma_f32 v63, -v71, v47, v55
  v_mfma_f32_16x16x32_bf16 v[28:31], v[192:195], a[252:255], v[28:31]
  buffer_load_dwordx4 a[180:183], v3, s[4:7], s63 offen offset:1024
  s_add_u32 s63, s65, 8192
  v_mfma_f32_16x16x32_bf16 v[24:27], v[188:191], a[224:227], v[24:27]
  ds_read_b128 a[252:255], v3 offset:35840
  v_fma_f32 v56, v32, v70, v56
  v_fma_f32 v57, v33, v70, v57
  v_mfma_f32_16x16x32_bf16 v[28:31], v[184:187], a[224:227], v[28:31]
  v_fma_f32 v58, v34, v70, v58
  v_fma_f32 v59, v35, v70, v59
  v_mfma_f32_16x16x32_bf16 v[24:27], v[180:183], a[228:231], v[24:27]
  ds_read_b128 a[224:227], v3 offset:36864
  v_fma_f32 v60, v36, v70, v60
  v_fma_f32 v61, v37, v70, v61
  v_mfma_f32_16x16x32_bf16 v[28:31], v[176:179], a[228:231], v[28:31]
  s_waitcnt lgkmcnt(5)
  buffer_load_dwordx4 a[184:187], v3, s[4:7], s63 offen offset:1024
  s_add_u32 s63, s66, 8192
  v_mfma_f32_16x16x32_bf16 v[24:27], v[172:175], a[232:235], v[24:27]
  ds_read_b128 a[228:231], v3 offset:37888
  v_fma_f32 v62, v38, v70, v62
  v_fma_f32 v63, v39, v70, v63
  v_mfma_f32_16x16x32_bf16 v[28:31], v[168:171], a[232:235], v[28:31]
  v_mul_f32 v56, v56, |v56|
  v_mul_f32 v57, v57, |v57|
  v_mfma_f32_16x16x32_bf16 v[24:27], v[164:167], a[236:239], v[24:27]
  ds_read_b128 a[232:235], v3 offset:38912
  v_mul_f32 v58, v58, |v58|
  v_mul_f32 v59, v59, |v59|
  v_mfma_f32_16x16x32_bf16 v[28:31], v[160:163], a[236:239], v[28:31]
  s_waitcnt lgkmcnt(5)
  buffer_load_dwordx4 a[188:191], v3, s[4:7], s63 offen offset:1024
  s_add_u32 s63, s67, 8192
  v_mfma_f32_16x16x32_bf16 v[24:27], v[156:159], a[240:243], v[24:27]
  ds_read_b128 a[236:239], v3 offset:39936
  v_mul_f32 v60, v60, |v60|
  v_mul_f32 v61, v61, |v61|
  v_mfma_f32_16x16x32_bf16 v[28:31], v[152:155], a[240:243], v[28:31]
  v_mul_f32 v62, v62, |v62|
  v_mul_f32 v63, v63, |v63|
  v_mfma_f32_16x16x32_bf16 v[24:27], v[148:151], a[244:247], v[24:27]
  s_barrier
  s_xor_b32 s96, s45, 0
  s_lshl_b32 s59, s34, 1
  s_add_u32 s96, s96, s59
  s_add_u32 s96, s96, s29
  s_add_u32 s96, s96, 4
  s_mul_i32 s96, s96, 57344
  s_mul_i32 s59, s20, 14336
  s_add_u32 s96, s96, s59
  s_add_u32 s96, s96, s27
  s_add_u32 s96, s96, 25165824
  s_xor_b32 s97, s45, 1
  s_lshl_b32 s59, s34, 1
  s_add_u32 s97, s97, s59
  s_add_u32 s97, s97, s29
  s_add_u32 s97, s97, 4
  s_mul_i32 s97, s97, 57344
  s_mul_i32 s59, s20, 14336
  s_add_u32 s97, s97, s59
  s_add_u32 s97, s97, s27
  s_add_u32 s97, s97, 25165824
  s_xor_b32 s98, s45, 0
  s_lshl_b32 s59, s34, 1
  s_add_u32 s98, s98, s59
  s_add_u32 s98, s98, s29
  s_mul_i32 s98, s98, 57344
  s_mul_i32 s59, s20, 14336
  s_add_u32 s98, s98, s59
  s_add_u32 s98, s98, s27
  s_add_u32 s98, s98, 25165824
  s_xor_b32 s99, s45, 1
  s_lshl_b32 s59, s34, 1
  s_add_u32 s99, s99, s59
  s_add_u32 s99, s99, s29
  s_mul_i32 s99, s99, 57344
  s_mul_i32 s59, s20, 14336
  s_add_u32 s99, s99, s59
  s_add_u32 s99, s99, s27
  s_add_u32 s99, s99, 25165824
  s_add_u32 s62, s100, s28
  s_add_u32 s62, s62, 6144
  buffer_load_dword v84, v5, s[4:7], s62 offen sc1
  ds_read_b128 a[240:243], v3 offset:40960
  v_cvt_pk_bf16_f32 v64, v56, v57
  v_cvt_pk_bf16_f32 v65, v58, v59
  v_mfma_f32_16x16x32_bf16 v[28:31], v[144:147], a[244:247], v[28:31]
  s_waitcnt lgkmcnt(5)
  buffer_load_dwordx4 a[192:195], v3, s[4:7], s63 offen offset:1024
  s_add_u32 s63, s68, 8192
  v_mfma_f32_16x16x32_bf16 v[24:27], v[140:143], a[248:251], v[24:27]
  ds_read_b128 a[244:247], v3 offset:41984
  v_cvt_pk_bf16_f32 v66, v60, v61
  v_cvt_pk_bf16_f32 v67, v62, v63
  v_mfma_f32_16x16x32_bf16 v[28:31], v[136:139], a[248:251], v[28:31]
  v_pk_max_i16 v64, v64, 0
  v_pk_max_i16 v65, v65, 0
  v_mfma_f32_16x16x32_bf16 v[24:27], v[132:135], a[252:255], v[24:27]
  ds_read_b128 a[248:251], v3 offset:43008
  v_pk_max_i16 v66, v66, 0
  v_pk_max_i16 v67, v67, 0
  v_mfma_f32_16x16x32_bf16 v[28:31], v[128:131], a[252:255], v[28:31]
  s_waitcnt lgkmcnt(5)
  buffer_load_dwordx4 a[196:199], v3, s[4:7], s63 offen offset:1024
  s_add_u32 s63, s64, 8192
  v_mfma_f32_16x16x32_bf16 v[24:27], v[124:127], a[224:227], v[24:27]
  ds_read_b128 a[252:255], v3 offset:44032
  buffer_store_dwordx4 v[64:67], v3, s[4:7], s54 offen sc1
  v_mfma_f32_16x16x32_bf16 v[28:31], v[120:123], a[224:227], v[28:31]
  v_mfma_f32_16x16x32_bf16 v[24:27], v[116:119], a[228:231], v[24:27]
  ds_read_b128 a[224:227], v3 offset:45056
  v_mfma_f32_16x16x32_bf16 v[28:31], v[112:115], a[228:231], v[28:31]
  s_waitcnt lgkmcnt(5)
  buffer_load_dwordx4 a[200:203], v3, s[4:7], s63 offen offset:2048
  s_add_u32 s63, s65, 8192
  v_mfma_f32_16x16x32_bf16 v[24:27], v[108:111], a[232:235], v[24:27]
  ds_read_b128 a[228:231], v3 offset:46080
  v_mfma_f32_16x16x32_bf16 v[28:31], v[104:107], a[232:235], v[28:31]
  v_mfma_f32_16x16x32_bf16 v[24:27], v[100:103], a[236:239], v[24:27]
  ds_read_b128 a[232:235], v3 offset:47104
  v_mfma_f32_16x16x32_bf16 v[28:31], v[96:99], a[236:239], v[28:31]
  s_waitcnt lgkmcnt(5)
  buffer_load_dwordx4 a[204:207], v3, s[4:7], s63 offen offset:2048
  s_add_u32 s63, s66, 8192
  v_mfma_f32_16x16x32_bf16 v[32:35], v[252:255], a[240:243], 0
  ds_read_b128 a[236:239], v3 offset:48128
  v_mfma_f32_16x16x32_bf16 v[36:39], v[248:251], a[240:243], 0
  v_mfma_f32_16x16x32_bf16 v[32:35], v[244:247], a[244:247], v[32:35]
  ds_read_b128 a[240:243], v3 offset:49152
  v_mfma_f32_16x16x32_bf16 v[36:39], v[240:243], a[244:247], v[36:39]
  s_waitcnt lgkmcnt(5)
  buffer_load_dwordx4 a[208:211], v3, s[4:7], s63 offen offset:2048
  s_add_u32 s63, s67, 8192
  v_mfma_f32_16x16x32_bf16 v[32:35], v[236:239], a[248:251], v[32:35]
  ds_read_b128 a[244:247], v3 offset:50176
  ds_read_b64 v[68:69], v23 offset:768
  v_mfma_f32_16x16x32_bf16 v[36:39], v[232:235], a[248:251], v[36:39]
  v_mfma_f32_16x16x32_bf16 v[32:35], v[228:231], a[252:255], v[32:35]
  ds_read_b128 a[248:251], v3 offset:51200
  v_mfma_f32_16x16x32_bf16 v[36:39], v[224:227], a[252:255], v[36:39]
  s_waitcnt lgkmcnt(6)
  buffer_load_dwordx4 a[212:215], v3, s[4:7], s63 offen offset:2048
  s_add_u32 s63, s68, 8192
  v_mfma_f32_16x16x32_bf16 v[32:35], v[220:223], a[224:227], v[32:35]
  ds_read_b128 a[252:255], v3 offset:52224
  v_mfma_f32_16x16x32_bf16 v[36:39], v[216:219], a[224:227], v[36:39]
  s_waitcnt lgkmcnt(2)
  s_add_u32 s54, s70, s27
  s_add_u32 s54, s54, 57344
  v_mfma_f32_16x16x32_bf16 v[32:35], v[212:215], a[228:231], v[32:35]
  ds_read_b128 a[224:227], v3 offset:53248
  v_fma_f32 v56, -v69, v40, v48
  v_fma_f32 v57, -v69, v41, v49
  v_mfma_f32_16x16x32_bf16 v[36:39], v[208:211], a[228:231], v[36:39]
  buffer_load_dwordx4 a[216:219], v3, s[4:7], s63 offen offset:2048
  s_add_u32 s63, s64, 8192
  v_mfma_f32_16x16x32_bf16 v[32:35], v[204:207], a[232:235], v[32:35]
  ds_read_b128 a[228:231], v3 offset:54272
  v_fma_f32 v58, -v69, v42, v50
  v_fma_f32 v59, -v69, v43, v51
  v_mfma_f32_16x16x32_bf16 v[36:39], v[200:203], a[232:235], v[36:39]
  v_fma_f32 v60, -v69, v44, v52
  v_fma_f32 v61, -v69, v45, v53
  v_mfma_f32_16x16x32_bf16 v[32:35], v[196:199], a[236:239], v[32:35]
  ds_read_b128 a[232:235], v3 offset:55296
  v_fma_f32 v62, -v69, v46, v54
  v_fma_f32 v63, -v69, v47, v55
  v_mfma_f32_16x16x32_bf16 v[36:39], v[192:195], a[236:239], v[36:39]
  buffer_load_dwordx4 a[220:223], v3, s[4:7], s63 offen offset:3072
  v_fma_f32 v56, v24, v68, v56
  v_mfma_f32_16x16x32_bf16 v[32:35], v[188:191], a[240:243], v[32:35]
  ds_read_b128 a[236:239], v3 offset:56320
  v_fma_f32 v57, v25, v68, v57
  v_fma_f32 v58, v26, v68, v58
  v_mfma_f32_16x16x32_bf16 v[36:39], v[184:187], a[240:243], v[36:39]
  v_fma_f32 v59, v27, v68, v59
  v_fma_f32 v60, v28, v68, v60
  v_mfma_f32_16x16x32_bf16 v[32:35], v[180:183], a[244:247], v[32:35]
  ds_read_b128 a[240:243], v3 offset:57344
  v_fma_f32 v61, v29, v68, v61
  v_fma_f32 v62, v30, v68, v62
  v_mfma_f32_16x16x32_bf16 v[36:39], v[176:179], a[244:247], v[36:39]
  s_waitcnt lgkmcnt(5)
  v_fma_f32 v63, v31, v68, v63
  v_mul_f32 v56, v56, |v56|
  v_mfma_f32_16x16x32_bf16 v[32:35], v[172:175], a[248:251], v[32:35]
  ds_read_b128 a[244:247], v3 offset:58368
  v_mul_f32 v57, v57, |v57|
  v_mul_f32 v58, v58, |v58|
  v_mfma_f32_16x16x32_bf16 v[36:39], v[168:171], a[248:251], v[36:39]
  v_mul_f32 v59, v59, |v59|
  v_mul_f32 v60, v60, |v60|
  v_mfma_f32_16x16x32_bf16 v[32:35], v[164:167], a[252:255], v[32:35]
  ds_read_b128 a[248:251], v3 offset:59392
  v_mul_f32 v61, v61, |v61|
  v_mul_f32 v62, v62, |v62|
  v_mfma_f32_16x16x32_bf16 v[36:39], v[160:163], a[252:255], v[36:39]
  s_waitcnt lgkmcnt(5)
  v_mul_f32 v63, v63, |v63|
  v_cvt_pk_bf16_f32 v64, v56, v57
  s_cmp_lg_u32 s20, 0
  s_cbranch_scc1 Lpd27
  s_waitcnt vmcnt(9)
  v_cmp_ne_u32 vcc, 1, v84
  s_cbranch_vccz Lpd27
  s_add_u32 s62, s100, s28
  s_add_u32 s62, s62, 6144
  s_mov_b32 s61, 0
Lp27:
  buffer_load_dword v84, v5, s[4:7], s62 offen sc1
  s_add_u32 s61, s61, 1
  s_cmp_gt_u32 s61, 0x100000
  s_cbranch_scc1 Lpd27
  s_waitcnt vmcnt(0)
  v_cmp_ne_u32 vcc, 1, v84
  s_cbranch_vccnz Lp27
Lpd27:
  s_barrier
  v_mfma_f32_16x16x32_bf16 v[32:35], v[156:159], a[224:227], v[32:35]
  ds_read_b128 a[252:255], v3 offset:60416
  buffer_load_dwordx4 v[160:163], v3, s[4:7], s96 offen offset:0 sc1
  v_cvt_pk_bf16_f32 v65, v58, v59
  v_mfma_f32_16x16x32_bf16 v[36:39], v[152:155], a[224:227], v[36:39]
  v_cvt_pk_bf16_f32 v66, v60, v61
  v_cvt_pk_bf16_f32 v67, v62, v63
  v_mfma_f32_16x16x32_bf16 v[32:35], v[148:151], a[228:231], v[32:35]
  v_pk_max_i16 v64, v64, 0
  v_pk_max_i16 v65, v65, 0
  v_mfma_f32_16x16x32_bf16 v[36:39], v[144:147], a[228:231], v[36:39]
  s_waitcnt lgkmcnt(4)
  v_pk_max_i16 v66, v66, 0
  v_pk_max_i16 v67, v67, 0
  v_mfma_f32_16x16x32_bf16 v[32:35], v[140:143], a[232:235], v[32:35]
  buffer_load_dwordx4 v[164:167], v3, s[4:7], s97 offen offset:0 sc1
  buffer_store_dwordx4 v[64:67], v3, s[4:7], s54 offen sc1
  v_mfma_f32_16x16x32_bf16 v[36:39], v[136:139], a[232:235], v[36:39]
  ds_read_b128 v[236:239], v0 offset:0
  v_add_u32 v242, s44, v0
  ds_read_b64 v[240:241], v242 offset:1024
  v_lshl_add_u32 v243, v13, 1, v1
  ds_read_b128 v[244:247], v243 offset:384
  ds_read_b128 v[248:251], v243 offset:400
  ds_read_b128 v[252:255], v243 offset:416
  v_mfma_f32_16x16x32_bf16 v[32:35], v[132:135], a[236:239], v[32:35]
  v_mfma_f32_16x16x32_bf16 v[36:39], v[128:131], a[236:239], v[36:39]
  s_waitcnt lgkmcnt(7)
  v_mfma_f32_16x16x32_bf16 v[32:35], v[124:127], a[240:243], v[32:35]
  buffer_load_dwordx4 v[168:171], v3, s[4:7], s96 offen offset:1024 sc1
  s_add_u32 s63, s68, 12288
  v_mfma_f32_16x16x32_bf16 v[36:39], v[120:123], a[240:243], v[36:39]
  s_cmp_eq_u32 s20, 3
  s_cselect_b32 s63, 0x7ff00000, s63
  v_mfma_f32_16x16x32_bf16 v[32:35], v[116:119], a[244:247], v[32:35]
  s_waitcnt lgkmcnt(0)
  s_add_u32 s60, s43, -1
  v_and_b32 v240, s60, v240
  v_and_b32 v241, s60, v241
  v_mfma_f32_16x16x32_bf16 v[36:39], v[112:115], a[244:247], v[36:39]
  v_lshlrev_b32 v216, 16, v236
  v_add_f32 v216, v216, v244
  v_mfma_f32_16x16x32_bf16 v[32:35], v[108:111], a[248:251], v[32:35]
  buffer_load_dwordx4 v[172:175], v3, s[4:7], s97 offen offset:1024 sc1
  v_and_b32 v217, 0xffff0000, v236
  v_mfma_f32_16x16x32_bf16 v[36:39], v[104:107], a[248:251], v[36:39]
  v_add_f32 v217, v217, v245
  v_lshlrev_b32 v218, 16, v237
  v_mfma_f32_16x16x32_bf16 v[32:35], v[100:103], a[252:255], v[32:35]
  v_add_f32 v218, v218, v246
  v_and_b32 v219, 0xffff0000, v237
  v_mfma_f32_16x16x32_bf16 v[36:39], v[96:99], a[252:255], v[36:39]
  v_add_f32 v219, v219, v247
  v_lshlrev_b32 v220, 16, v238
  buffer_load_dwordx4 v[176:179], v3, s[4:7], s96 offen offset:2048 sc1
  buffer_load_dwordx4 v[180:183], v3, s[4:7], s97 offen offset:2048 sc1
  buffer_load_dwordx4 v[184:187], v3, s[4:7], s96 offen offset:3072 sc1
  buffer_load_dwordx4 v[188:191], v3, s[4:7], s97 offen offset:3072 sc1
  s_add_u32 s96, s96, 4096
  buffer_load_dwordx4 v[192:195], v3, s[4:7], s96 offen offset:0 sc1
  s_add_u32 s97, s97, 4096
  buffer_load_dwordx4 v[196:199], v3, s[4:7], s97 offen offset:0 sc1
  ds_read_b64 v[70:71], v23 offset:896
  s_waitcnt lgkmcnt(0)
  s_add_u32 s54, s70, s27
  s_add_u32 s54, s54, 0
  v_fma_f32 v56, -v71, v40, v48
  v_fma_f32 v57, -v71, v41, v49
  v_fma_f32 v58, -v71, v42, v50
  v_fma_f32 v59, -v71, v43, v51
  v_fma_f32 v60, -v71, v44, v52
  v_fma_f32 v61, -v71, v45, v53
  v_fma_f32 v62, -v71, v46, v54
  v_fma_f32 v63, -v71, v47, v55
  v_fma_f32 v56, v32, v70, v56
  v_fma_f32 v57, v33, v70, v57
  v_fma_f32 v58, v34, v70, v58
  v_fma_f32 v59, v35, v70, v59
  v_fma_f32 v60, v36, v70, v60
  v_fma_f32 v61, v37, v70, v61
  v_fma_f32 v62, v38, v70, v62
  v_fma_f32 v63, v39, v70, v63
  v_mul_f32 v56, v56, |v56|
  v_mul_f32 v57, v57, |v57|
  v_mul_f32 v58, v58, |v58|
  v_mul_f32 v59, v59, |v59|
  v_mul_f32 v60, v60, |v60|
  v_mul_f32 v61, v61, |v61|
  v_mul_f32 v62, v62, |v62|
  v_mul_f32 v63, v63, |v63|
  v_cvt_pk_bf16_f32 v64, v56, v57
  v_cvt_pk_bf16_f32 v65, v58, v59
  v_cvt_pk_bf16_f32 v66, v60, v61
  v_cvt_pk_bf16_f32 v67, v62, v63
  v_pk_max_i16 v64, v64, 0
  v_pk_max_i16 v65, v65, 0
  v_pk_max_i16 v66, v66, 0
  v_pk_max_i16 v67, v67, 0
  buffer_store_dwordx4 v[64:67], v3, s[4:7], s54 offen sc1
  v_add_f32 v220, v220, v248
  v_and_b32 v221, 0xffff0000, v238
  v_add_f32 v221, v221, v249
  v_lshlrev_b32 v222, 16, v239
  v_add_f32 v222, v222, v250
  v_and_b32 v223, 0xffff0000, v239
  v_add_f32 v223, v223, v251
  v_lshlrev_b32 v232, 16, v240
  v_add_f32 v232, v232, v252
  v_and_b32 v233, 0xffff0000, v240
  v_add_f32 v233, v233, v253
  v_lshlrev_b32 v234, 16, v241
  v_add_f32 v234, v234, v254
  v_and_b32 v235, 0xffff0000, v241
  v_add_f32 v235, v235, v255
  buffer_load_dwordx4 v[200:203], v3, s[4:7], s96 offen offset:1024 sc1
  buffer_load_dwordx4 v[204:207], v3, s[4:7], s97 offen offset:1024 sc1
  buffer_load_dwordx4 v[208:211], v3, s[4:7], s96 offen offset:2048 sc1
  buffer_load_dwordx4 v[212:215], v3, s[4:7], s97 offen offset:2048 sc1
  s_waitcnt vmcnt(14)
  v_mfma_f32_16x16x32_bf16 v[216:219], a[0:3], v[160:163], v[216:219]
  ds_read_b128 v[48:51], v0 offset:8192
  v_add_u32 v54, s44, v0
  ds_read_b64 v[52:53], v54 offset:9216
  v_lshl_add_u32 v55, v13, 1, v1
  ds_read_b128 v[56:59], v55 offset:384
  ds_read_b128 v[60:63], v55 offset:400
  ds_read_b128 v[64:67], v55 offset:416
  v_mfma_f32_16x16x32_bf16 v[220:223], a[4:7], v[160:163], v[220:223]
  v_mfma_f32_16x16x32_bf16 v[224:227], a[8:11], v[160:163], 0
  v_mfma_f32_16x16x32_bf16 v[228:231], a[12:15], v[160:163], 0
  buffer_load_dwordx4 v[136:139], v3, s[4:7], s63 offen offset:0
  s_add_u32 s63, s64, 12288
  v_mfma_f32_16x16x32_bf16 v[232:235], a[16:19], v[160:163], v[232:235]
  s_cmp_eq_u32 s20, 3
  s_cselect_b32 s63, 0x7ff00000, s63
  v_mfma_f32_16x16x32_bf16 v[236:239], a[0:3], v[164:167], 0
  s_waitcnt lgkmcnt(0)
  s_add_u32 s60, s43, -1
  v_and_b32 v52, s60, v52
  v_and_b32 v53, s60, v53
  v_mfma_f32_16x16x32_bf16 v[240:243], a[4:7], v[164:167], 0
  v_lshlrev_b32 v96, 16, v48
  v_add_f32 v96, v96, v56
  v_mfma_f32_16x16x32_bf16 v[244:247], a[8:11], v[164:167], 0
  buffer_load_dwordx4 v[140:143], v3, s[4:7], s63 offen offset:1024
  s_add_u32 s63, s65, 12288
  v_mfma_f32_16x16x32_bf16 v[248:251], a[12:15], v[164:167], 0
  s_cmp_eq_u32 s20, 3
  s_cselect_b32 s63, 0x7ff00000, s63
  v_mfma_f32_16x16x32_bf16 v[252:255], a[16:19], v[164:167], 0
  v_and_b32 v97, 0xffff0000, v48
  v_add_f32 v97, v97, v57
  buffer_load_dwordx4 v[160:163], v3, s[4:7], s96 offen offset:3072 sc1
  buffer_load_dwordx4 v[164:167], v3, s[4:7], s97 offen offset:3072 sc1
  s_waitcnt vmcnt(15)
  v_mfma_f32_16x16x32_bf16 v[216:219], a[20:23], v[168:171], v[216:219]
  v_lshlrev_b32 v98, 16, v49
  v_add_f32 v98, v98, v58
  v_mfma_f32_16x16x32_bf16 v[220:223], a[24:27], v[168:171], v[220:223]
  v_and_b32 v99, 0xffff0000, v49
  v_add_f32 v99, v99, v59
  v_mfma_f32_16x16x32_bf16 v[224:227], a[28:31], v[168:171], v[224:227]
  v_lshlrev_b32 v100, 16, v50
  v_add_f32 v100, v100, v60
  v_mfma_f32_16x16x32_bf16 v[228:231], a[32:35], v[168:171], v[228:231]
  buffer_load_dwordx4 v[144:147], v3, s[4:7], s63 offen offset:1024
  s_add_u32 s63, s66, 12288
  v_mfma_f32_16x16x32_bf16 v[232:235], a[36:39], v[168:171], v[232:235]
  s_cmp_eq_u32 s20, 3
  s_cselect_b32 s63, 0x7ff00000, s63
  v_mfma_f32_16x16x32_bf16 v[236:239], a[20:23], v[172:175], v[236:239]
  v_and_b32 v101, 0xffff0000, v50
  v_add_f32 v101, v101, v61
  v_mfma_f32_16x16x32_bf16 v[240:243], a[24:27], v[172:175], v[240:243]
  v_lshlrev_b32 v102, 16, v51
  v_add_f32 v102, v102, v62
  v_mfma_f32_16x16x32_bf16 v[244:247], a[28:31], v[172:175], v[244:247]
  buffer_load_dwordx4 v[148:151], v3, s[4:7], s63 offen offset:1024
  s_add_u32 s63, s67, 12288
  v_mfma_f32_16x16x32_bf16 v[248:251], a[32:35], v[172:175], v[248:251]
  s_cmp_eq_u32 s20, 3
  s_cselect_b32 s63, 0x7ff00000, s63
  v_mfma_f32_16x16x32_bf16 v[252:255], a[36:39], v[172:175], v[252:255]
  v_and_b32 v103, 0xffff0000, v51
  v_add_f32 v103, v103, v63
  s_add_u32 s96, s96, 4096
  buffer_load_dwordx4 v[168:171], v3, s[4:7], s96 offen offset:0 sc1
  s_add_u32 s97, s97, 4096
  buffer_load_dwordx4 v[172:175], v3, s[4:7], s97 offen offset:0 sc1
  s_waitcnt vmcnt(17)
  v_mfma_f32_16x16x32_bf16 v[216:219], a[40:43], v[176:179], v[216:219]
  v_lshlrev_b32 v112, 16, v52
  v_add_f32 v112, v112, v64
  v_mfma_f32_16x16x32_bf16 v[220:223], a[44:47], v[176:179], v[220:223]
  v_and_b32 v113, 0xffff0000, v52
  v_add_f32 v113, v113, v65
  v_mfma_f32_16x16x32_bf16 v[224:227], a[48:51], v[176:179], v[224:227]
  v_lshlrev_b32 v114, 16, v53
  v_add_f32 v114, v114, v66
  v_mfma_f32_16x16x32_bf16 v[228:231], a[52:55], v[176:179], v[228:231]
  buffer_load_dwordx4 v[152:155], v3, s[4:7], s63 offen offset:1024
  s_add_u32 s63, s68, 12288
  v_mfma_f32_16x16x32_bf16 v[232:235], a[56:59], v[176:179], v[232:235]
  s_cmp_eq_u32 s20, 3
  s_cselect_b32 s63, 0x7ff00000, s63
  v_mfma_f32_16x16x32_bf16 v[236:239], a[40:43], v[180:183], v[236:239]
  v_and_b32 v115, 0xffff0000, v53
  v_add_f32 v115, v115, v67
  v_mfma_f32_16x16x32_bf16 v[240:243], a[44:47], v[180:183], v[240:243]
  v_mfma_f32_16x16x32_bf16 v[244:247], a[48:51], v[180:183], v[244:247]
  buffer_load_dwordx4 v[156:159], v3, s[4:7], s63 offen offset:1024
  s_add_u32 s63, s65, 8192
  v_mfma_f32_16x16x32_bf16 v[248:251], a[52:55], v[180:183], v[248:251]
  v_mfma_f32_16x16x32_bf16 v[252:255], a[56:59], v[180:183], v[252:255]
  s_waitcnt vmcnt(14)
  s_barrier
  s_cmp_lg_u32 s20, 0
  s_cbranch_scc1 Lf28
  s_add_u32 s62, s100, s28
  s_add_u32 s62, s62, 7168
  s_lshl_b32 s61, s22, 2
  s_add_u32 s62, s62, s61
  s_mov_b64 exec, 1
  s_cmp_eq_u32 s12, 1
  s_cbranch_scc1 Ldb29
  buffer_store_dword v86, v87, s[4:7], s62 offen sc1
  s_branch Lde29
Ldb29:
  buffer_store_dword v86, v87, s[4:7], s62 offen
Lde29:
  s_mov_b64 exec, -1
Lf28:
  buffer_load_dwordx4 v[176:179], v3, s[4:7], s96 offen offset:1024 sc1
  buffer_load_dwordx4 v[180:183], v3, s[4:7], s97 offen offset:1024 sc1
  v_mfma_f32_16x16x32_bf16 v[216:219], a[60:63], v[184:187], v[216:219]
  v_mfma_f32_16x16x32_bf16 v[220:223], a[64:67], v[184:187], v[220:223]
  v_mfma_f32_16x16x32_bf16 v[224:227], a[68:71], v[184:187], v[224:227]
  v_mfma_f32_16x16x32_bf16 v[228:231], a[72:75], v[184:187], v[228:231]
  buffer_load_dwordx4 a[224:227], v3, s[4:7], s63 offen offset:3072
  s_add_u32 s63, s66, 8192
  v_mfma_f32_16x16x32_bf16 v[232:235], a[76:79], v[184:187], v[232:235]
  v_mfma_f32_16x16x32_bf16 v[236:239], a[60:63], v[188:191], v[236:239]
  v_mfma_f32_16x16x32_bf16 v[240:243], a[64:67], v[188:191], v[240:243]
  v_mfma_f32_16x16x32_bf16 v[244:247], a[68:71], v[188:191], v[244:247]
  buffer_load_dwordx4 a[228:231], v3, s[4:7], s63 offen offset:3072
  s_add_u32 s63, s67, 8192
  v_mfma_f32_16x16x32_bf16 v[248:251], a[72:75], v[188:191], v[248:251]
  v_mfma_f32_16x16x32_bf16 v[252:255], a[76:79], v[188:191], v[252:255]
  buffer_load_dwordx4 v[184:187], v3, s[4:7], s96 offen offset:2048 sc1
  buffer_load_dwordx4 v[188:191], v3, s[4:7], s97 offen offset:2048 sc1
  v_mfma_f32_16x16x32_bf16 v[216:219], a[80:83], v[192:195], v[216:219]
  v_mfma_f32_16x16x32_bf16 v[220:223], a[84:87], v[192:195], v[220:223]
  v_mfma_f32_16x16x32_bf16 v[224:227], a[88:91], v[192:195], v[224:227]
  v_mfma_f32_16x16x32_bf16 v[228:231], a[92:95], v[192:195], v[228:231]
  buffer_load_dwordx4 a[232:235], v3, s[4:7], s63 offen offset:3072
  s_add_u32 s63, s68, 8192
  v_mfma_f32_16x16x32_bf16 v[232:235], a[96:99], v[192:195], v[232:235]
  v_mfma_f32_16x16x32_bf16 v[236:239], a[80:83], v[196:199], v[236:239]
  v_mfma_f32_16x16x32_bf16 v[240:243], a[84:87], v[196:199], v[240:243]
  v_mfma_f32_16x16x32_bf16 v[244:247], a[88:91], v[196:199], v[244:247]
  buffer_load_dwordx4 a[236:239], v3, s[4:7], s63 offen offset:3072
  s_add_u32 s63, s64, 12288
  v_mfma_f32_16x16x32_bf16 v[248:251], a[92:95], v[196:199], v[248:251]
  s_cmp_eq_u32 s20, 3
  s_cselect_b32 s63, 0x7ff00000, s63
  v_mfma_f32_16x16x32_bf16 v[252:255], a[96:99], v[196:199], v[252:255]
  buffer_load_dwordx4 v[192:195], v3, s[4:7], s96 offen offset:3072 sc1
  buffer_load_dwordx4 v[196:199], v3, s[4:7], s97 offen offset:3072 sc1
  s_waitcnt vmcnt(22)
  v_mfma_f32_16x16x32_bf16 v[216:219], a[100:103], v[200:203], v[216:219]
  v_mfma_f32_16x16x32_bf16 v[220:223], a[104:107], v[200:203], v[220:223]
  v_mfma_f32_16x16x32_bf16 v[224:227], a[108:111], v[200:203], v[224:227]
  v_mfma_f32_16x16x32_bf16 v[228:231], a[112:115], v[200:203], v[228:231]
  buffer_load_dwordx4 a[240:243], v3, s[4:7], s63 offen offset:0
  s_add_u32 s63, s65, 12288
  v_mfma_f32_16x16x32_bf16 v[232:235], a[116:119], v[200:203], v[232:235]
  s_cmp_eq_u32 s20, 3
  s_cselect_b32 s63, 0x7ff00000, s63
  v_mfma_f32_16x16x32_bf16 v[236:239], a[100:103], v[204:207], v[236:239]
  v_mfma_f32_16x16x32_bf16 v[240:243], a[104:107], v[204:207], v[240:243]
  v_mfma_f32_16x16x32_bf16 v[244:247], a[108:111], v[204:207], v[244:247]
  buffer_load_dwordx4 a[244:247], v3, s[4:7], s63 offen offset:0
  s_add_u32 s63, s66, 12288
  v_mfma_f32_16x16x32_bf16 v[248:251], a[112:115], v[204:207], v[248:251]
  s_cmp_eq_u32 s20, 3
  s_cselect_b32 s63, 0x7ff00000, s63
  v_mfma_f32_16x16x32_bf16 v[252:255], a[116:119], v[204:207], v[252:255]
  s_add_u32 s96, s96, 4096
  s_cmp_eq_u32 s20, 3
  s_cselect_b32 s96, 0x7ff00000, s96
  buffer_load_dwordx4 v[200:203], v3, s[4:7], s96 offen offset:0 sc1
  s_add_u32 s97, s97, 4096
  s_cmp_eq_u32 s20, 3
  s_cselect_b32 s97, 0x7ff00000, s97
  buffer_load_dwordx4 v[204:207], v3, s[4:7], s97 offen offset:0 sc1
  s_waitcnt vmcnt(24)
  v_mfma_f32_16x16x32_bf16 v[216:219], a[120:123], v[208:211], v[216:219]
  v_mfma_f32_16x16x32_bf16 v[220:223], a[124:127], v[208:211], v[220:223]
  v_mfma_f32_16x16x32_bf16 v[224:227], a[128:131], v[208:211], v[224:227]
  v_mfma_f32_16x16x32_bf16 v[228:231], a[132:135], v[208:211], v[228:231]
  buffer_load_dwordx4 a[248:251], v3, s[4:7], s63 offen offset:0
  s_add_u32 s63, s67, 12288
  v_mfma_f32_16x16x32_bf16 v[232:235], a[136:139], v[208:211], v[232:235]
  s_cmp_eq_u32 s20, 3
  s_cselect_b32 s63, 0x7ff00000, s63
  v_mfma_f32_16x16x32_bf16 v[236:239], a[120:123], v[212:215], v[236:239]
  v_mfma_f32_16x16x32_bf16 v[240:243], a[124:127], v[212:215], v[240:243]
  v_mfma_f32_16x16x32_bf16 v[244:247], a[128:131], v[212:215], v[244:247]
  buffer_load_dwordx4 a[252:255], v3, s[4:7], s63 offen offset:0
  v_mfma_f32_16x16x32_bf16 v[248:251], a[132:135], v[212:215], v[248:251]
  v_mfma_f32_16x16x32_bf16 v[252:255], a[136:139], v[212:215], v[252:255]
  buffer_load_dwordx4 v[208:211], v3, s[4:7], s96 offen offset:1024 sc1
  buffer_load_dwordx4 v[212:215], v3, s[4:7], s97 offen offset:1024 sc1
  s_waitcnt vmcnt(24)
  v_mfma_f32_16x16x32_bf16 v[216:219], a[140:143], v[160:163], v[216:219]
  v_mfma_f32_16x16x32_bf16 v[220:223], a[144:147], v[160:163], v[220:223]
  v_mfma_f32_16x16x32_bf16 v[224:227], a[148:151], v[160:163], v[224:227]
  v_mfma_f32_16x16x32_bf16 v[228:231], a[152:155], v[160:163], v[228:231]
  v_mfma_f32_16x16x32_bf16 v[232:235], a[156:159], v[160:163], v[232:235]
  v_mfma_f32_16x16x32_bf16 v[236:239], a[140:143], v[164:167], v[236:239]
  v_mfma_f32_16x16x32_bf16 v[240:243], a[144:147], v[164:167], v[240:243]
  v_mfma_f32_16x16x32_bf16 v[244:247], a[148:151], v[164:167], v[244:247]
  v_mfma_f32_16x16x32_bf16 v[248:251], a[152:155], v[164:167], v[248:251]
  v_mfma_f32_16x16x32_bf16 v[252:255], a[156:159], v[164:167], v[252:255]
  s_add_u32 s62, s100, s28
  s_add_u32 s62, s62, 7168
  buffer_load_dword v84, v5, s[4:7], s62 offen sc1
  s_waitcnt vmcnt(21)
  v_mfma_f32_16x16x32_bf16 v[216:219], a[160:163], v[168:171], v[216:219]
  v_mfma_f32_16x16x32_bf16 v[220:223], a[164:167], v[168:171], v[220:223]
  v_mfma_f32_16x16x32_bf16 v[224:227], a[168:171], v[168:171], v[224:227]
  v_mfma_f32_16x16x32_bf16 v[228:231], a[172:175], v[168:171], v[228:231]
  v_mfma_f32_16x16x32_bf16 v[232:235], a[176:179], v[168:171], v[232:235]
  v_mfma_f32_16x16x32_bf16 v[236:239], a[160:163], v[172:175], v[236:239]
  v_mfma_f32_16x16x32_bf16 v[240:243], a[164:167], v[172:175], v[240:243]
  v_mfma_f32_16x16x32_bf16 v[244:247], a[168:171], v[172:175], v[244:247]
  v_mfma_f32_16x16x32_bf16 v[248:251], a[172:175], v[172:175], v[248:251]
  v_mfma_f32_16x16x32_bf16 v[252:255], a[176:179], v[172:175], v[252:255]
  s_waitcnt vmcnt(17)
  v_mfma_f32_16x16x32_bf16 v[216:219], a[180:183], v[176:179], v[216:219]
  v_mfma_f32_16x16x32_bf16 v[220:223], a[184:187], v[176:179], v[220:223]
  v_mfma_f32_16x16x32_bf16 v[224:227], a[188:191], v[176:179], v[224:227]
  v_mfma_f32_16x16x32_bf16 v[228:231], a[192:195], v[176:179], v[228:231]
  v_mfma_f32_16x16x32_bf16 v[232:235], a[196:199], v[176:179], v[232:235]
  v_mfma_f32_16x16x32_bf16 v[236:239], a[180:183], v[180:183], v[236:239]
  v_mfma_f32_16x16x32_bf16 v[240:243], a[184:187], v[180:183], v[240:243]
  v_mfma_f32_16x16x32_bf16 v[244:247], a[188:191], v[180:183], v[244:247]
  v_mfma_f32_16x16x32_bf16 v[248:251], a[192:195], v[180:183], v[248:251]
  v_mfma_f32_16x16x32_bf16 v[252:255], a[196:199], v[180:183], v[252:255]
  s_cmp_lg_u32 s20, 0
  s_cbranch_scc1 Lpd30
  s_waitcnt vmcnt(0)
  v_cmp_ne_u32 vcc, 1, v84
  s_cbranch_vccz Lpd30
  s_add_u32 s62, s100, s28
  s_add_u32 s62, s62, 7168
  s_mov_b32 s61, 0
Lp30:
  buffer_load_dword v84, v5, s[4:7], s62 offen sc1
  s_add_u32 s61, s61, 1
  s_cmp_gt_u32 s61, 0x100000
  s_cbranch_scc1 Lpd30
  s_waitcnt vmcnt(0)
  v_cmp_ne_u32 vcc, 1, v84
  s_cbranch_vccnz Lp30
Lpd30:
  s_barrier
  buffer_load_dwordx4 v[160:163], v3, s[4:7], s98 offen offset:0 sc1
  buffer_load_dwordx4 v[164:167], v3, s[4:7], s99 offen offset:0 sc1
  buffer_load_dwordx4 v[168:171], v3, s[4:7], s98 offen offset:1024 sc1
  buffer_load_dwordx4 v[172:175], v3, s[4:7], s99 offen offset:1024 sc1
  buffer_load_dwordx4 v[176:179], v3, s[4:7], s98 offen offset:2048 sc1
  buffer_load_dwordx4 v[180:183], v3, s[4:7], s99 offen offset:2048 sc1
  s_waitcnt vmcnt(19)
  v_mfma_f32_16x16x32_bf16 v[216:219], a[200:203], v[184:187], v[216:219]
  v_mfma_f32_16x16x32_bf16 v[220:223], a[204:207], v[184:187], v[220:223]
  v_mfma_f32_16x16x32_bf16 v[224:227], a[208:211], v[184:187], v[224:227]
  v_mfma_f32_16x16x32_bf16 v[228:231], a[212:215], v[184:187], v[228:231]
  v_mfma_f32_16x16x32_bf16 v[232:235], a[216:219], v[184:187], v[232:235]
  v_mfma_f32_16x16x32_bf16 v[236:239], a[200:203], v[188:191], v[236:239]
  v_mfma_f32_16x16x32_bf16 v[240:243], a[204:207], v[188:191], v[240:243]
  v_mfma_f32_16x16x32_bf16 v[244:247], a[208:211], v[188:191], v[244:247]
  v_mfma_f32_16x16x32_bf16 v[248:251], a[212:215], v[188:191], v[248:251]
  v_mfma_f32_16x16x32_bf16 v[252:255], a[216:219], v[188:191], v[252:255]
  buffer_load_dwordx4 v[184:187], v3, s[4:7], s98 offen offset:3072 sc1
  buffer_load_dwordx4 v[188:191], v3, s[4:7], s99 offen offset:3072 sc1
  s_waitcnt vmcnt(17)
  v_mfma_f32_16x16x32_bf16 v[216:219], a[220:223], v[192:195], v[216:219]
  v_mfma_f32_16x16x32_bf16 v[220:223], a[224:227], v[192:195], v[220:223]
  v_mfma_f32_16x16x32_bf16 v[224:227], a[228:231], v[192:195], v[224:227]
  v_mfma_f32_16x16x32_bf16 v[228:231], a[232:235], v[192:195], v[228:231]
  v_mfma_f32_16x16x32_bf16 v[232:235], a[236:239], v[192:195], v[232:235]
  v_mfma_f32_16x16x32_bf16 v[236:239], a[220:223], v[196:199], v[236:239]
  v_mfma_f32_16x16x32_bf16 v[240:243], a[224:227], v[196:199], v[240:243]
  v_mfma_f32_16x16x32_bf16 v[244:247], a[228:231], v[196:199], v[244:247]
  v_mfma_f32_16x16x32_bf16 v[248:251], a[232:235], v[196:199], v[248:251]
  v_mfma_f32_16x16x32_bf16 v[252:255], a[236:239], v[196:199], v[252:255]
  s_add_u32 s98, s98, 4096
  buffer_load_dwordx4 v[192:195], v3, s[4:7], s98 offen offset:0 sc1
  s_add_u32 s99, s99, 4096
  buffer_load_dwordx4 v[196:199], v3, s[4:7], s99 offen offset:0 sc1
  s_waitcnt vmcnt(15)
  s_waitcnt vmcnt(13)
  v_mfma_f32_16x16x32_bf16 v[216:219], a[240:243], v[200:203], v[216:219]
  v_mfma_f32_16x16x32_bf16 v[220:223], a[244:247], v[200:203], v[220:223]
  v_mfma_f32_16x16x32_bf16 v[224:227], a[248:251], v[200:203], v[224:227]
  v_mfma_f32_16x16x32_bf16 v[228:231], a[252:255], v[200:203], v[228:231]
  v_mfma_f32_16x16x32_bf16 v[232:235], v[136:139], v[200:203], v[232:235]
  v_mfma_f32_16x16x32_bf16 v[236:239], a[240:243], v[204:207], v[236:239]
  v_mfma_f32_16x16x32_bf16 v[240:243], a[244:247], v[204:207], v[240:243]
  v_mfma_f32_16x16x32_bf16 v[244:247], a[248:251], v[204:207], v[244:247]
  v_mfma_f32_16x16x32_bf16 v[248:251], a[252:255], v[204:207], v[248:251]
  v_mfma_f32_16x16x32_bf16 v[252:255], v[136:139], v[204:207], v[252:255]
  buffer_load_dwordx4 v[200:203], v3, s[4:7], s98 offen offset:1024 sc1
  buffer_load_dwordx4 v[204:207], v3, s[4:7], s99 offen offset:1024 sc1
  s_waitcnt vmcnt(13)
  v_mfma_f32_16x16x32_bf16 v[216:219], v[140:143], v[208:211], v[216:219]
  v_mfma_f32_16x16x32_bf16 v[220:223], v[144:147], v[208:211], v[220:223]
  v_mfma_f32_16x16x32_bf16 v[224:227], v[148:151], v[208:211], v[224:227]
  v_mfma_f32_16x16x32_bf16 v[228:231], v[152:155], v[208:211], v[228:231]
  v_mfma_f32_16x16x32_bf16 v[232:235], v[156:159], v[208:211], v[232:235]
  v_mfma_f32_16x16x32_bf16 v[236:239], v[140:143], v[212:215], v[236:239]
  v_mfma_f32_16x16x32_bf16 v[240:243], v[144:147], v[212:215], v[240:243]
  v_mfma_f32_16x16x32_bf16 v[244:247], v[148:151], v[212:215], v[244:247]
  v_mfma_f32_16x16x32_bf16 v[248:251], v[152:155], v[212:215], v[248:251]
  v_mfma_f32_16x16x32_bf16 v[252:255], v[156:159], v[212:215], v[252:255]
  buffer_load_dwordx4 v[208:211], v3, s[4:7], s98 offen offset:2048 sc1
  buffer_load_dwordx4 v[212:215], v3, s[4:7], s99 offen offset:2048 sc1
  s_waitcnt vmcnt(12)
  v_mfma_f32_16x16x32_bf16 v[96:99], a[0:3], v[160:163], v[96:99]
  ds_write_b128 v16, v[236:239] offset:0
  ds_write_b128 v16, v[240:243] offset:1024
  v_mfma_f32_16x16x32_bf16 v[100:103], a[4:7], v[160:163], v[100:103]
  ds_write_b128 v17, v[224:227] offset:0
  ds_write_b128 v17, v[228:231] offset:1024
  v_mfma_f32_16x16x32_bf16 v[104:107], a[8:11], v[160:163], 0
  ds_write_b128 v18, v[244:247] offset:0
  ds_write_b128 v18, v[248:251] offset:1024
  v_mfma_f32_16x16x32_bf16 v[108:111], a[12:15], v[160:163], 0
  ds_write_b128 v17, v[232:235] offset:2048
  ds_write_b128 v19, v[252:255] offset:2048
  v_mfma_f32_16x16x32_bf16 v[112:115], a[16:19], v[160:163], v[112:115]
  s_waitcnt lgkmcnt(0)
  s_barrier
  v_mfma_f32_16x16x32_bf16 v[116:119], a[0:3], v[164:167], 0
  ds_read_b128 v[36:39], v20 offset:0
  ds_read_b128 v[40:43], v20 offset:1024
  v_mfma_f32_16x16x32_bf16 v[120:123], a[4:7], v[164:167], 0
  ds_read_b128 v[44:47], v20 offset:2048
  ds_read_b128 v[48:51], v20 offset:3072
  v_mfma_f32_16x16x32_bf16 v[124:127], a[8:11], v[164:167], 0
  ds_read_b128 v[52:55], v20 offset:4096
  ds_read_b128 v[56:59], v20 offset:5120
  v_mfma_f32_16x16x32_bf16 v[128:131], a[12:15], v[164:167], 0
  v_mov_b32 v68, 0x3f803f80
  v_mov_b32 v66, 0
  v_mfma_f32_16x16x32_bf16 v[132:135], a[16:19], v[164:167], 0
  v_mov_b32 v67, 0
  buffer_load_dwordx4 v[160:163], v3, s[4:7], s98 offen offset:3072 sc1
  buffer_load_dwordx4 v[164:167], v3, s[4:7], s99 offen offset:3072 sc1
  s_waitcnt vmcnt(12)
  v_mfma_f32_16x16x32_bf16 v[96:99], a[20:23], v[168:171], v[96:99]
  s_add_u32 s63, s31, 0
  v_mfma_f32_16x16x32_bf16 v[100:103], a[24:27], v[168:171], v[100:103]
  v_mfma_f32_16x16x32_bf16 v[104:107], a[28:31], v[168:171], v[104:107]
  v_mfma_f32_16x16x32_bf16 v[108:111], a[32:35], v[168:171], v[108:111]
  s_waitcnt lgkmcnt(3)
  v_add_f32 v216, v216, v36
  v_add_f32 v217, v217, v37
  v_mfma_f32_16x16x32_bf16 v[112:115], a[36:39], v[168:171], v[112:115]
  v_add_f32 v218, v218, v38
  v_add_f32 v219, v219, v39
  v_mfma_f32_16x16x32_bf16 v[116:119], a[20:23], v[172:175], v[116:119]
  v_add_f32 v220, v220, v40
  v_add_f32 v221, v221, v41
  v_mfma_f32_16x16x32_bf16 v[120:123], a[24:27], v[172:175], v[120:123]
  v_add_f32 v222, v222, v42
  v_add_f32 v223, v223, v43
  v_mfma_f32_16x16x32_bf16 v[124:127], a[28:31], v[172:175], v[124:127]
  v_add_f32 v232, v232, v44
  v_add_f32 v233, v233, v45
  v_mfma_f32_16x16x32_bf16 v[128:131], a[32:35], v[172:175], v[128:131]
  v_add_f32 v234, v234, v46
  v_add_f32 v235, v235, v47
  v_mfma_f32_16x16x32_bf16 v[132:135], a[36:39], v[172:175], v[132:135]
  ds_read_b128 v[36:39], v20 offset:6144
  ds_read_b128 v[40:43], v20 offset:7168
  s_add_u32 s98, s98, 4096
  buffer_load_dwordx4 v[168:171], v3, s[4:7], s98 offen offset:0 sc1
  s_add_u32 s99, s99, 4096
  buffer_load_dwordx4 v[172:175], v3, s[4:7], s99 offen offset:0 sc1
  s_waitcnt vmcnt(12)
  v_mfma_f32_16x16x32_bf16 v[96:99], a[40:43], v[176:179], v[96:99]
  ds_read_b128 v[44:47], v20 offset:8192
  s_waitcnt lgkmcnt(3)
  v_mfma_f32_16x16x32_bf16 v[100:103], a[44:47], v[176:179], v[100:103]
  v_add_f32 v216, v216, v48
  v_add_f32 v217, v217, v49
  v_mfma_f32_16x16x32_bf16 v[104:107], a[48:51], v[176:179], v[104:107]
  v_add_f32 v218, v218, v50
  v_add_f32 v219, v219, v51
  v_mfma_f32_16x16x32_bf16 v[108:111], a[52:55], v[176:179], v[108:111]
  v_add_f32 v220, v220, v52
  v_add_f32 v221, v221, v53
  v_mfma_f32_16x16x32_bf16 v[112:115], a[56:59], v[176:179], v[112:115]
  v_add_f32 v222, v222, v54
  v_add_f32 v223, v223, v55
  v_mfma_f32_16x16x32_bf16 v[116:119], a[40:43], v[180:183], v[116:119]
  v_add_f32 v232, v232, v56
  v_add_f32 v233, v233, v57
  v_mfma_f32_16x16x32_bf16 v[120:123], a[44:47], v[180:183], v[120:123]
  v_add_f32 v234, v234, v58
  v_add_f32 v235, v235, v59
  v_mfma_f32_16x16x32_bf16 v[124:127], a[48:51], v[180:183], v[124:127]
  s_waitcnt lgkmcnt(0)
  v_add_f32 v216, v216, v36
  v_add_f32 v217, v217, v37
  v_mfma_f32_16x16x32_bf16 v[128:131], a[52:55], v[180:183], v[128:131]
  v_add_f32 v218, v218, v38
  v_add_f32 v219, v219, v39
  v_mfma_f32_16x16x32_bf16 v[132:135], a[56:59], v[180:183], v[132:135]
  v_add_f32 v220, v220, v40
  v_add_f32 v221, v221, v41
  buffer_load_dwordx4 v[176:179], v3, s[4:7], s98 offen offset:1024 sc1
  buffer_load_dwordx4 v[180:183], v3, s[4:7], s99 offen offset:1024 sc1
  s_waitcnt vmcnt(12)
  v_mfma_f32_16x16x32_bf16 v[96:99], a[60:63], v[184:187], v[96:99]
  v_add_f32 v222, v222, v42
  v_add_f32 v223, v223, v43
  v_mfma_f32_16x16x32_bf16 v[100:103], a[64:67], v[184:187], v[100:103]
  v_add_f32 v232, v232, v44
  v_add_f32 v233, v233, v45
  v_mfma_f32_16x16x32_bf16 v[104:107], a[68:71], v[184:187], v[104:107]
  v_add_f32 v234, v234, v46
  v_add_f32 v235, v235, v47
  v_mfma_f32_16x16x32_bf16 v[108:111], a[72:75], v[184:187], v[108:111]
  v_cvt_pk_bf16_f32 v60, v216, v217
  v_cvt_pk_bf16_f32 v61, v218, v219
  v_mfma_f32_16x16x32_bf16 v[112:115], a[76:79], v[184:187], v[112:115]
  v_cvt_pk_bf16_f32 v62, v220, v221
  v_cvt_pk_bf16_f32 v63, v222, v223
  v_mfma_f32_16x16x32_bf16 v[116:119], a[60:63], v[188:191], v[116:119]
  v_cvt_pk_bf16_f32 v64, v232, v233
  v_cvt_pk_bf16_f32 v65, v234, v235
  v_mfma_f32_16x16x32_bf16 v[120:123], a[64:67], v[188:191], v[120:123]
  s_add_u32 s60, s43, -1
  v_and_b32 v64, s60, v64
  v_and_b32 v65, s60, v65
  v_mfma_f32_16x16x32_bf16 v[124:127], a[68:71], v[188:191], v[124:127]
  s_lshl_b32 s59, s34, 1
  s_add_u32 s59, s59, s45
  s_add_u32 s59, s59, s29
  s_add_u32 s59, s59, 4
  s_mul_i32 s60, s59, 20480
  s_add_u32 s60, s60, s9
  s_add_u32 s60, s60, 8388608
  s_lshl_b32 s59, s41, 10
  s_add_u32 s59, s59, s60
  s_lshl_b32 s58, s42, 10
  s_add_u32 s58, s58, s60
  s_add_u32 s58, s58, s44
  s_cmp_eq_u32 s43, 1
  s_cselect_b32 s58, 0x7ff00000, s58
  s_cmp_eq_u32 s12, 1
  s_cbranch_scc1 Ldb32
  buffer_store_dwordx4 v[60:63], v3, s[4:7], s59 offen sc1
  buffer_store_dwordx2 v[64:65], v3, s[4:7], s58 offen sc1
  s_branch Lde32
Ldb32:
  buffer_store_dwordx4 v[60:63], v3, s[4:7], s59 offen
  buffer_store_dwordx2 v[64:65], v3, s[4:7], s58 offen
Lde32:
  v_mfma_f32_16x16x32_bf16 v[128:131], a[72:75], v[188:191], v[128:131]
  v_dot2c_f32_bf16 v66, v60, v68
  v_dot2c_f32_bf16 v67, v60, v60
  v_mfma_f32_16x16x32_bf16 v[132:135], a[76:79], v[188:191], v[132:135]
  v_dot2c_f32_bf16 v66, v61, v68
  v_dot2c_f32_bf16 v67, v61, v61
  buffer_load_dwordx4 v[184:187], v3, s[4:7], s98 offen offset:2048 sc1
  buffer_load_dwordx4 v[188:191], v3, s[4:7], s99 offen offset:2048 sc1
  s_waitcnt vmcnt(14)
  v_mfma_f32_16x16x32_bf16 v[96:99], a[80:83], v[192:195], v[96:99]
  v_dot2c_f32_bf16 v66, v62, v68
  v_dot2c_f32_bf16 v67, v62, v62
  v_mfma_f32_16x16x32_bf16 v[100:103], a[84:87], v[192:195], v[100:103]
  v_dot2c_f32_bf16 v66, v63, v68
  v_dot2c_f32_bf16 v67, v63, v63
  v_mfma_f32_16x16x32_bf16 v[104:107], a[88:91], v[192:195], v[104:107]
  v_dot2c_f32_bf16 v66, v64, v68
  v_dot2c_f32_bf16 v67, v64, v64
  v_mfma_f32_16x16x32_bf16 v[108:111], a[92:95], v[192:195], v[108:111]
  v_dot2c_f32_bf16 v66, v65, v68
  v_dot2c_f32_bf16 v67, v65, v65
  v_mfma_f32_16x16x32_bf16 v[112:115], a[96:99], v[192:195], v[112:115]
  s_nop 0
  v_mov_b32 v68, v66
  v_mov_b32 v69, v67
  v_mfma_f32_16x16x32_bf16 v[116:119], a[80:83], v[196:199], v[116:119]
  v_permlane16_swap_b32 v66, v68
  v_permlane16_swap_b32 v67, v69
  v_mfma_f32_16x16x32_bf16 v[120:123], a[84:87], v[196:199], v[120:123]
  v_add_f32 v66, v66, v68
  v_add_f32 v67, v67, v69
  v_mfma_f32_16x16x32_bf16 v[124:127], a[88:91], v[196:199], v[124:127]
  v_mov_b32 v68, v66
  v_mov_b32 v69, v67
  v_mfma_f32_16x16x32_bf16 v[128:131], a[92:95], v[196:199], v[128:131]
  v_permlane32_swap_b32 v66, v68
  v_permlane32_swap_b32 v67, v69
  v_mfma_f32_16x16x32_bf16 v[132:135], a[96:99], v[196:199], v[132:135]
  v_add_f32 v66, v66, v68
  v_add_f32 v67, v67, v69
  buffer_load_dwordx4 v[192:195], v3, s[4:7], s98 offen offset:3072 sc1
  buffer_load_dwordx4 v[196:199], v3, s[4:7], s99 offen offset:3072 sc1
  s_waitcnt vmcnt(14)
  v_mfma_f32_16x16x32_bf16 v[96:99], a[100:103], v[200:203], v[96:99]
  s_lshl_b32 s59, s34, 1
  s_add_u32 s59, s59, s45
  s_add_u32 s59, s59, s29
  s_add_u32 s59, s59, 4
  s_lshl_b32 s59, s59, 11
  s_lshl_b32 s60, s35, 4
  s_add_u32 s59, s59, s60
  s_lshl_b32 s60, s43, 3
  s_add_u32 s59, s59, s60
  s_add_u32 s59, s59, s11
  s_add_u32 s59, s59, 39845888
  s_mov_b64 exec, 0xffff
  s_cmp_eq_u32 s12, 1
  s_cbranch_scc1 Ldb33
  buffer_store_dwordx2 v[66:67], v21, s[4:7], s59 offen sc1
  s_branch Lde33
Ldb33:
  buffer_store_dwordx2 v[66:67], v21, s[4:7], s59 offen
Lde33:
  s_mov_b64 exec, -1
  v_mfma_f32_16x16x32_bf16 v[100:103], a[104:107], v[200:203], v[100:103]
  ds_write_b128 v0, v[60:63] offset:0
  v_add_u32 v68, s44, v0
  ds_write_b64 v68, v[64:65] offset:1024
  v_mfma_f32_16x16x32_bf16 v[104:107], a[108:111], v[200:203], v[104:107]
  v_mfma_f32_16x16x32_bf16 v[108:111], a[112:115], v[200:203], v[108:111]
  buffer_load_dwordx4 a[0:3], v3, s[4:7], s63 offen offset:0
  s_add_u32 s63, s31, 20480
  v_mfma_f32_16x16x32_bf16 v[112:115], a[116:119], v[200:203], v[112:115]
  v_mfma_f32_16x16x32_bf16 v[116:119], a[100:103], v[204:207], v[116:119]
  v_mfma_f32_16x16x32_bf16 v[120:123], a[104:107], v[204:207], v[120:123]
  v_mfma_f32_16x16x32_bf16 v[124:127], a[108:111], v[204:207], v[124:127]
  buffer_load_dwordx4 a[4:7], v3, s[4:7], s63 offen offset:0
  s_add_u32 s63, s31, 0
  v_mfma_f32_16x16x32_bf16 v[128:131], a[112:115], v[204:207], v[128:131]
  v_mfma_f32_16x16x32_bf16 v[132:135], a[116:119], v[204:207], v[132:135]
  s_add_u32 s98, s98, 4096
  s_cmp_eq_u32 s20, 3
  s_cselect_b32 s98, 0x7ff00000, s98
  buffer_load_dwordx4 v[200:203], v3, s[4:7], s98 offen offset:0 sc1
  s_add_u32 s99, s99, 4096
  s_cmp_eq_u32 s20, 3
  s_cselect_b32 s99, 0x7ff00000, s99
  buffer_load_dwordx4 v[204:207], v3, s[4:7], s99 offen offset:0 sc1
  s_waitcnt vmcnt(17)
  v_mfma_f32_16x16x32_bf16 v[96:99], a[120:123], v[208:211], v[96:99]
  v_mfma_f32_16x16x32_bf16 v[100:103], a[124:127], v[208:211], v[100:103]
  v_mfma_f32_16x16x32_bf16 v[104:107], a[128:131], v[208:211], v[104:107]
  v_mfma_f32_16x16x32_bf16 v[108:111], a[132:135], v[208:211], v[108:111]
  buffer_load_dwordx4 a[8:11], v3, s[4:7], s63 offen offset:1024
  s_add_u32 s63, s31, 20480
  v_mfma_f32_16x16x32_bf16 v[112:115], a[136:139], v[208:211], v[112:115]
  v_mfma_f32_16x16x32_bf16 v[116:119], a[120:123], v[212:215], v[116:119]
  v_mfma_f32_16x16x32_bf16 v[120:123], a[124:127], v[212:215], v[120:123]
  v_mfma_f32_16x16x32_bf16 v[124:127], a[128:131], v[212:215], v[124:127]
  buffer_load_dwordx4 a[12:15], v3, s[4:7], s63 offen offset:1024
  s_add_u32 s63, s31, 0
  v_mfma_f32_16x16x32_bf16 v[128:131], a[132:135], v[212:215], v[128:131]
  v_mfma_f32_16x16x32_bf16 v[132:135], a[136:139], v[212:215], v[132:135]
  buffer_load_dwordx4 v[208:211], v3, s[4:7], s98 offen offset:1024 sc1
  buffer_load_dwordx4 v[212:215], v3, s[4:7], s99 offen offset:1024 sc1
  s_mul_i32 s62, s33, 2560
  s_mul_i32 s61, s29, 20480
  s_add_u32 s62, s62, s61
  s_add_u32 s62, s62, 18874368
  v_min_u32 v88, 19, v2
  v_lshlrev_b32 v88, 7, v88
  buffer_load_dword v89, v88, s[4:7], s62 offen
  s_waitcnt vmcnt(20)
  v_mfma_f32_16x16x32_bf16 v[96:99], a[140:143], v[160:163], v[96:99]
  v_mfma_f32_16x16x32_bf16 v[100:103], a[144:147], v[160:163], v[100:103]
  v_mfma_f32_16x16x32_bf16 v[104:107], a[148:151], v[160:163], v[104:107]
  v_mfma_f32_16x16x32_bf16 v[108:111], a[152:155], v[160:163], v[108:111]
  buffer_load_dwordx4 a[16:19], v3, s[4:7], s63 offen offset:2048
  s_add_u32 s63, s31, 20480
  v_mfma_f32_16x16x32_bf16 v[112:115], a[156:159], v[160:163], v[112:115]
  v_mfma_f32_16x16x32_bf16 v[116:119], a[140:143], v[164:167], v[116:119]
  v_mfma_f32_16x16x32_bf16 v[120:123], a[144:147], v[164:167], v[120:123]
  v_mfma_f32_16x16x32_bf16 v[124:127], a[148:151], v[164:167], v[124:127]
  buffer_load_dwordx4 a[20:23], v3, s[4:7], s63 offen offset:2048
  s_add_u32 s63, s31, 0
  v_mfma_f32_16x16x32_bf16 v[128:131], a[152:155], v[164:167], v[128:131]
  v_mfma_f32_16x16x32_bf16 v[132:135], a[156:159], v[164:167], v[132:135]
  s_waitcnt vmcnt(20)
  v_mfma_f32_16x16x32_bf16 v[96:99], a[160:163], v[168:171], v[96:99]
  v_mfma_f32_16x16x32_bf16 v[100:103], a[164:167], v[168:171], v[100:103]
  buffer_load_dwordx4 a[24:27], v3, s[4:7], s63 offen offset:3072
  s_add_u32 s63, s31, 20480
  v_mfma_f32_16x16x32_bf16 v[104:107], a[168:171], v[168:171], v[104:107]
  v_mfma_f32_16x16x32_bf16 v[108:111], a[172:175], v[168:171], v[108:111]
  v_mfma_f32_16x16x32_bf16 v[112:115], a[176:179], v[168:171], v[112:115]
  v_mfma_f32_16x16x32_bf16 v[116:119], a[160:163], v[172:175], v[116:119]
  buffer_load_dwordx4 a[28:31], v3, s[4:7], s63 offen offset:3072
  s_add_u32 s63, s31, 4096
  v_mfma_f32_16x16x32_bf16 v[120:123], a[164:167], v[172:175], v[120:123]
  v_mfma_f32_16x16x32_bf16 v[124:127], a[168:171], v[172:175], v[124:127]
  v_mfma_f32_16x16x32_bf16 v[128:131], a[172:175], v[172:175], v[128:131]
  v_mfma_f32_16x16x32_bf16 v[132:135], a[176:179], v[172:175], v[132:135]
  buffer_load_dwordx4 a[32:35], v3, s[4:7], s63 offen offset:0
  s_add_u32 s63, s31, 24576
  s_waitcnt vmcnt(14)
  s_barrier
  s_cmp_lg_u32 s20, 0
  s_cbranch_scc1 Lf34
  s_add_u32 s62, s100, s28
  s_add_u32 s62, s62, 8192
  s_lshl_b32 s61, s22, 2
  s_add_u32 s62, s62, s61
  s_mov_b64 exec, 1
  s_cmp_eq_u32 s12, 1
  s_cbranch_scc1 Ldb35
  buffer_store_dword v86, v87, s[4:7], s62 offen sc1
  s_branch Lde35
Ldb35:
  buffer_store_dword v86, v87, s[4:7], s62 offen
Lde35:
  s_mov_b64 exec, -1
Lf34:
  s_add_u32 s62, s100, s28
  s_add_u32 s62, s62, 8192
  buffer_load_dword v84, v5, s[4:7], s62 offen sc1
  v_mfma_f32_16x16x32_bf16 v[96:99], a[180:183], v[176:179], v[96:99]
  v_mfma_f32_16x16x32_bf16 v[100:103], a[184:187], v[176:179], v[100:103]
  v_mfma_f32_16x16x32_bf16 v[104:107], a[188:191], v[176:179], v[104:107]
  v_mfma_f32_16x16x32_bf16 v[108:111], a[192:195], v[176:179], v[108:111]
  buffer_load_dwordx4 a[36:39], v3, s[4:7], s63 offen offset:0
  s_add_u32 s63, s31, 4096
  v_mfma_f32_16x16x32_bf16 v[112:115], a[196:199], v[176:179], v[112:115]
  v_mfma_f32_16x16x32_bf16 v[116:119], a[180:183], v[180:183], v[116:119]
  v_mfma_f32_16x16x32_bf16 v[120:123], a[184:187], v[180:183], v[120:123]
  v_mfma_f32_16x16x32_bf16 v[124:127], a[188:191], v[180:183], v[124:127]
  buffer_load_dwordx4 a[40:43], v3, s[4:7], s63 offen offset:1024
  s_add_u32 s63, s31, 24576
  v_mfma_f32_16x16x32_bf16 v[128:131], a[192:195], v[180:183], v[128:131]
  v_mfma_f32_16x16x32_bf16 v[132:135], a[196:199], v[180:183], v[132:135]
  v_mfma_f32_16x16x32_bf16 v[96:99], a[200:203], v[184:187], v[96:99]
  v_mfma_f32_16x16x32_bf16 v[100:103], a[204:207], v[184:187], v[100:103]
  buffer_load_dwordx4 a[44:47], v3, s[4:7], s63 offen offset:1024
  s_add_u32 s63, s31, 4096
  v_mfma_f32_16x16x32_bf16 v[104:107], a[208:211], v[184:187], v[104:107]
  v_mfma_f32_16x16x32_bf16 v[108:111], a[212:215], v[184:187], v[108:111]
  v_mfma_f32_16x16x32_bf16 v[112:115], a[216:219], v[184:187], v[112:115]
  v_mfma_f32_16x16x32_bf16 v[116:119], a[200:203], v[188:191], v[116:119]
  buffer_load_dwordx4 a[48:51], v3, s[4:7], s63 offen offset:2048
  s_add_u32 s63, s31, 24576
  v_mfma_f32_16x16x32_bf16 v[120:123], a[204:207], v[188:191], v[120:123]
  v_mfma_f32_16x16x32_bf16 v[124:127], a[208:211], v[188:191], v[124:127]
  v_mfma_f32_16x16x32_bf16 v[128:131], a[212:215], v[188:191], v[128:131]
  v_mfma_f32_16x16x32_bf16 v[132:135], a[216:219], v[188:191], v[132:135]
  buffer_load_dwordx4 a[52:55], v3, s[4:7], s63 offen offset:2048
  s_add_u32 s63, s31, 4096
  s_cmp_lg_u32 s20, 0
  s_cbranch_scc1 Lpd36
  s_waitcnt vmcnt(5)
  v_cmp_ne_u32 vcc, 1, v84
  s_cbranch_vccz Lpd36
  s_add_u32 s62, s100, s28
  s_add_u32 s62, s62, 8192
  s_mov_b32 s61, 0
Lp36:
  buffer_load_dword v84, v5, s[4:7], s62 offen sc1
  s_add_u32 s61, s61, 1
  s_cmp_gt_u32 s61, 0x100000
  s_cbranch_scc1 Lpd36
  s_waitcnt vmcnt(0)
  v_cmp_ne_u32 vcc, 1, v84
  s_cbranch_vccnz Lp36
Lpd36:
  s_barrier
  s_sub_u32 s53, s29, s20
  s_lshl_b32 s53, s53, 11
  s_add_u32 s53, s53, s11
  s_add_u32 s53, s53, 39860224
  buffer_load_dwordx4 v[72:75], v12, s[4:7], s53 offen sc1
  buffer_load_dwordx4 v[76:79], v12, s[4:7], s53 offen offset:16 sc1
  v_mfma_f32_16x16x32_bf16 v[96:99], a[220:223], v[192:195], v[96:99]
  s_add_u32 s52, s69, s9
  s_add_u32 s52, s52, 8531968
  s_add_u32 m0, s30, 0
  v_mfma_f32_16x16x32_bf16 v[100:103], a[224:227], v[192:195], v[100:103]
  v_mfma_f32_16x16x32_bf16 v[104:107], a[228:231], v[192:195], v[104:107]
  v_mfma_f32_16x16x32_bf16 v[108:111], a[232:235], v[192:195], v[108:111]
  buffer_load_dwordx4 v3, s[4:7], s52 offen offset:0 sc1 lds
  v_mfma_f32_16x16x32_bf16 v[112:115], a[236:239], v[192:195], v[112:115]
  v_mfma_f32_16x16x32_bf16 v[116:119], a[220:223], v[196:199], v[116:119]
  v_mfma_f32_16x16x32_bf16 v[120:123], a[224:227], v[196:199], v[120:123]
  v_mfma_f32_16x16x32_bf16 v[124:127], a[228:231], v[196:199], v[124:127]
  buffer_load_dwordx4 v3, s[4:7], s52 offen offset:1024 sc1 lds
  v_mfma_f32_16x16x32_bf16 v[128:131], a[232:235], v[196:199], v[128:131]
  v_mfma_f32_16x16x32_bf16 v[132:135], a[236:239], v[196:199], v[132:135]
  s_waitcnt vmcnt(20)
  v_mfma_f32_16x16x32_bf16 v[96:99], a[240:243], v[200:203], v[96:99]
  v_mfma_f32_16x16x32_bf16 v[100:103], a[244:247], v[200:203], v[100:103]
  buffer_load_dwordx4 v3, s[4:7], s52 offen offset:2048 sc1 lds
  v_mfma_f32_16x16x32_bf16 v[104:107], a[248:251], v[200:203], v[104:107]
  v_mfma_f32_16x16x32_bf16 v[108:111], a[252:255], v[200:203], v[108:111]
  v_mfma_f32_16x16x32_bf16 v[112:115], v[136:139], v[200:203], v[112:115]
  v_mfma_f32_16x16x32_bf16 v[116:119], a[240:243], v[204:207], v[116:119]
  buffer_load_dwordx4 v3, s[4:7], s52 offen offset:3072 sc1 lds
  s_add_u32 s52, s52, 4096
  v_mfma_f32_16x16x32_bf16 v[120:123], a[244:247], v[204:207], v[120:123]
  s_add_u32 m0, s30, 4096
  v_mfma_f32_16x16x32_bf16 v[124:127], a[248:251], v[204:207], v[124:127]
  v_mfma_f32_16x16x32_bf16 v[128:131], a[252:255], v[204:207], v[128:131]
  v_mfma_f32_16x16x32_bf16 v[132:135], v[136:139], v[204:207], v[132:135]
  buffer_load_dwordx4 v3, s[4:7], s52 offen offset:0 sc1 lds
  s_add_u32 s52, s69, s9
  s_waitcnt vmcnt(19)
  v_mfma_f32_16x16x32_bf16 v[96:99], v[140:143], v[208:211], v[96:99]
  s_add_u32 s52, s52, 8511488
  s_add_u32 m0, s30, 20480
  v_mfma_f32_16x16x32_bf16 v[100:103], v[144:147], v[208:211], v[100:103]
  v_mfma_f32_16x16x32_bf16 v[104:107], v[148:151], v[208:211], v[104:107]
  v_mfma_f32_16x16x32_bf16 v[108:111], v[152:155], v[208:211], v[108:111]
  buffer_load_dwordx4 v3, s[4:7], s52 offen offset:0 sc1 lds
  v_mfma_f32_16x16x32_bf16 v[112:115], v[156:159], v[208:211], v[112:115]
  v_mfma_f32_16x16x32_bf16 v[116:119], v[140:143], v[212:215], v[116:119]
  v_mfma_f32_16x16x32_bf16 v[120:123], v[144:147], v[212:215], v[120:123]
  v_mfma_f32_16x16x32_bf16 v[124:127], v[148:151], v[212:215], v[124:127]
  buffer_load_dwordx4 v3, s[4:7], s52 offen offset:1024 sc1 lds
  v_mfma_f32_16x16x32_bf16 v[128:131], v[152:155], v[212:215], v[128:131]
  v_mfma_f32_16x16x32_bf16 v[132:135], v[156:159], v[212:215], v[132:135]
  s_nop 2
  ds_write_b128 v16, v[116:119] offset:0
  ds_write_b128 v16, v[120:123] offset:1024
  ds_write_b128 v17, v[104:107] offset:0
  ds_write_b128 v17, v[108:111] offset:1024
  ds_write_b128 v18, v[124:127] offset:0
  ds_write_b128 v18, v[128:131] offset:1024
  ds_write_b128 v17, v[112:115] offset:2048
  ds_write_b128 v19, v[132:135] offset:2048
  buffer_load_dwordx4 a[56:59], v3, s[4:7], s63 offen offset:3072
  s_add_u32 s63, s31, 24576
  buffer_load_dwordx4 a[60:63], v3, s[4:7], s63 offen offset:3072
  s_add_u32 s63, s31, 8192
  buffer_load_dwordx4 a[64:67], v3, s[4:7], s63 offen offset:0
  s_add_u32 s63, s31, 28672
  buffer_load_dwordx4 a[68:71], v3, s[4:7], s63 offen offset:0
  s_add_u32 s63, s31, 8192
  buffer_load_dwordx4 a[72:75], v3, s[4:7], s63 offen offset:1024
  s_add_u32 s63, s31, 28672
  buffer_load_dwordx4 a[76:79], v3, s[4:7], s63 offen offset:1024
  s_add_u32 s63, s31, 8192
  buffer_load_dwordx4 a[80:83], v3, s[4:7], s63 offen offset:2048
  s_add_u32 s63, s31, 28672
  buffer_load_dwordx4 a[84:87], v3, s[4:7], s63 offen offset:2048
  s_add_u32 s63, s31, 8192
  buffer_load_dwordx4 a[88:91], v3, s[4:7], s63 offen offset:3072
  s_add_u32 s63, s31, 28672
  buffer_load_dwordx4 a[92:95], v3, s[4:7], s63 offen offset:3072
  buffer_load_dwordx4 v3, s[4:7], s52 offen offset:2048 sc1 lds
  buffer_load_dwordx4 v3, s[4:7], s52 offen offset:3072 sc1 lds
  s_add_u32 s52, s52, 4096
  s_add_u32 m0, s30, 24576
  s_nop 0
  buffer_load_dwordx4 v3, s[4:7], s52 offen offset:0 sc1 lds
  s_waitcnt lgkmcnt(0)
  s_barrier
  ds_read_b128 v[172:175], v20 offset:0
  ds_read_b128 v[176:179], v20 offset:1024
  ds_read_b128 v[180:183], v20 offset:2048
  ds_read_b128 v[184:187], v20 offset:3072
  ds_read_b128 v[188:191], v20 offset:4096
  ds_read_b128 v[192:195], v20 offset:5120
  v_mov_b32 v204, 0x3f803f80
  v_mov_b32 v202, 0
  v_mov_b32 v203, 0
  s_waitcnt lgkmcnt(3)
  v_pk_add_f32 v[96:97], v[96:97], v[172:173]
  v_pk_add_f32 v[98:99], v[98:99], v[174:175]
  v_pk_add_f32 v[100:101], v[100:101], v[176:177]
  v_pk_add_f32 v[102:103], v[102:103], v[178:179]
  v_pk_add_f32 v[112:113], v[112:113], v[180:181]
  v_pk_add_f32 v[114:115], v[114:115], v[182:183]
  ds_read_b128 v[172:175], v20 offset:6144
  ds_read_b128 v[176:179], v20 offset:7168
  ds_read_b128 v[180:183], v20 offset:8192
  s_waitcnt lgkmcnt(3)
  v_pk_add_f32 v[96:97], v[96:97], v[184:185]
  v_pk_add_f32 v[98:99], v[98:99], v[186:187]
  v_pk_add_f32 v[100:101], v[100:101], v[188:189]
  v_pk_add_f32 v[102:103], v[102:103], v[190:191]
  v_pk_add_f32 v[112:113], v[112:113], v[192:193]
  v_pk_add_f32 v[114:115], v[114:115], v[194:195]
  s_waitcnt lgkmcnt(0)
  v_pk_add_f32 v[96:97], v[96:97], v[172:173]
  v_pk_add_f32 v[98:99], v[98:99], v[174:175]
  v_pk_add_f32 v[100:101], v[100:101], v[176:177]
  v_pk_add_f32 v[102:103], v[102:103], v[178:179]
  v_pk_add_f32 v[112:113], v[112:113], v[180:181]
  v_pk_add_f32 v[114:115], v[114:115], v[182:183]
  v_cvt_pk_bf16_f32 v196, v96, v97
  v_cvt_pk_bf16_f32 v197, v98, v99
  v_cvt_pk_bf16_f32 v198, v100, v101
  v_cvt_pk_bf16_f32 v199, v102, v103
  v_cvt_pk_bf16_f32 v200, v112, v113
  v_cvt_pk_bf16_f32 v201, v114, v115
  s_add_u32 s60, s43, -1
  v_and_b32 v200, s60, v200
  v_and_b32 v201, s60, v201
  s_lshl_b32 s59, s34, 1
  s_add_u32 s59, s59, s45
  s_add_u32 s59, s59, s29
  s_mul_i32 s60, s59, 20480
  s_add_u32 s60, s60, s9
  s_add_u32 s60, s60, 8388608
  s_lshl_b32 s59, s41, 10
  s_add_u32 s59, s59, s60
  s_lshl_b32 s58, s42, 10
  s_add_u32 s58, s58, s60
  s_add_u32 s58, s58, s44
  s_cmp_eq_u32 s43, 1
  s_cselect_b32 s58, 0x7ff00000, s58
  s_cmp_eq_u32 s12, 1
  s_cbranch_scc1 Ldb38
  buffer_store_dwordx4 v[196:199], v3, s[4:7], s59 offen sc1
  buffer_store_dwordx2 v[200:201], v3, s[4:7], s58 offen sc1
  s_branch Lde38
Ldb38:
  buffer_store_dwordx4 v[196:199], v3, s[4:7], s59 offen
  buffer_store_dwordx2 v[200:201], v3, s[4:7], s58 offen
Lde38:
  v_dot2c_f32_bf16 v202, v196, v204
  v_dot2c_f32_bf16 v203, v196, v196
  v_dot2c_f32_bf16 v202, v197, v204
  v_dot2c_f32_bf16 v203, v197, v197
  v_dot2c_f32_bf16 v202, v198, v204
  v_dot2c_f32_bf16 v203, v198, v198
  v_dot2c_f32_bf16 v202, v199, v204
  v_dot2c_f32_bf16 v203, v199, v199
  v_dot2c_f32_bf16 v202, v200, v204
  v_dot2c_f32_bf16 v203, v200, v200
  v_dot2c_f32_bf16 v202, v201, v204
  v_dot2c_f32_bf16 v203, v201, v201
  s_nop 1
  v_mov_b32 v204, v202
  v_mov_b32 v205, v203
  s_nop 0
  v_permlane16_swap_b32 v202, v204
  v_permlane16_swap_b32 v203, v205
  v_add_f32 v202, v202, v204
  v_add_f32 v203, v203, v205
  v_mov_b32 v204, v202
  v_mov_b32 v205, v203
  s_nop 0
  v_permlane32_swap_b32 v202, v204
  v_permlane32_swap_b32 v203, v205
  v_add_f32 v202, v202, v204
  v_add_f32 v203, v203, v205
  s_lshl_b32 s59, s34, 1
  s_add_u32 s59, s59, s45
  s_add_u32 s59, s59, s29
  s_lshl_b32 s59, s59, 11
  s_lshl_b32 s60, s35, 4
  s_add_u32 s59, s59, s60
  s_lshl_b32 s60, s43, 3
  s_add_u32 s59, s59, s60
  s_add_u32 s59, s59, s11
  s_add_u32 s59, s59, 39845888
  s_mov_b64 exec, 0xffff
  s_cmp_eq_u32 s12, 1
  s_cbranch_scc1 Ldb39
  buffer_store_dwordx2 v[202:203], v21, s[4:7], s59 offen sc1
  s_branch Lde39
Ldb39:
  buffer_store_dwordx2 v[202:203], v21, s[4:7], s59 offen
Lde39:
  s_mov_b64 exec, -1
  ds_write_b128 v0, v[196:199] offset:8192
  v_add_u32 v204, s44, v0
  ds_write_b64 v204, v[200:201] offset:9216
  s_mov_b32 s23, 1
  s_mov_b32 s24, s9
  s_mov_b32 s25, s11
  s_cmp_eq_u32 s12, 1
  s_cselect_b32 s26, 0, 2621440
  s_mov_b32 s27, 7340032
  s_mov_b32 s28, 8192
  s_add_u32 s52, s69, s24
  s_add_u32 s52, s52, 8491008
  s_add_u32 m0, s30, 40960
  s_nop 0
  buffer_load_dwordx4 v3, s[4:7], s52 offen offset:0 sc1 lds
  buffer_load_dwordx4 v3, s[4:7], s52 offen offset:1024 sc1 lds
  buffer_load_dwordx4 v3, s[4:7], s52 offen offset:2048 sc1 lds
  buffer_load_dwordx4 v3, s[4:7], s52 offen offset:3072 sc1 lds
  s_add_u32 s52, s52, 4096
  s_add_u32 m0, s30, 45056
  s_nop 0
  buffer_load_dwordx4 v3, s[4:7], s52 offen offset:0 sc1 lds
  s_add_u32 s52, s69, s24
  s_add_u32 s52, s52, 8470528
  s_add_u32 m0, s30, 61440
  s_nop 0
  buffer_load_dwordx4 v3, s[4:7], s52 offen offset:0 sc1 lds
  buffer_load_dwordx4 v3, s[4:7], s52 offen offset:1024 sc1 lds
  buffer_load_dwordx4 v3, s[4:7], s52 offen offset:2048 sc1 lds
  buffer_load_dwordx4 v3, s[4:7], s52 offen offset:3072 sc1 lds
  s_add_u32 s52, s52, 4096
  s_add_u32 m0, s30, 65536
  s_nop 0
  buffer_load_dwordx4 v3, s[4:7], s52 offen offset:0 sc1 lds
  s_add_u32 s55, s31, 12288
  buffer_load_dwordx4 a[96:99], v3, s[4:7], s55 offen offset:0
  s_add_u32 s55, s31, 32768
  buffer_load_dwordx4 a[100:103], v3, s[4:7], s55 offen offset:0
  s_add_u32 s55, s31, 12288
  buffer_load_dwordx4 a[104:107], v3, s[4:7], s55 offen offset:1024
  s_add_u32 s55, s31, 32768
  buffer_load_dwordx4 a[108:111], v3, s[4:7], s55 offen offset:1024
  s_mul_i32 s63, s20, 5120
  s_add_u32 s63, s63, 2621440
  s_mul_i32 s64, s36, 20480
  s_add_u32 s64, s64, s63
  s_mul_i32 s65, s37, 20480
  s_add_u32 s65, s65, s63
  s_mul_i32 s66, s38, 20480
  s_add_u32 s66, s66, s63
  s_mul_i32 s67, s39, 20480
  s_add_u32 s67, s67, s63
  s_mul_i32 s68, s40, 20480
  s_add_u32 s68, s68, s63
  s_add_u32 s61, s9, s9
  s_sub_u32 s61, s61, s8
  s_add_u32 s62, s11, s11
  s_sub_u32 s62, s62, s10
  s_mov_b32 s8, s61
  s_mov_b32 s10, s62
  s_waitcnt vmcnt(14)
  s_waitcnt vmcnt(9)
  s_barrier
  s_cmp_lg_u32 s20, 0
  s_cbranch_scc1 Lf40
  s_add_u32 s62, s100, s28
  s_add_u32 s62, s62, 1024
  s_lshl_b32 s61, s22, 2
  s_add_u32 s62, s62, s61
  s_mov_b64 exec, 1
  s_cmp_eq_u32 s12, 1
  s_cbranch_scc1 Ldb41
  buffer_store_dword v86, v87, s[4:7], s62 offen sc1
  s_branch Lde41
Ldb41:
  buffer_store_dword v86, v87, s[4:7], s62 offen
Lde41:
  s_mov_b64 exec, -1
Lf40:
  ds_read_b128 a[224:227], v3 offset:0
  ds_read_b128 a[228:231], v3 offset:20480
  ds_read_b128 a[232:235], v3 offset:40960
  ds_read_b128 a[236:239], v3 offset:1024
  ds_read_b128 a[240:243], v3 offset:21504
  ds_read_b128 a[244:247], v3 offset:41984
  ds_read_b128 a[248:251], v3 offset:2048
  s_waitcnt lgkmcnt(5)
  v_mfma_f32_16x16x32_bf16 v[24:27], a[0:3], a[224:227], 0
  ds_read_b128 a[252:255], v3 offset:22528
  s_add_u32 s55, s31, 12288
  v_add_f32 v72, v72, v74
  v_mfma_f32_16x16x32_bf16 v[28:31], a[4:7], a[224:227], 0
  v_add_f32 v73, v73, v75
  v_add_f32 v76, v76, v78
  v_mfma_f32_16x16x32_bf16 v[32:35], a[0:3], a[228:231], 0
  ds_read_b128 a[224:227], v3 offset:43008
  v_add_f32 v77, v77, v79
  v_add_f32 v72, v72, v76
  v_mfma_f32_16x16x32_bf16 v[36:39], a[4:7], a[228:231], 0
  s_waitcnt lgkmcnt(5)
  buffer_load_dwordx4 a[112:115], v3, s[4:7], s55 offen offset:2048
  s_add_u32 s55, s31, 32768
  v_mfma_f32_16x16x32_bf16 v[104:107], a[0:3], a[232:235], 0
  ds_read_b128 a[228:231], v3 offset:3072
  v_add_f32 v73, v73, v77
  v_mov_b32 v74, v72
  v_mfma_f32_16x16x32_bf16 v[108:111], a[4:7], a[232:235], 0
  v_mov_b32 v75, v73
  v_permlane16_swap_b32 v72, v74
  v_mfma_f32_16x16x32_bf16 v[24:27], a[8:11], a[236:239], v[24:27]
  ds_read_b128 a[232:235], v3 offset:23552
  v_permlane16_swap_b32 v73, v75
  v_add_f32 v72, v72, v74
  v_mfma_f32_16x16x32_bf16 v[28:31], a[12:15], a[236:239], v[28:31]
  s_waitcnt lgkmcnt(5)
  buffer_load_dwordx4 a[116:119], v3, s[4:7], s55 offen offset:2048
  s_add_u32 s55, s31, 12288
  v_mfma_f32_16x16x32_bf16 v[32:35], a[8:11], a[240:243], v[32:35]
  ds_read_b128 a[236:239], v3 offset:44032
  v_add_f32 v73, v73, v75
  v_mov_b32 v74, v72
  v_mfma_f32_16x16x32_bf16 v[36:39], a[12:15], a[240:243], v[36:39]
  v_mov_b32 v75, v73
  v_permlane32_swap_b32 v72, v74
  v_mfma_f32_16x16x32_bf16 v[104:107], a[8:11], a[244:247], v[104:107]
  ds_read_b128 a[240:243], v3 offset:4096
  v_permlane32_swap_b32 v73, v75
  v_add_f32 v72, v72, v74
  v_mfma_f32_16x16x32_bf16 v[108:111], a[12:15], a[244:247], v[108:111]
  s_waitcnt lgkmcnt(5)
  buffer_load_dwordx4 a[120:123], v3, s[4:7], s55 offen offset:3072
  s_add_u32 s55, s31, 32768
  v_mfma_f32_16x16x32_bf16 v[24:27], a[16:19], a[248:251], v[24:27]
  ds_read_b128 a[244:247], v3 offset:24576
  v_add_f32 v73, v73, v75
  v_mul_f32 v72, 0x3acccccd, v72
  v_mfma_f32_16x16x32_bf16 v[28:31], a[20:23], a[248:251], v[28:31]
  v_mul_f32 v73, 0x3acccccd, v73
  v_fma_f32 v73, -v72, v72, v73
  v_mfma_f32_16x16x32_bf16 v[32:35], a[16:19], a[252:255], v[32:35]
  ds_read_b128 a[248:251], v3 offset:45056
  v_max_f32 v73, 0, v73
  v_cvt_pk_bf16_f32 v74, v72, v73
  v_mfma_f32_16x16x32_bf16 v[36:39], a[20:23], a[252:255], v[36:39]
  s_waitcnt lgkmcnt(5)
  buffer_load_dwordx4 a[124:127], v3, s[4:7], s55 offen offset:3072
  s_add_u32 s55, s31, 16384
  v_mfma_f32_16x16x32_bf16 v[104:107], a[16:19], a[224:227], v[104:107]
  ds_read_b128 a[252:255], v3 offset:5120
  v_lshlrev_b32 v72, 16, v74
  v_and_b32 v73, 0xffff0000, v74
  v_mfma_f32_16x16x32_bf16 v[108:111], a[20:23], a[224:227], v[108:111]
  v_add_f32 v73, 0x3727c5ac, v73
  v_cvt_pk_bf16_f32 v73, v73, v73
  v_mfma_f32_16x16x32_bf16 v[24:27], a[24:27], a[228:231], v[24:27]
  ds_read_b128 a[224:227], v3 offset:25600
  v_lshlrev_b32 v73, 16, v73
  v_sqrt_f32 v73, v73
  v_mfma_f32_16x16x32_bf16 v[28:31], a[28:31], a[228:231], v[28:31]
  s_waitcnt lgkmcnt(5)
  buffer_load_dwordx4 a[128:131], v3, s[4:7], s55 offen offset:0
  s_add_u32 s55, s31, 36864
  v_mfma_f32_16x16x32_bf16 v[32:35], a[24:27], a[232:235], v[32:35]
  ds_read_b128 a[228:231], v3 offset:46080
  v_cvt_pk_bf16_f32 v73, v73, v73
  v_lshlrev_b32 v73, 16, v73
  v_mfma_f32_16x16x32_bf16 v[36:39], a[28:31], a[232:235], v[36:39]
  v_rcp_f32 v74, v73
  s_lshl_b32 s53, s20, 7
  v_add_u32 v76, s53, v23
  v_mfma_f32_16x16x32_bf16 v[104:107], a[24:27], a[236:239], v[104:107]
  ds_read_b128 a[232:235], v3 offset:6144
  v_mul_f32 v75, v72, v74
  ds_write_b64 v76, v[74:75] offset:0
  v_mfma_f32_16x16x32_bf16 v[108:111], a[28:31], a[236:239], v[108:111]
  s_waitcnt lgkmcnt(6)
  buffer_load_dwordx4 a[132:135], v3, s[4:7], s55 offen offset:0
  s_add_u32 s55, s31, 16384
  v_mfma_f32_16x16x32_bf16 v[24:27], a[32:35], a[240:243], v[24:27]
  ds_read_b128 a[236:239], v3 offset:26624
  v_lshlrev_b32 v148, 2, v15
  v_sub_u32 v148, v14, v148
  v_mfma_f32_16x16x32_bf16 v[28:31], a[36:39], a[240:243], v[28:31]
  v_mov_b32 v150, 0xf149f2ca
  v_add_u32 v149, 16, v148
  v_mfma_f32_16x16x32_bf16 v[32:35], a[32:35], a[244:247], v[32:35]
  s_waitcnt lgkmcnt(1)
  s_barrier
  s_add_u32 s62, s100, s28
  s_add_u32 s62, s62, 1024
  buffer_load_dword v84, v5, s[4:7], s62 offen sc1
  ds_read_b128 a[240:243], v3 offset:47104
  v_and_b32 v149, 0xfffffff1, v149
  v_cmp_eq_u32 vcc, 0, v149
  s_nop 1
  v_cndmask_b32 v96, v150, 0, vcc
  v_mfma_f32_16x16x32_bf16 v[36:39], a[36:39], a[244:247], v[36:39]
  buffer_load_dwordx4 a[136:139], v3, s[4:7], s55 offen offset:1024
  s_add_u32 s55, s31, 36864
  v_mfma_f32_16x16x32_bf16 v[104:107], a[32:35], a[248:251], v[104:107]
  ds_read_b128 a[244:247], v3 offset:7168
  v_add_u32 v149, 15, v148
  v_and_b32 v149, 0xfffffff1, v149
  v_mfma_f32_16x16x32_bf16 v[108:111], a[36:39], a[248:251], v[108:111]
  v_cmp_eq_u32 vcc, 0, v149
  s_nop 1
  v_cndmask_b32 v97, v150, 0, vcc
  v_mfma_f32_16x16x32_bf16 v[24:27], a[40:43], a[252:255], v[24:27]
  ds_read_b128 a[248:251], v3 offset:27648
  v_add_u32 v149, 14, v148
  v_and_b32 v149, 0xfffffff1, v149
  v_mfma_f32_16x16x32_bf16 v[28:31], a[44:47], a[252:255], v[28:31]
  buffer_load_dwordx4 a[140:143], v3, s[4:7], s55 offen offset:1024
  s_add_u32 s55, s31, 16384
  v_mfma_f32_16x16x32_bf16 v[32:35], a[40:43], a[224:227], v[32:35]
  ds_read_b128 a[252:255], v3 offset:48128
  v_cmp_eq_u32 vcc, 0, v149
  s_nop 1
  v_cndmask_b32 v98, v150, 0, vcc
  v_mfma_f32_16x16x32_bf16 v[36:39], a[44:47], a[224:227], v[36:39]
  v_add_u32 v149, 13, v148
  v_and_b32 v149, 0xfffffff1, v149
  v_mfma_f32_16x16x32_bf16 v[104:107], a[40:43], a[228:231], v[104:107]
  ds_read_b128 a[224:227], v3 offset:8192
  v_cmp_eq_u32 vcc, 0, v149
  s_nop 1
  v_cndmask_b32 v99, v150, 0, vcc
  v_mfma_f32_16x16x32_bf16 v[108:111], a[44:47], a[228:231], v[108:111]
  s_waitcnt lgkmcnt(5)
  buffer_load_dwordx4 a[144:147], v3, s[4:7], s55 offen offset:2048
  s_add_u32 s55, s31, 36864
  v_mfma_f32_16x16x32_bf16 v[24:27], a[48:51], a[232:235], v[24:27]
  ds_read_b128 a[228:231], v3 offset:28672
  v_add_u32 v149, 0, v148
  v_and_b32 v149, 0xfffffff1, v149
  v_mfma_f32_16x16x32_bf16 v[28:31], a[52:55], a[232:235], v[28:31]
  v_cmp_eq_u32 vcc, 0, v149
  s_nop 1
  v_cndmask_b32 v100, v150, 0, vcc
  v_mfma_f32_16x16x32_bf16 v[32:35], a[48:51], a[236:239], v[32:35]
  ds_read_b128 a[232:235], v3 offset:49152
  v_add_u32 v149, -1, v148
  v_and_b32 v149, 0xfffffff1, v149
  v_mfma_f32_16x16x32_bf16 v[36:39], a[52:55], a[236:239], v[36:39]
  s_waitcnt lgkmcnt(5)
  buffer_load_dwordx4 a[148:151], v3, s[4:7], s55 offen offset:2048
  s_add_u32 s55, s31, 16384
  ds_read_b128 v[40:43], v1 offset:0
  ds_read_b128 v[44:47], v1 offset:16
  v_mfma_f32_16x16x32_bf16 v[104:107], a[48:51], a[240:243], v[104:107]
  ds_read_b128 a[236:239], v3 offset:9216
  v_cmp_eq_u32 vcc, 0, v149
  s_nop 1
  v_cndmask_b32 v101, v150, 0, vcc
  v_mfma_f32_16x16x32_bf16 v[108:111], a[52:55], a[240:243], v[108:111]
  v_add_u32 v149, -2, v148
  v_and_b32 v149, 0xfffffff1, v149
  v_mfma_f32_16x16x32_bf16 v[24:27], a[56:59], a[244:247], v[24:27]
  ds_read_b128 a[240:243], v3 offset:29696
  v_cmp_eq_u32 vcc, 0, v149
  s_nop 1
  v_cndmask_b32 v102, v150, 0, vcc
  v_mfma_f32_16x16x32_bf16 v[28:31], a[60:63], a[244:247], v[28:31]
  s_waitcnt lgkmcnt(7)
  buffer_load_dwordx4 a[152:155], v3, s[4:7], s55 offen offset:3072
  s_add_u32 s55, s31, 36864
  v_mfma_f32_16x16x32_bf16 v[32:35], a[56:59], a[248:251], v[32:35]
  ds_read_b128 a[244:247], v3 offset:50176
  v_add_u32 v149, -3, v148
  v_and_b32 v149, 0xfffffff1, v149
  v_mfma_f32_16x16x32_bf16 v[36:39], a[60:63], a[248:251], v[36:39]
  v_cmp_eq_u32 vcc, 0, v149
  s_nop 1
  v_cndmask_b32 v103, v150, 0, vcc
  v_mfma_f32_16x16x32_bf16 v[104:107], a[56:59], a[252:255], v[104:107]
  ds_read_b128 a[248:251], v3 offset:10240
  v_mfma_f32_16x16x32_bf16 v[108:111], a[60:63], a[252:255], v[108:111]
  s_waitcnt lgkmcnt(7)
  buffer_load_dwordx4 a[156:159], v3, s[4:7], s55 offen offset:3072
  v_mfma_f32_16x16x32_bf16 v[24:27], a[64:67], a[224:227], v[24:27]
  ds_read_b128 a[252:255], v3 offset:30720
  v_mfma_f32_16x16x32_bf16 v[28:31], a[68:71], a[224:227], v[28:31]
  v_mfma_f32_16x16x32_bf16 v[32:35], a[64:67], a[228:231], v[32:35]
  ds_read_b128 a[224:227], v3 offset:51200
  v_mfma_f32_16x16x32_bf16 v[36:39], a[68:71], a[228:231], v[36:39]
  s_waitcnt lgkmcnt(5)
  buffer_load_dwordx4 a[160:163], v3, s[4:7], s64 offen offset:0
  v_mfma_f32_16x16x32_bf16 v[104:107], a[64:67], a[232:235], v[104:107]
  ds_read_b128 a[228:231], v3 offset:11264
  v_mfma_f32_16x16x32_bf16 v[108:111], a[68:71], a[232:235], v[108:111]
  v_mfma_f32_16x16x32_bf16 v[24:27], a[72:75], a[236:239], v[24:27]
  ds_read_b128 a[232:235], v3 offset:31744
  v_mfma_f32_16x16x32_bf16 v[28:31], a[76:79], a[236:239], v[28:31]
  s_waitcnt lgkmcnt(5)
  buffer_load_dwordx4 a[164:167], v3, s[4:7], s65 offen offset:0
  v_mfma_f32_16x16x32_bf16 v[32:35], a[72:75], a[240:243], v[32:35]
  ds_read_b128 a[236:239], v3 offset:52224
  v_mfma_f32_16x16x32_bf16 v[36:39], a[76:79], a[240:243], v[36:39]
  v_mfma_f32_16x16x32_bf16 v[104:107], a[72:75], a[244:247], v[104:107]
  ds_read_b128 a[240:243], v3 offset:12288
  v_mfma_f32_16x16x32_bf16 v[108:111], a[76:79], a[244:247], v[108:111]
  s_waitcnt lgkmcnt(5)
  buffer_load_dwordx4 a[168:171], v3, s[4:7], s66 offen offset:0
  v_mfma_f32_16x16x32_bf16 v[24:27], a[80:83], a[248:251], v[24:27]
  ds_read_b128 a[244:247], v3 offset:32768
  v_mfma_f32_16x16x32_bf16 v[28:31], a[84:87], a[248:251], v[28:31]
  v_mfma_f32_16x16x32_bf16 v[32:35], a[80:83], a[252:255], v[32:35]
  ds_read_b128 a[248:251], v3 offset:53248
  v_mfma_f32_16x16x32_bf16 v[36:39], a[84:87], a[252:255], v[36:39]
  s_waitcnt lgkmcnt(5)
  buffer_load_dwordx4 a[172:175], v3, s[4:7], s67 offen offset:0
  v_mfma_f32_16x16x32_bf16 v[104:107], a[80:83], a[224:227], v[104:107]
  ds_read_b128 a[252:255], v3 offset:13312
  v_mfma_f32_16x16x32_bf16 v[108:111], a[84:87], a[224:227], v[108:111]
  v_mfma_f32_16x16x32_bf16 v[24:27], a[88:91], a[228:231], v[24:27]
  s_cmp_lg_u32 s20, 0
  s_cbranch_scc1 Lpd42
  s_waitcnt vmcnt(10)
  v_cmp_ne_u32 vcc, 1, v84
  s_cbranch_vccz Lpd42
  s_add_u32 s62, s100, s28
  s_add_u32 s62, s62, 1024
  s_mov_b32 s61, 0
Lp42:
  buffer_load_dword v84, v5, s[4:7], s62 offen sc1
  s_add_u32 s61, s61, 1
  s_cmp_gt_u32 s61, 0x100000
  s_cbranch_scc1 Lpd42
  s_waitcnt vmcnt(0)
  v_cmp_ne_u32 vcc, 1, v84
  s_cbranch_vccnz Lp42
Lpd42:
  s_barrier
  s_sub_u32 s53, s29, s20
  s_lshl_b32 s53, s53, 11
  s_add_u32 s53, s53, s25
  s_add_u32 s53, s53, 39852032
  buffer_load_dwordx4 v[72:75], v12, s[4:7], s53 offen sc1
  buffer_load_dwordx4 v[76:79], v12, s[4:7], s53 offen offset:16 sc1
  s_add_u32 s52, s69, s24
  ds_read_b128 a[224:227], v3 offset:33792
  s_add_u32 s52, s52, 8450048
  s_add_u32 m0, s30, 81920
  v_mfma_f32_16x16x32_bf16 v[28:31], a[92:95], a[228:231], v[28:31]
  s_waitcnt lgkmcnt(5)
  buffer_load_dwordx4 v3, s[4:7], s52 offen offset:0 sc1 lds
  v_mfma_f32_16x16x32_bf16 v[32:35], a[88:91], a[232:235], v[32:35]
  ds_read_b128 a[228:231], v3 offset:54272
  v_mfma_f32_16x16x32_bf16 v[36:39], a[92:95], a[232:235], v[36:39]
  v_mfma_f32_16x16x32_bf16 v[104:107], a[88:91], a[236:239], v[104:107]
  ds_read_b128 a[232:235], v3 offset:14336
  v_mfma_f32_16x16x32_bf16 v[108:111], a[92:95], a[236:239], v[108:111]
  s_waitcnt lgkmcnt(5)
  buffer_load_dwordx4 v3, s[4:7], s52 offen offset:1024 sc1 lds
  s_waitcnt vmcnt(23)
  v_mfma_f32_16x16x32_bf16 v[24:27], a[96:99], a[240:243], v[24:27]
  ds_read_b128 a[236:239], v3 offset:34816
  v_mfma_f32_16x16x32_bf16 v[28:31], a[100:103], a[240:243], v[28:31]
  v_mfma_f32_16x16x32_bf16 v[32:35], a[96:99], a[244:247], v[32:35]
  ds_read_b128 a[240:243], v3 offset:55296
  v_mfma_f32_16x16x32_bf16 v[36:39], a[100:103], a[244:247], v[36:39]
  s_waitcnt lgkmcnt(5)
  buffer_load_dwordx4 v3, s[4:7], s52 offen offset:2048 sc1 lds
  v_mfma_f32_16x16x32_bf16 v[104:107], a[96:99], a[248:251], v[104:107]
  ds_read_b128 a[244:247], v3 offset:15360
  v_mfma_f32_16x16x32_bf16 v[108:111], a[100:103], a[248:251], v[108:111]
  s_waitcnt vmcnt(22)
  v_mfma_f32_16x16x32_bf16 v[24:27], a[104:107], a[252:255], v[24:27]
  ds_read_b128 a[248:251], v3 offset:35840
  v_mfma_f32_16x16x32_bf16 v[28:31], a[108:111], a[252:255], v[28:31]
  s_waitcnt lgkmcnt(5)
  buffer_load_dwordx4 v3, s[4:7], s52 offen offset:3072 sc1 lds
  s_add_u32 s52, s52, 4096
  v_mfma_f32_16x16x32_bf16 v[32:35], a[104:107], a[224:227], v[32:35]
  ds_read_b128 a[252:255], v3 offset:56320
  s_add_u32 m0, s30, 86016
  v_mfma_f32_16x16x32_bf16 v[36:39], a[108:111], a[224:227], v[36:39]
  v_mfma_f32_16x16x32_bf16 v[104:107], a[104:107], a[228:231], v[104:107]
  ds_read_b128 a[224:227], v3 offset:16384
  v_mfma_f32_16x16x32_bf16 v[108:111], a[108:111], a[228:231], v[108:111]
  s_waitcnt lgkmcnt(5)
  buffer_load_dwordx4 v3, s[4:7], s52 offen offset:0 sc1 lds
  s_waitcnt vmcnt(22)
  v_mfma_f32_16x16x32_bf16 v[24:27], a[112:115], a[232:235], v[24:27]
  ds_read_b128 a[228:231], v3 offset:36864
  v_mfma_f32_16x16x32_bf16 v[28:31], a[116:119], a[232:235], v[28:31]
  v_mfma_f32_16x16x32_bf16 v[32:35], a[112:115], a[236:239], v[32:35]
  ds_read_b128 a[232:235], v3 offset:57344
  v_mfma_f32_16x16x32_bf16 v[36:39], a[116:119], a[236:239], v[36:39]
  s_waitcnt lgkmcnt(5)
  buffer_load_dwordx4 a[176:179], v3, s[4:7], s68 offen offset:0
  v_mfma_f32_16x16x32_bf16 v[104:107], a[112:115], a[240:243], v[104:107]
  ds_read_b128 a[236:239], v3 offset:17408
  v_mfma_f32_16x16x32_bf16 v[108:111], a[116:119], a[240:243], v[108:111]
  s_waitcnt vmcnt(21)
  v_mfma_f32_16x16x32_bf16 v[24:27], a[120:123], a[244:247], v[24:27]
  ds_read_b128 a[240:243], v3 offset:37888
  v_mfma_f32_16x16x32_bf16 v[28:31], a[124:127], a[244:247], v[28:31]
  s_waitcnt lgkmcnt(5)
  buffer_load_dwordx4 a[180:183], v3, s[4:7], s64 offen offset:1024
  v_mfma_f32_16x16x32_bf16 v[32:35], a[120:123], a[248:251], v[32:35]
  ds_read_b128 a[244:247], v3 offset:58368
  v_mfma_f32_16x16x32_bf16 v[36:39], a[124:127], a[248:251], v[36:39]
  v_mfma_f32_16x16x32_bf16 v[104:107], a[120:123], a[252:255], v[104:107]
  ds_read_b128 a[248:251], v3 offset:18432
  v_mfma_f32_16x16x32_bf16 v[108:111], a[124:127], a[252:255], v[108:111]
  s_waitcnt lgkmcnt(5)
  buffer_load_dwordx4 a[184:187], v3, s[4:7], s65 offen offset:1024
  s_waitcnt vmcnt(21)
  v_mfma_f32_16x16x32_bf16 v[24:27], a[128:131], a[224:227], v[24:27]
  ds_read_b128 a[252:255], v3 offset:38912
  v_mfma_f32_16x16x32_bf16 v[28:31], a[132:135], a[224:227], v[28:31]
  v_mfma_f32_16x16x32_bf16 v[32:35], a[128:131], a[228:231], v[32:35]
  ds_read_b128 a[224:227], v3 offset:59392
  v_mfma_f32_16x16x32_bf16 v[36:39], a[132:135], a[228:231], v[36:39]
  s_waitcnt lgkmcnt(5)
  buffer_load_dwordx4 a[188:191], v3, s[4:7], s66 offen offset:1024
  v_mfma_f32_16x16x32_bf16 v[104:107], a[128:131], a[232:235], v[104:107]
  ds_read_b128 a[228:231], v3 offset:19456
  v_mfma_f32_16x16x32_bf16 v[108:111], a[132:135], a[232:235], v[108:111]
  s_waitcnt vmcnt(19)
  v_mfma_f32_16x16x32_bf16 v[24:27], a[136:139], a[236:239], v[24:27]
  ds_read_b128 a[232:235], v3 offset:39936
  v_mfma_f32_16x16x32_bf16 v[28:31], a[140:143], a[236:239], v[28:31]
  s_waitcnt lgkmcnt(5)
  buffer_load_dwordx4 a[192:195], v3, s[4:7], s67 offen offset:1024
  v_mfma_f32_16x16x32_bf16 v[32:35], a[136:139], a[240:243], v[32:35]
  ds_read_b128 a[236:239], v3 offset:60416
  v_mfma_f32_16x16x32_bf16 v[36:39], a[140:143], a[240:243], v[36:39]
  v_mfma_f32_16x16x32_bf16 v[104:107], a[136:139], a[244:247], v[104:107]
  s_barrier
  ds_read_b128 a[240:243], v4 offset:0
  v_mfma_f32_16x16x32_bf16 v[108:111], a[140:143], a[244:247], v[108:111]
  s_waitcnt lgkmcnt(5)
  buffer_load_dwordx4 a[196:199], v3, s[4:7], s68 offen offset:1024
  s_waitcnt vmcnt(19)
  v_mfma_f32_16x16x32_bf16 v[24:27], a[144:147], a[248:251], v[24:27]
  ds_read_b128 a[244:247], v4 offset:1024
  v_mfma_f32_16x16x32_bf16 v[28:31], a[148:151], a[248:251], v[28:31]
  v_mfma_f32_16x16x32_bf16 v[32:35], a[144:147], a[252:255], v[32:35]
  ds_read_b128 a[248:251], v4 offset:2048
  v_mfma_f32_16x16x32_bf16 v[36:39], a[148:151], a[252:255], v[36:39]
  s_waitcnt lgkmcnt(5)
  buffer_load_dwordx4 a[200:203], v3, s[4:7], s64 offen offset:2048
  v_mfma_f32_16x16x32_bf16 v[104:107], a[144:147], a[224:227], v[104:107]
  ds_read_b128 a[252:255], v4 offset:3072
  v_mfma_f32_16x16x32_bf16 v[108:111], a[148:151], a[224:227], v[108:111]
  s_waitcnt vmcnt(18)
  v_mfma_f32_16x16x32_bf16 v[24:27], a[152:155], a[228:231], v[24:27]
  ds_read_b128 a[224:227], v4 offset:4096
  v_mfma_f32_16x16x32_bf16 v[28:31], a[156:159], a[228:231], v[28:31]
  s_waitcnt lgkmcnt(5)
  buffer_load_dwordx4 a[204:207], v3, s[4:7], s65 offen offset:2048
  s_waitcnt vmcnt(13)
  v_mfma_f32_16x16x32_bf16 v[32:35], a[152:155], a[232:235], v[32:35]
  ds_read_b128 a[228:231], v4 offset:5120
  v_add_f32 v72, v72, v74
  v_add_f32 v73, v73, v75
  v_mfma_f32_16x16x32_bf16 v[36:39], a[156:159], a[232:235], v[36:39]
  v_add_f32 v76, v76, v78
  v_add_f32 v77, v77, v79
  v_mfma_f32_16x16x32_bf16 v[104:107], a[152:155], a[236:239], v[104:107]
  ds_read_b128 a[232:235], v4 offset:6144
  v_add_f32 v72, v72, v76
  v_add_f32 v73, v73, v77
  v_mfma_f32_16x16x32_bf16 v[108:111], a[156:159], a[236:239], v[108:111]
  s_waitcnt lgkmcnt(5)
  buffer_load_dwordx4 a[208:211], v3, s[4:7], s66 offen offset:2048
  v_mov_b32 v74, v72
  v_mfma_f32_16x16x32_bf16 v[112:115], a[0:3], a[240:243], 0
  ds_read_b128 a[236:239], v4 offset:7168
  v_mov_b32 v75, v73
  v_permlane16_swap_b32 v72, v74
  v_mfma_f32_16x16x32_bf16 v[116:119], a[4:7], a[240:243], 0
  v_permlane16_swap_b32 v73, v75
  v_add_f32 v72, v72, v74
  v_mfma_f32_16x16x32_bf16 v[112:115], a[8:11], a[244:247], v[112:115]
  ds_read_b128 a[240:243], v4 offset:8192
  v_add_f32 v73, v73, v75
  v_mov_b32 v74, v72
  v_mfma_f32_16x16x32_bf16 v[116:119], a[12:15], a[244:247], v[116:119]
  s_waitcnt lgkmcnt(5)
  buffer_load_dwordx4 a[212:215], v3, s[4:7], s67 offen offset:2048
  v_mov_b32 v75, v73
  v_mfma_f32_16x16x32_bf16 v[112:115], a[16:19], a[248:251], v[112:115]
  ds_read_b128 a[244:247], v4 offset:9216
  ds_read_b64 v[68:69], v23 offset:0
  v_permlane32_swap_b32 v72, v74
  v_mfma_f32_16x16x32_bf16 v[116:119], a[20:23], a[248:251], v[116:119]
  v_permlane32_swap_b32 v73, v75
  v_add_f32 v72, v72, v74
  v_mfma_f32_16x16x32_bf16 v[112:115], a[24:27], a[252:255], v[112:115]
  ds_read_b128 a[248:251], v4 offset:10240
  v_add_f32 v73, v73, v75
  v_mul_f32 v72, 0x3acccccd, v72
  v_mfma_f32_16x16x32_bf16 v[116:119], a[28:31], a[252:255], v[116:119]
  s_waitcnt lgkmcnt(6)
  buffer_load_dwordx4 a[216:219], v3, s[4:7], s68 offen offset:2048
  v_mul_f32 v73, 0x3acccccd, v73
  v_mfma_f32_16x16x32_bf16 v[112:115], a[32:35], a[224:227], v[112:115]
  ds_read_b128 a[252:255], v4 offset:11264
  v_fma_f32 v73, -v72, v72, v73
  v_max_f32 v73, 0, v73
  v_mfma_f32_16x16x32_bf16 v[116:119], a[36:39], a[224:227], v[116:119]
  s_waitcnt lgkmcnt(2)
  v_mul_f32 v56, v69, v40
  v_mul_f32 v57, v69, v41
  v_mfma_f32_16x16x32_bf16 v[112:115], a[40:43], a[228:231], v[112:115]
  ds_read_b128 a[224:227], v4 offset:12288
  v_mul_f32 v58, v69, v42
  v_mul_f32 v59, v69, v43
  v_mfma_f32_16x16x32_bf16 v[116:119], a[44:47], a[228:231], v[116:119]
  buffer_load_dwordx4 a[220:223], v3, s[4:7], s64 offen offset:3072
  s_add_u32 s63, s32, 0
  v_mfma_f32_16x16x32_bf16 v[112:115], a[48:51], a[232:235], v[112:115]
  ds_read_b128 a[228:231], v4 offset:13312
  v_mul_f32 v60, v69, v44
  v_mul_f32 v61, v69, v45
  v_mfma_f32_16x16x32_bf16 v[116:119], a[52:55], a[232:235], v[116:119]
  v_mul_f32 v62, v69, v46
  v_mul_f32 v63, v69, v47
  v_mfma_f32_16x16x32_bf16 v[112:115], a[56:59], a[236:239], v[112:115]
  ds_read_b128 a[232:235], v4 offset:14336
  v_fma_f32 v56, v24, v68, -v56
  v_fma_f32 v57, v25, v68, -v57
  v_mfma_f32_16x16x32_bf16 v[116:119], a[60:63], a[236:239], v[116:119]
  buffer_load_dwordx4 v[252:255], v3, s[4:7], s63 offen offset:0
  s_add_u32 s63, s32, 20480
  v_mfma_f32_16x16x32_bf16 v[112:115], a[64:67], a[240:243], v[112:115]
  ds_read_b128 a[236:239], v4 offset:15360
  v_fma_f32 v58, v26, v68, -v58
  v_fma_f32 v59, v27, v68, -v59
  v_mfma_f32_16x16x32_bf16 v[116:119], a[68:71], a[240:243], v[116:119]
  v_fma_f32 v60, v28, v68, -v60
  v_fma_f32 v61, v29, v68, -v61
  v_fma_f32 v62, v30, v68, -v62
  v_fma_f32 v63, v31, v68, -v63
  v_cvt_pk_bf16_f32 v64, v56, v57
  v_cvt_pk_bf16_f32 v65, v58, v59
  v_cvt_pk_bf16_f32 v66, v60, v61
  v_cvt_pk_bf16_f32 v67, v62, v63
  ds_write_b128 v6, v[64:67] offset:30464
  s_waitcnt lgkmcnt(0)
  s_barrier
  v_mfma_f32_16x16x32_bf16 v[112:115], a[72:75], a[244:247], v[112:115]
  s_add_u32 s52, s69, s24
  ds_read_b128 a[240:243], v4 offset:16384
  s_lshl_b32 s58, s20, 10
  v_add_u32 v88, s58, v3
  s_lshl_b32 s58, s20, 6
  v_add_u32 v89, s58, v3
  v_add_u32 v90, 137216, v88
  v_add_u32 v91, 141312, v89
  ds_read_b128 v[80:83], v90
  s_mov_b64 exec, 0xf
  ds_read_b128 v[92:95], v91
  s_mov_b64 exec, -1
  v_mfma_f32_16x16x32_bf16 v[116:119], a[76:79], a[244:247], v[116:119]
  s_add_u32 s52, s52, 8429568
  s_add_u32 m0, s30, 0
  v_mfma_f32_16x16x32_bf16 v[112:115], a[80:83], a[248:251], v[112:115]
  ds_read_b128 a[244:247], v4 offset:17408
  buffer_load_dwordx4 v3, s[4:7], s52 offen offset:0 sc1 lds
  ds_read_b64 v[70:71], v23 offset:128
  v_mfma_f32_16x16x32_bf16 v[116:119], a[84:87], a[248:251], v[116:119]
  v_cvt_pk_bf16_f32 v74, v72, v73
  v_lshlrev_b32 v72, 16, v74
  v_mfma_f32_16x16x32_bf16 v[112:115], a[88:91], a[252:255], v[112:115]
  ds_read_b128 a[248:251], v4 offset:18432
  s_waitcnt lgkmcnt(3)
  s_mul_i32 s58, s23, 1179648
  s_add_u32 s58, s58, s48
  buffer_store_dwordx4 v[80:83], v88, s[4:7], s58 offen sc1
  s_add_u32 s58, s58, 4096
  s_mov_b64 exec, 0xf
  buffer_store_dwordx4 v[92:95], v89, s[4:7], s58 offen sc1
  s_mov_b64 exec, -1
  v_mfma_f32_16x16x32_bf16 v[116:119], a[92:95], a[252:255], v[116:119]
  v_and_b32 v73, 0xffff0000, v74
  v_add_f32 v73, 0x3727c5ac, v73
  v_mfma_f32_16x16x32_bf16 v[112:115], a[96:99], a[224:227], v[112:115]
  ds_read_b128 a[252:255], v4 offset:19456
  buffer_load_dwordx4 v3, s[4:7], s52 offen offset:1024 sc1 lds
  v_cvt_pk_bf16_f32 v73, v73, v73
  v_mfma_f32_16x16x32_bf16 v[116:119], a[100:103], a[224:227], v[116:119]
  s_waitcnt lgkmcnt(2)
  v_mul_f32 v56, v71, v40
  v_mul_f32 v57, v71, v41
  v_mfma_f32_16x16x32_bf16 v[112:115], a[104:107], a[228:231], v[112:115]
  v_mul_f32 v58, v71, v42
  v_mul_f32 v59, v71, v43
  v_mul_f32 v60, v71, v44
  v_mul_f32 v61, v71, v45
  v_mul_f32 v62, v71, v46
  v_mul_f32 v63, v71, v47
  v_fma_f32 v56, v32, v70, -v56
  v_fma_f32 v57, v33, v70, -v57
  v_fma_f32 v58, v34, v70, -v58
  v_fma_f32 v59, v35, v70, -v59
  v_fma_f32 v60, v36, v70, -v60
  v_fma_f32 v61, v37, v70, -v61
  v_fma_f32 v62, v38, v70, -v62
  v_fma_f32 v63, v39, v70, -v63
  v_cvt_pk_bf16_f32 v64, v56, v57
  v_cvt_pk_bf16_f32 v65, v58, v59
  v_cvt_pk_bf16_f32 v66, v60, v61
  v_cvt_pk_bf16_f32 v67, v62, v63
  ds_write_b128 v6, v[64:67] offset:26112
  ds_read_b64 v[68:69], v23 offset:256
  s_waitcnt lgkmcnt(0)
  v_mul_f32 v56, v69, v40
  v_mul_f32 v57, v69, v41
  v_mul_f32 v58, v69, v42
  v_mul_f32 v59, v69, v43
  v_mul_f32 v60, v69, v44
  v_mul_f32 v61, v69, v45
  v_mul_f32 v62, v69, v46
  v_mul_f32 v63, v69, v47
  v_fma_f32 v56, v104, v68, -v56
  v_fma_f32 v57, v105, v68, -v57
  v_fma_f32 v58, v106, v68, -v58
  v_fma_f32 v59, v107, v68, -v59
  v_fma_f32 v60, v108, v68, -v60
  v_fma_f32 v61, v109, v68, -v61
  v_fma_f32 v62, v110, v68, -v62
  v_fma_f32 v63, v111, v68, -v63
  v_cvt_pk_bf16_f32 v64, v56, v57
  v_cvt_pk_bf16_f32 v65, v58, v59
  v_cvt_pk_bf16_f32 v66, v60, v61
  v_cvt_pk_bf16_f32 v67, v62, v63
  ds_write_b128 v6, v[64:67] offset:21760
  s_waitcnt lgkmcnt(0)
  s_waitcnt vmcnt(17)
  s_barrier
  ds_read_b128 a[224:227], v4 offset:20480
  v_lshlrev_b32 v73, 16, v73
  v_sqrt_f32 v73, v73
  v_mfma_f32_16x16x32_bf16 v[116:119], a[108:111], a[228:231], v[116:119]
  v_cvt_pk_bf16_f32 v73, v73, v73
  v_lshlrev_b32 v73, 16, v73
  v_mfma_f32_16x16x32_bf16 v[112:115], a[112:115], a[232:235], v[112:115]
  ds_read_b128 a[228:231], v4 offset:21504
  buffer_load_dwordx4 v3, s[4:7], s52 offen offset:2048 sc1 lds
  v_rcp_f32 v74, v73
  v_mfma_f32_16x16x32_bf16 v[116:119], a[116:119], a[232:235], v[116:119]
  s_lshl_b32 s53, s20, 7
  v_add_u32 v76, s53, v23
  v_mfma_f32_16x16x32_bf16 v[112:115], a[120:123], a[236:239], v[112:115]
  ds_read_b128 a[232:235], v4 offset:22528
  v_mul_f32 v75, v72, v74
  ds_write_b64 v76, v[74:75] offset:512
  v_mfma_f32_16x16x32_bf16 v[116:119], a[124:127], a[236:239], v[116:119]
  v_mov_b32 v128, 0
  v_mov_b32 v129, 0
  v_mfma_f32_16x16x32_bf16 v[112:115], a[128:131], a[240:243], v[112:115]
  ds_read_b128 a[236:239], v4 offset:23552
  buffer_load_dwordx4 v3, s[4:7], s52 offen offset:3072 sc1 lds
  s_add_u32 s52, s52, 4096
  v_mfma_f32_16x16x32_bf16 v[116:119], a[132:135], a[240:243], v[116:119]
  s_add_u32 m0, s30, 4096
  v_mov_b32 v130, 0
  v_mfma_f32_16x16x32_bf16 v[112:115], a[136:139], a[244:247], v[112:115]
  ds_read_b128 a[240:243], v4 offset:24576
  v_mov_b32 v131, 0
  s_mov_b32 exec_hi, 0xffff
  ds_read_b128 v[128:131], v8 offset:34816
  s_mov_b32 exec_hi, -1
  v_mfma_f32_16x16x32_bf16 v[116:119], a[140:143], a[244:247], v[116:119]
  ds_read_b128 v[132:135], v7 offset:30464
  ds_read_b128 v[136:139], v7 offset:34816
  v_mfma_f32_16x16x32_bf16 v[112:115], a[144:147], a[248:251], v[112:115]
  ds_read_b128 a[244:247], v4 offset:25600
  buffer_load_dwordx4 v3, s[4:7], s52 offen offset:0 sc1 lds
  s_add_u32 s52, s69, s24
  v_mfma_f32_16x16x32_bf16 v[116:119], a[148:151], a[248:251], v[116:119]
  s_add_u32 s52, s52, 8409088
  s_add_u32 m0, s30, 20480
  v_mfma_f32_16x16x32_bf16 v[112:115], a[152:155], a[252:255], v[112:115]
  ds_read_b128 a[248:251], v4 offset:26624
  v_mfma_f32_16x16x32_bf16 v[116:119], a[156:159], a[252:255], v[116:119]
  s_waitcnt lgkmcnt(9)
  v_mfma_f32_16x16x32_bf16 v[24:27], a[0:3], a[224:227], 0
  s_waitcnt lgkmcnt(2)
  ds_read_b128 a[252:255], v4 offset:27648
  buffer_load_dwordx4 v3, s[4:7], s52 offen offset:0 sc1 lds
  v_mfma_f32_16x16x32_bf16 v[140:143], v[132:135], v[128:131], 0
  v_mfma_f32_16x16x32_bf16 v[28:31], a[4:7], a[224:227], 0
  v_mfma_f32_16x16x32_bf16 v[144:147], v[136:139], v[128:131], 0
  v_mfma_f32_16x16x32_bf16 v[24:27], a[8:11], a[228:231], v[24:27]
  ds_read_b128 a[224:227], v4 offset:28672
  v_mfma_f32_16x16x32_bf16 v[28:31], a[12:15], a[228:231], v[28:31]
  ds_read_b64_tr_b16 v[132:133], v9 offset:30464
  ds_read_b64_tr_b16 v[134:135], v9 offset:34816
  v_mfma_f32_16x16x32_bf16 v[24:27], a[16:19], a[232:235], v[24:27]
  ds_read_b128 a[228:231], v4 offset:29696
  buffer_load_dwordx4 v3, s[4:7], s52 offen offset:1024 sc1 lds
  ds_read_b64 v[70:71], v23 offset:384
  v_mfma_f32_16x16x32_bf16 v[28:31], a[20:23], a[232:235], v[28:31]
  ds_read_b64_tr_b16 v[136:137], v9 offset:30496
  ds_read_b64_tr_b16 v[138:139], v9 offset:34848
  v_mfma_f32_16x16x32_bf16 v[24:27], a[24:27], a[236:239], v[24:27]
  ds_read_b128 a[232:235], v4 offset:30720
  s_mov_b32 s56, 0x3ea52b5c
  v_mfma_f32_16x16x32_bf16 v[28:31], a[28:31], a[236:239], v[28:31]
  s_waitcnt lgkmcnt(10)
  v_mfma_f32_16x16x32_bf16 v[24:27], a[32:35], a[240:243], v[24:27]
  ds_read_b128 a[236:239], v4 offset:31744
  buffer_load_dwordx4 v3, s[4:7], s52 offen offset:2048 sc1 lds
  v_fma_f32 v140, v140, s56, v96
  v_mfma_f32_16x16x32_bf16 v[28:31], a[36:39], a[240:243], v[28:31]
  s_waitcnt lgkmcnt(4)
  v_mul_f32 v56, v71, v40
  v_mul_f32 v57, v71, v41
  v_mfma_f32_16x16x32_bf16 v[24:27], a[40:43], a[244:247], v[24:27]
  ds_read_b128 a[240:243], v4 offset:32768
  v_mul_f32 v58, v71, v42
  v_mul_f32 v59, v71, v43
  v_mfma_f32_16x16x32_bf16 v[28:31], a[44:47], a[244:247], v[28:31]
  v_mul_f32 v60, v71, v44
  v_mul_f32 v61, v71, v45
  v_mfma_f32_16x16x32_bf16 v[24:27], a[48:51], a[248:251], v[24:27]
  ds_read_b128 a[244:247], v4 offset:33792
  buffer_load_dwordx4 v3, s[4:7], s52 offen offset:3072 sc1 lds
  s_add_u32 s52, s52, 4096
  v_mfma_f32_16x16x32_bf16 v[28:31], a[52:55], a[248:251], v[28:31]
  s_add_u32 m0, s30, 24576
  v_mul_f32 v62, v71, v46
  v_mfma_f32_16x16x32_bf16 v[24:27], a[56:59], a[252:255], v[24:27]
  ds_read_b128 a[248:251], v4 offset:34816
  v_mul_f32 v63, v71, v47
  v_fma_f32 v56, v112, v70, -v56
  v_mfma_f32_16x16x32_bf16 v[28:31], a[60:63], a[252:255], v[28:31]
  v_fma_f32 v57, v113, v70, -v57
  v_fma_f32 v58, v114, v70, -v58
  v_mfma_f32_16x16x32_bf16 v[24:27], a[64:67], a[224:227], v[24:27]
  ds_read_b128 a[252:255], v4 offset:35840
  buffer_load_dwordx4 v3, s[4:7], s52 offen offset:0 sc1 lds
  s_add_u32 s52, s69, s24
  v_mfma_f32_16x16x32_bf16 v[28:31], a[68:71], a[224:227], v[28:31]
  s_add_u32 s52, s52, 8388608
  s_add_u32 m0, s30, 40960
  v_mfma_f32_16x16x32_bf16 v[24:27], a[72:75], a[228:231], v[24:27]
  ds_read_b128 a[224:227], v4 offset:36864
  v_fma_f32 v59, v115, v70, -v59
  v_fma_f32 v60, v116, v70, -v60
  v_mfma_f32_16x16x32_bf16 v[28:31], a[76:79], a[228:231], v[28:31]
  s_waitcnt lgkmcnt(5)
  v_fma_f32 v61, v117, v70, -v61
  v_fma_f32 v62, v118, v70, -v62
  v_mfma_f32_16x16x32_bf16 v[24:27], a[80:83], a[232:235], v[24:27]
  ds_read_b128 a[228:231], v4 offset:37888
  buffer_load_dwordx4 v3, s[4:7], s52 offen offset:0 sc1 lds
  v_fma_f32 v63, v119, v70, -v63
  v_mfma_f32_16x16x32_bf16 v[28:31], a[84:87], a[232:235], v[28:31]
  v_cvt_pk_bf16_f32 v64, v56, v57
  v_cvt_pk_bf16_f32 v65, v58, v59
  v_mfma_f32_16x16x32_bf16 v[24:27], a[88:91], a[236:239], v[24:27]
  ds_read_b128 a[232:235], v4 offset:38912
  v_cvt_pk_bf16_f32 v66, v60, v61
  v_cvt_pk_bf16_f32 v67, v62, v63
  v_mfma_f32_16x16x32_bf16 v[28:31], a[92:95], a[236:239], v[28:31]
  s_waitcnt lgkmcnt(5)
  ds_write_b128 v6, v[64:67] offset:17408
  v_fma_f32 v141, v141, s56, v97
  v_mfma_f32_16x16x32_bf16 v[24:27], a[96:99], a[240:243], v[24:27]
  ds_read_b128 a[236:239], v4 offset:39936
  buffer_load_dwordx4 v3, s[4:7], s52 offen offset:1024 sc1 lds
  v_fma_f32 v142, v142, s56, v98
  v_mfma_f32_16x16x32_bf16 v[28:31], a[100:103], a[240:243], v[28:31]
  v_fma_f32 v143, v143, s56, v99
  v_fma_f32 v144, v144, s56, v100
  v_mfma_f32_16x16x32_bf16 v[24:27], a[104:107], a[244:247], v[24:27]
  s_waitcnt vmcnt(11)
  s_waitcnt lgkmcnt(1)
  s_waitcnt vmcnt(7)
  s_barrier
  s_cmp_lg_u32 s20, 0
  s_cbranch_scc1 Lf43
  s_lshl_b32 s62, s23, 10
  s_add_u32 s62, s62, s49
  s_mov_b64 exec, 1
  buffer_store_dword v86, v87, s[4:7], s62 offen sc1
  s_mov_b64 exec, -1
Lf43:
  ds_read_b128 a[240:243], v3 offset:0
  v_fma_f32 v145, v145, s56, v101
  v_fma_f32 v146, v146, s56, v102
  v_mfma_f32_16x16x32_bf16 v[28:31], a[108:111], a[244:247], v[28:31]
  v_fma_f32 v147, v147, s56, v103
  v_max3_f32 v148, v140, v141, v142
  v_mfma_f32_16x16x32_bf16 v[24:27], a[112:115], a[248:251], v[24:27]
  ds_read_b128 a[244:247], v3 offset:1024
  buffer_load_dwordx4 v3, s[4:7], s52 offen offset:2048 sc1 lds
  v_max3_f32 v149, v143, v144, v145
  v_mfma_f32_16x16x32_bf16 v[28:31], a[116:119], a[248:251], v[28:31]
  v_max3_f32 v148, v148, v146, v147
  v_max_f32 v148, v148, v149
  v_mfma_f32_16x16x32_bf16 v[24:27], a[120:123], a[252:255], v[24:27]
  ds_read_b128 a[248:251], v3 offset:2048
  v_mov_b32 v149, v148
  s_nop 1
  v_permlane16_swap_b32 v148, v149
  v_mfma_f32_16x16x32_bf16 v[28:31], a[124:127], a[252:255], v[28:31]
  v_max_f32 v148, v148, v149
  v_mov_b32 v149, v148
  v_mfma_f32_16x16x32_bf16 v[24:27], a[128:131], a[224:227], v[24:27]
  ds_read_b128 a[252:255], v3 offset:3072
  buffer_load_dwordx4 v3, s[4:7], s52 offen offset:3072 sc1 lds
  s_add_u32 s52, s52, 4096
  v_mfma_f32_16x16x32_bf16 v[28:31], a[132:135], a[224:227], v[28:31]
  s_add_u32 m0, s30, 45056
  v_permlane32_swap_b32 v148, v149
  v_mfma_f32_16x16x32_bf16 v[24:27], a[136:139], a[228:231], v[24:27]
  ds_read_b128 a[224:227], v3 offset:4096
  v_max_f32 v148, v148, v149
  v_sub_f32 v140, v140, v148
  v_mfma_f32_16x16x32_bf16 v[28:31], a[140:143], a[228:231], v[28:31]
  s_waitcnt lgkmcnt(5)
  v_sub_f32 v141, v141, v148
  v_sub_f32 v142, v142, v148
  v_mfma_f32_16x16x32_bf16 v[24:27], a[144:147], a[232:235], v[24:27]
  ds_read_b128 a[228:231], v3 offset:5120
  buffer_load_dwordx4 v3, s[4:7], s52 offen offset:0 sc1 lds
  v_sub_f32 v143, v143, v148
  v_mfma_f32_16x16x32_bf16 v[28:31], a[148:151], a[232:235], v[28:31]
  v_sub_f32 v144, v144, v148
  v_sub_f32 v145, v145, v148
  v_mfma_f32_16x16x32_bf16 v[24:27], a[152:155], a[236:239], v[24:27]
  ds_read_b128 a[232:235], v3 offset:6144
  v_sub_f32 v146, v146, v148
  v_sub_f32 v147, v147, v148
  v_mfma_f32_16x16x32_bf16 v[28:31], a[156:159], a[236:239], v[28:31]
  s_waitcnt lgkmcnt(5)
  v_exp_f32 v140, v140
  v_exp_f32 v141, v141
  v_mfma_f32_16x16x32_bf16 v[32:35], a[0:3], a[240:243], 0
  ds_read_b128 a[236:239], v3 offset:7168
  buffer_load_dwordx4 v[248:251], v3, s[4:7], s63 offen offset:0
  s_add_u32 s63, s32, 0
  v_mfma_f32_16x16x32_bf16 v[36:39], a[4:7], a[240:243], 0
  v_exp_f32 v142, v142
  v_exp_f32 v143, v143
  v_mfma_f32_16x16x32_bf16 v[32:35], a[8:11], a[244:247], v[32:35]
  ds_read_b128 a[240:243], v3 offset:8192
  v_exp_f32 v144, v144
  v_exp_f32 v145, v145
  v_mfma_f32_16x16x32_bf16 v[36:39], a[12:15], a[244:247], v[36:39]
  s_waitcnt lgkmcnt(5)
  v_exp_f32 v146, v146
  v_exp_f32 v147, v147
  v_mfma_f32_16x16x32_bf16 v[32:35], a[16:19], a[248:251], v[32:35]
  ds_read_b128 a[244:247], v3 offset:9216
  buffer_load_dwordx4 v[244:247], v3, s[4:7], s63 offen offset:1024
  s_add_u32 s63, s32, 20480
  v_mfma_f32_16x16x32_bf16 v[36:39], a[20:23], a[248:251], v[36:39]
  ds_read_b64 v[68:69], v23 offset:512
  v_cvt_pk_bf16_f32 v128, v140, v141
  v_mfma_f32_16x16x32_bf16 v[32:35], a[24:27], a[252:255], v[32:35]
  ds_read_b128 a[248:251], v3 offset:10240
  v_cvt_pk_bf16_f32 v129, v142, v143
  v_cvt_pk_bf16_f32 v130, v144, v145
  v_mfma_f32_16x16x32_bf16 v[36:39], a[28:31], a[252:255], v[36:39]
  s_waitcnt lgkmcnt(6)
  v_cvt_pk_bf16_f32 v131, v146, v147
  v_add_f32 v148, v140, v141
  v_mfma_f32_16x16x32_bf16 v[32:35], a[32:35], a[224:227], v[32:35]
  ds_read_b128 a[252:255], v3 offset:11264
  buffer_load_dwordx4 v[240:243], v3, s[4:7], s63 offen offset:1024
  s_add_u32 s63, s32, 0
  v_mfma_f32_16x16x32_bf16 v[36:39], a[36:39], a[224:227], v[36:39]
  v_add_f32 v149, v142, v143
  v_add_f32 v150, v144, v145
  v_mfma_f32_16x16x32_bf16 v[32:35], a[40:43], a[228:231], v[32:35]
  s_waitcnt lgkmcnt(2)
  ds_read_b128 a[224:227], v3 offset:12288
  v_mul_f32 v56, v69, v40
  v_mul_f32 v57, v69, v41
  v_mfma_f32_16x16x32_bf16 v[36:39], a[44:47], a[228:231], v[36:39]
  v_mul_f32 v58, v69, v42
  v_mul_f32 v59, v69, v43
  v_mfma_f32_16x16x32_bf16 v[32:35], a[48:51], a[232:235], v[32:35]
  ds_read_b128 a[228:231], v3 offset:13312
  buffer_load_dwordx4 v[236:239], v3, s[4:7], s63 offen offset:2048
  s_add_u32 s63, s32, 20480
  v_mfma_f32_16x16x32_bf16 v[36:39], a[52:55], a[232:235], v[36:39]
  v_mul_f32 v60, v69, v44
  v_mul_f32 v61, v69, v45
  v_mfma_f32_16x16x32_bf16 v[32:35], a[56:59], a[236:239], v[32:35]
  ds_read_b128 a[232:235], v3 offset:14336
  v_mul_f32 v62, v69, v46
  v_mul_f32 v63, v69, v47
  v_mfma_f32_16x16x32_bf16 v[36:39], a[60:63], a[236:239], v[36:39]
  v_fma_f32 v56, v24, v68, -v56
  v_fma_f32 v57, v25, v68, -v57
  v_mfma_f32_16x16x32_bf16 v[32:35], a[64:67], a[240:243], v[32:35]
  ds_read_b128 a[236:239], v3 offset:15360
  buffer_load_dwordx4 v[232:235], v3, s[4:7], s63 offen offset:2048
  s_add_u32 s63, s32, 0
  v_mfma_f32_16x16x32_bf16 v[36:39], a[68:71], a[240:243], v[36:39]
  v_fma_f32 v58, v26, v68, -v58
  v_fma_f32 v59, v27, v68, -v59
  v_mfma_f32_16x16x32_bf16 v[32:35], a[72:75], a[244:247], v[32:35]
  ds_read_b128 a[240:243], v3 offset:16384
  v_fma_f32 v60, v28, v68, -v60
  v_fma_f32 v61, v29, v68, -v61
  v_mfma_f32_16x16x32_bf16 v[36:39], a[76:79], a[244:247], v[36:39]
  s_waitcnt lgkmcnt(5)
  v_fma_f32 v62, v30, v68, -v62
  v_fma_f32 v63, v31, v68, -v63
  v_mfma_f32_16x16x32_bf16 v[32:35], a[80:83], a[248:251], v[32:35]
  ds_read_b128 a[244:247], v3 offset:17408
  buffer_load_dwordx4 v[228:231], v3, s[4:7], s63 offen offset:3072
  s_add_u32 s63, s32, 20480
  v_mfma_f32_16x16x32_bf16 v[36:39], a[84:87], a[248:251], v[36:39]
  v_cvt_pk_bf16_f32 v64, v56, v57
  v_cvt_pk_bf16_f32 v65, v58, v59
  v_mfma_f32_16x16x32_bf16 v[32:35], a[88:91], a[252:255], v[32:35]
  ds_read_b128 a[248:251], v3 offset:18432
  v_cvt_pk_bf16_f32 v66, v60, v61
  v_cvt_pk_bf16_f32 v67, v62, v63
  v_mfma_f32_16x16x32_bf16 v[36:39], a[92:95], a[252:255], v[36:39]
  s_waitcnt lgkmcnt(5)
  ds_write_b128 v6, v[64:67] offset:13056
  v_add_f32 v151, v146, v147
  v_mfma_f32_16x16x32_bf16 v[32:35], a[96:99], a[224:227], v[32:35]
  ds_read_b128 a[252:255], v3 offset:19456
  buffer_load_dwordx4 v[224:227], v3, s[4:7], s63 offen offset:3072
  s_add_u32 s63, s32, 4096
  v_mfma_f32_16x16x32_bf16 v[36:39], a[100:103], a[224:227], v[36:39]
  v_add_f32 v148, v148, v149
  v_add_f32 v150, v150, v151
  v_mfma_f32_16x16x32_bf16 v[32:35], a[104:107], a[228:231], v[32:35]
  s_waitcnt lgkmcnt(1)
  s_waitcnt vmcnt(12)
  s_barrier
  ds_read_b128 a[224:227], v3 offset:20480
  v_add_f32 v148, v148, v150
  v_mfma_f32_16x16x32_bf16 v[36:39], a[108:111], a[228:231], v[36:39]
  v_mfma_f32_16x16x32_bf16 v[140:143], v[132:135], v[128:131], 0
  v_mfma_f32_16x16x32_bf16 v[32:35], a[112:115], a[232:235], v[32:35]
  ds_read_b128 a[228:231], v3 offset:21504
  buffer_load_dwordx4 v[220:223], v3, s[4:7], s63 offen offset:0
  s_add_u32 s63, s32, 24576
  v_mfma_f32_16x16x32_bf16 v[36:39], a[116:119], a[232:235], v[36:39]
  v_mfma_f32_16x16x32_bf16 v[144:147], v[136:139], v[128:131], 0
  v_mfma_f32_16x16x32_bf16 v[32:35], a[120:123], a[236:239], v[32:35]
  ds_read_b128 a[232:235], v3 offset:22528
  v_mov_b32 v149, v148
  s_nop 1
  v_permlane16_swap_b32 v148, v149
  v_mfma_f32_16x16x32_bf16 v[36:39], a[124:127], a[236:239], v[36:39]
  v_add_f32 v148, v148, v149
  v_mov_b32 v149, v148
  v_mfma_f32_16x16x32_bf16 v[32:35], a[128:131], a[240:243], v[32:35]
  ds_read_b128 a[236:239], v3 offset:23552
  buffer_load_dwordx4 v[216:219], v3, s[4:7], s63 offen offset:0
  s_add_u32 s63, s32, 4096
  v_mfma_f32_16x16x32_bf16 v[36:39], a[132:135], a[240:243], v[36:39]
  v_permlane32_swap_b32 v148, v149
  v_add_f32 v148, v148, v149
  v_mfma_f32_16x16x32_bf16 v[32:35], a[136:139], a[244:247], v[32:35]
  ds_read_b128 a[240:243], v3 offset:24576
  v_rcp_f32 v148, v148
  s_nop 0
  v_mul_f32 v140, v140, v148
  v_mfma_f32_16x16x32_bf16 v[36:39], a[140:143], a[244:247], v[36:39]
  s_waitcnt lgkmcnt(5)
  v_mul_f32 v141, v141, v148
  v_mul_f32 v142, v142, v148
  v_mfma_f32_16x16x32_bf16 v[32:35], a[144:147], a[248:251], v[32:35]
  ds_read_b128 a[244:247], v3 offset:25600
  buffer_load_dwordx4 v[212:215], v3, s[4:7], s63 offen offset:1024
  s_add_u32 s63, s32, 24576
  v_mfma_f32_16x16x32_bf16 v[36:39], a[148:151], a[248:251], v[36:39]
  v_mul_f32 v143, v143, v148
  v_mul_f32 v144, v144, v148
  v_mfma_f32_16x16x32_bf16 v[32:35], a[152:155], a[252:255], v[32:35]
  ds_read_b128 a[248:251], v3 offset:26624
  v_mul_f32 v145, v145, v148
  v_mul_f32 v146, v146, v148
  v_mfma_f32_16x16x32_bf16 v[36:39], a[156:159], a[252:255], v[36:39]
  s_waitcnt lgkmcnt(5)
  v_mul_f32 v147, v147, v148
  v_cvt_pk_bf16_f32 v128, v140, v141
  v_mfma_f32_16x16x32_bf16 v[24:27], a[0:3], a[224:227], 0
  ds_read_b128 a[252:255], v3 offset:27648
  buffer_load_dwordx4 v[208:211], v3, s[4:7], s63 offen offset:1024
  s_add_u32 s63, s32, 4096
  v_mfma_f32_16x16x32_bf16 v[28:31], a[4:7], a[224:227], 0
  v_cvt_pk_bf16_f32 v129, v142, v143
  v_cvt_pk_bf16_f32 v130, v144, v145
  v_mfma_f32_16x16x32_bf16 v[24:27], a[8:11], a[228:231], v[24:27]
  ds_read_b128 a[224:227], v3 offset:28672
  v_cvt_pk_bf16_f32 v131, v146, v147
  s_add_u32 s57, s71, s26
  s_add_u32 s57, s57, 143360
  s_cmp_eq_u32 s12, 1
  s_cbranch_scc1 Ldb44
  buffer_store_dwordx2 v[128:129], v10, s[4:7], s57 offen sc1
  buffer_store_dwordx2 v[130:131], v11, s[4:7], s57 offen sc1
  s_branch Lde44
Ldb44:
  buffer_store_dwordx2 v[128:129], v10, s[4:7], s57 offen
  buffer_store_dwordx2 v[130:131], v11, s[4:7], s57 offen
Lde44:
  v_mfma_f32_16x16x32_bf16 v[28:31], a[12:15], a[228:231], v[28:31]
  s_waitcnt lgkmcnt(5)
  v_mov_b32 v104, 0
  v_mov_b32 v105, 0
  v_mfma_f32_16x16x32_bf16 v[24:27], a[16:19], a[232:235], v[24:27]
  ds_read_b128 a[228:231], v3 offset:29696
  buffer_load_dwordx4 v[204:207], v3, s[4:7], s63 offen offset:2048
  s_add_u32 s63, s32, 24576
  v_mfma_f32_16x16x32_bf16 v[28:31], a[20:23], a[232:235], v[28:31]
  ds_read_b64 v[70:71], v23 offset:640
  v_mov_b32 v106, 0
  v_mfma_f32_16x16x32_bf16 v[24:27], a[24:27], a[236:239], v[24:27]
  ds_read_b128 a[232:235], v3 offset:30720
  v_mov_b32 v107, 0
  s_mov_b32 exec_hi, 0xffff
  ds_read_b128 v[104:107], v8 offset:26112
  s_mov_b32 exec_hi, -1
  v_mfma_f32_16x16x32_bf16 v[28:31], a[28:31], a[236:239], v[28:31]
  s_waitcnt lgkmcnt(7)
  ds_read_b128 v[108:111], v7 offset:21760
  ds_read_b128 v[112:115], v7 offset:26112
  v_mfma_f32_16x16x32_bf16 v[24:27], a[32:35], a[240:243], v[24:27]
  ds_read_b128 a[236:239], v3 offset:31744
  buffer_load_dwordx4 v[200:203], v3, s[4:7], s63 offen offset:2048
  s_add_u32 s63, s32, 4096
  v_mfma_f32_16x16x32_bf16 v[28:31], a[36:39], a[240:243], v[28:31]
  v_mfma_f32_16x16x32_bf16 v[24:27], a[40:43], a[244:247], v[24:27]
  s_waitcnt lgkmcnt(5)
  ds_read_b128 a[240:243], v3 offset:32768
  v_mul_f32 v56, v71, v40
  v_mul_f32 v57, v71, v41
  v_mfma_f32_16x16x32_bf16 v[28:31], a[44:47], a[244:247], v[28:31]
  v_mul_f32 v58, v71, v42
  v_mul_f32 v59, v71, v43
  v_mfma_f32_16x16x32_bf16 v[24:27], a[48:51], a[248:251], v[24:27]
  s_waitcnt lgkmcnt(2)
  ds_read_b128 a[244:247], v3 offset:33792
  buffer_load_dwordx4 v[196:199], v3, s[4:7], s63 offen offset:3072
  s_add_u32 s63, s32, 24576
  v_mfma_f32_16x16x32_bf16 v[28:31], a[52:55], a[248:251], v[28:31]
  v_mul_f32 v60, v71, v44
  v_mul_f32 v61, v71, v45
  v_mfma_f32_16x16x32_bf16 v[24:27], a[56:59], a[252:255], v[24:27]
  ds_read_b128 a[248:251], v3 offset:34816
  v_mul_f32 v62, v71, v46
  v_mul_f32 v63, v71, v47
  v_mfma_f32_16x16x32_bf16 v[28:31], a[60:63], a[252:255], v[28:31]
  v_fma_f32 v56, v32, v70, -v56
  v_fma_f32 v57, v33, v70, -v57
  v_mfma_f32_16x16x32_bf16 v[24:27], a[64:67], a[224:227], v[24:27]
  ds_read_b128 a[252:255], v3 offset:35840
  buffer_load_dwordx4 v[192:195], v3, s[4:7], s63 offen offset:3072
  s_add_u32 s63, s32, 8192
  v_mfma_f32_16x16x32_bf16 v[28:31], a[68:71], a[224:227], v[28:31]
  v_fma_f32 v58, v34, v70, -v58
  v_fma_f32 v59, v35, v70, -v59
  v_mfma_f32_16x16x32_bf16 v[24:27], a[72:75], a[228:231], v[24:27]
  ds_read_b128 a[224:227], v3 offset:36864
  v_fma_f32 v60, v36, v70, -v60
  v_fma_f32 v61, v37, v70, -v61
  v_mfma_f32_16x16x32_bf16 v[28:31], a[76:79], a[228:231], v[28:31]
  s_waitcnt lgkmcnt(5)
  v_fma_f32 v62, v38, v70, -v62
  v_fma_f32 v63, v39, v70, -v63
  v_mfma_f32_16x16x32_bf16 v[24:27], a[80:83], a[232:235], v[24:27]
  ds_read_b128 a[228:231], v3 offset:37888
  buffer_load_dwordx4 v[188:191], v3, s[4:7], s63 offen offset:0
  s_add_u32 s63, s32, 28672
  v_mfma_f32_16x16x32_bf16 v[28:31], a[84:87], a[232:235], v[28:31]
  v_cvt_pk_bf16_f32 v64, v56, v57
  v_cvt_pk_bf16_f32 v65, v58, v59
  v_mfma_f32_16x16x32_bf16 v[24:27], a[88:91], a[236:239], v[24:27]
  ds_read_b128 a[232:235], v3 offset:38912
  v_cvt_pk_bf16_f32 v66, v60, v61
  v_cvt_pk_bf16_f32 v67, v62, v63
  v_mfma_f32_16x16x32_bf16 v[28:31], a[92:95], a[236:239], v[28:31]
  s_waitcnt lgkmcnt(5)
  ds_write_b128 v6, v[64:67] offset:8704
  v_mfma_f32_16x16x32_bf16 v[116:119], v[108:111], v[104:107], 0
  v_mfma_f32_16x16x32_bf16 v[24:27], a[96:99], a[240:243], v[24:27]
  ds_read_b128 a[236:239], v3 offset:39936
  buffer_load_dwordx4 v[184:187], v3, s[4:7], s63 offen offset:0
  s_add_u32 s63, s32, 8192
  v_mfma_f32_16x16x32_bf16 v[28:31], a[100:103], a[240:243], v[28:31]
  v_mfma_f32_16x16x32_bf16 v[120:123], v[112:115], v[104:107], 0
  v_mfma_f32_16x16x32_bf16 v[24:27], a[104:107], a[244:247], v[24:27]
  s_waitcnt lgkmcnt(1)
  s_waitcnt vmcnt(19)
  s_barrier
  s_xor_b32 s96, s45, 0
  s_lshl_b32 s59, s34, 1
  s_add_u32 s96, s96, s59
  s_add_u32 s96, s96, s29
  s_add_u32 s96, s96, 4
  s_mul_i32 s96, s96, 20480
  s_mul_i32 s59, s20, 5120
  s_add_u32 s96, s96, s59
  s_add_u32 s96, s96, s26
  s_add_u32 s96, s96, 18874368
  s_xor_b32 s97, s45, 1
  s_lshl_b32 s59, s34, 1
  s_add_u32 s97, s97, s59
  s_add_u32 s97, s97, s29
  s_add_u32 s97, s97, 4
  s_mul_i32 s97, s97, 20480
  s_mul_i32 s59, s20, 5120
  s_add_u32 s97, s97, s59
  s_add_u32 s97, s97, s26
  s_add_u32 s97, s97, 18874368
  s_xor_b32 s98, s45, 0
  s_lshl_b32 s59, s34, 1
  s_add_u32 s98, s98, s59
  s_add_u32 s98, s98, s29
  s_mul_i32 s98, s98, 20480
  s_mul_i32 s59, s20, 5120
  s_add_u32 s98, s98, s59
  s_add_u32 s98, s98, s26
  s_add_u32 s98, s98, 18874368
  s_xor_b32 s99, s45, 1
  s_lshl_b32 s59, s34, 1
  s_add_u32 s99, s99, s59
  s_add_u32 s99, s99, s29
  s_mul_i32 s99, s99, 20480
  s_mul_i32 s59, s20, 5120
  s_add_u32 s99, s99, s59
  s_add_u32 s99, s99, s26
  s_add_u32 s99, s99, 18874368
  ds_read_b128 a[240:243], v3 offset:40960
  v_mfma_f32_16x16x32_bf16 v[28:31], a[108:111], a[244:247], v[28:31]
  ds_read_b64_tr_b16 v[108:109], v9 offset:21760
  ds_read_b64_tr_b16 v[110:111], v9 offset:26112
  v_mfma_f32_16x16x32_bf16 v[24:27], a[112:115], a[248:251], v[24:27]
  ds_read_b128 a[244:247], v3 offset:41984
  buffer_load_dwordx4 v[180:183], v3, s[4:7], s63 offen offset:1024
  s_add_u32 s63, s32, 28672
  v_mfma_f32_16x16x32_bf16 v[28:31], a[116:119], a[248:251], v[28:31]
  ds_read_b64_tr_b16 v[112:113], v9 offset:21792
  ds_read_b64_tr_b16 v[114:115], v9 offset:26144
  v_mfma_f32_16x16x32_bf16 v[24:27], a[120:123], a[252:255], v[24:27]
  ds_read_b128 a[248:251], v3 offset:43008
  s_mov_b32 s56, 0x3ea52b5c
  v_mfma_f32_16x16x32_bf16 v[28:31], a[124:127], a[252:255], v[28:31]
  v_mfma_f32_16x16x32_bf16 v[24:27], a[128:131], a[224:227], v[24:27]
  ds_read_b128 a[252:255], v3 offset:44032
  buffer_load_dwordx4 v[176:179], v3, s[4:7], s63 offen offset:1024
  s_add_u32 s63, s32, 8192
  v_mfma_f32_16x16x32_bf16 v[28:31], a[132:135], a[224:227], v[28:31]
  v_fma_f32 v116, v116, s56, v96
  v_fma_f32 v117, v117, s56, v97
  v_mfma_f32_16x16x32_bf16 v[24:27], a[136:139], a[228:231], v[24:27]
  ds_read_b128 a[224:227], v3 offset:45056
  v_fma_f32 v118, v118, s56, v98
  v_fma_f32 v119, v119, s56, v99
  v_mfma_f32_16x16x32_bf16 v[28:31], a[140:143], a[228:231], v[28:31]
  s_waitcnt lgkmcnt(9)
  v_fma_f32 v120, v120, s56, v100
  v_fma_f32 v121, v121, s56, v101
  v_mfma_f32_16x16x32_bf16 v[24:27], a[144:147], a[232:235], v[24:27]
  ds_read_b128 a[228:231], v3 offset:46080
  buffer_load_dwordx4 v[172:175], v3, s[4:7], s63 offen offset:2048
  s_add_u32 s63, s32, 28672
  v_mfma_f32_16x16x32_bf16 v[28:31], a[148:151], a[232:235], v[28:31]
  v_fma_f32 v122, v122, s56, v102
  v_fma_f32 v123, v123, s56, v103
  v_mfma_f32_16x16x32_bf16 v[24:27], a[152:155], a[236:239], v[24:27]
  ds_read_b128 a[232:235], v3 offset:47104
  v_max3_f32 v124, v116, v117, v118
  v_max3_f32 v125, v119, v120, v121
  v_mfma_f32_16x16x32_bf16 v[28:31], a[156:159], a[236:239], v[28:31]
  s_waitcnt lgkmcnt(7)
  v_max3_f32 v124, v124, v122, v123
  v_max_f32 v124, v124, v125
  v_mfma_f32_16x16x32_bf16 v[32:35], a[0:3], a[240:243], 0
  ds_read_b128 a[236:239], v3 offset:48128
  buffer_load_dwordx4 v[168:171], v3, s[4:7], s63 offen offset:2048
  s_add_u32 s63, s32, 8192
  v_mfma_f32_16x16x32_bf16 v[36:39], a[4:7], a[240:243], 0
  v_mov_b32 v125, v124
  s_nop 1
  v_permlane16_swap_b32 v124, v125
  s_lshl_b32 s62, s23, 10
  s_add_u32 s62, s62, s47
  buffer_load_dword v85, v87, s[4:7], s62 offen sc1
  v_mfma_f32_16x16x32_bf16 v[32:35], a[8:11], a[244:247], v[32:35]
  ds_read_b128 a[240:243], v3 offset:49152
  v_max_f32 v124, v124, v125
  v_mov_b32 v125, v124
  v_mfma_f32_16x16x32_bf16 v[36:39], a[12:15], a[244:247], v[36:39]
  s_waitcnt lgkmcnt(5)
  v_permlane32_swap_b32 v124, v125
  v_max_f32 v124, v124, v125
  v_mfma_f32_16x16x32_bf16 v[32:35], a[16:19], a[248:251], v[32:35]
  ds_read_b128 a[244:247], v3 offset:50176
  buffer_load_dwordx4 v[164:167], v3, s[4:7], s63 offen offset:3072
  s_add_u32 s63, s32, 28672
  v_mfma_f32_16x16x32_bf16 v[36:39], a[20:23], a[248:251], v[36:39]
  ds_read_b64 v[68:69], v23 offset:768
  v_sub_f32 v116, v116, v124
  v_mfma_f32_16x16x32_bf16 v[32:35], a[24:27], a[252:255], v[32:35]
  ds_read_b128 a[248:251], v3 offset:51200
  v_sub_f32 v117, v117, v124
  v_sub_f32 v118, v118, v124
  v_mfma_f32_16x16x32_bf16 v[36:39], a[28:31], a[252:255], v[36:39]
  s_waitcnt lgkmcnt(6)
  v_sub_f32 v119, v119, v124
  v_sub_f32 v120, v120, v124
  v_mfma_f32_16x16x32_bf16 v[32:35], a[32:35], a[224:227], v[32:35]
  ds_read_b128 a[252:255], v3 offset:52224
  buffer_load_dwordx4 v[160:163], v3, s[4:7], s63 offen offset:3072
  s_add_u32 s63, s32, 12288
  v_mfma_f32_16x16x32_bf16 v[36:39], a[36:39], a[224:227], v[36:39]
  v_sub_f32 v121, v121, v124
  v_sub_f32 v122, v122, v124
  v_mfma_f32_16x16x32_bf16 v[32:35], a[40:43], a[228:231], v[32:35]
  s_waitcnt lgkmcnt(2)
  ds_read_b128 a[224:227], v3 offset:53248
  v_mul_f32 v56, v69, v40
  v_mul_f32 v57, v69, v41
  v_mfma_f32_16x16x32_bf16 v[36:39], a[44:47], a[228:231], v[36:39]
  v_mul_f32 v58, v69, v42
  v_mul_f32 v59, v69, v43
  v_mfma_f32_16x16x32_bf16 v[32:35], a[48:51], a[232:235], v[32:35]
  ds_read_b128 a[228:231], v3 offset:54272
  buffer_load_dwordx4 v[156:159], v3, s[4:7], s63 offen offset:0
  s_add_u32 s63, s32, 32768
  v_mfma_f32_16x16x32_bf16 v[36:39], a[52:55], a[232:235], v[36:39]
  v_mul_f32 v60, v69, v44
  v_mul_f32 v61, v69, v45
  v_mfma_f32_16x16x32_bf16 v[32:35], a[56:59], a[236:239], v[32:35]
  ds_read_b128 a[232:235], v3 offset:55296
  v_mul_f32 v62, v69, v46
  v_mul_f32 v63, v69, v47
  v_mfma_f32_16x16x32_bf16 v[36:39], a[60:63], a[236:239], v[36:39]
  v_fma_f32 v56, v24, v68, -v56
  v_fma_f32 v57, v25, v68, -v57
  v_mfma_f32_16x16x32_bf16 v[32:35], a[64:67], a[240:243], v[32:35]
  ds_read_b128 a[236:239], v3 offset:56320
  buffer_load_dwordx4 v[152:155], v3, s[4:7], s63 offen offset:0
  v_fma_f32 v58, v26, v68, -v58
  v_mfma_f32_16x16x32_bf16 v[36:39], a[68:71], a[240:243], v[36:39]
  v_fma_f32 v59, v27, v68, -v59
  v_fma_f32 v60, v28, v68, -v60
  v_mfma_f32_16x16x32_bf16 v[32:35], a[72:75], a[244:247], v[32:35]
  ds_read_b128 a[240:243], v3 offset:57344
  v_fma_f32 v61, v29, v68, -v61
  v_fma_f32 v62, v30, v68, -v62
  v_mfma_f32_16x16x32_bf16 v[36:39], a[76:79], a[244:247], v[36:39]
  s_waitcnt lgkmcnt(5)
  v_fma_f32 v63, v31, v68, -v63
  v_cvt_pk_bf16_f32 v64, v56, v57
  v_mfma_f32_16x16x32_bf16 v[32:35], a[80:83], a[248:251], v[32:35]
  ds_read_b128 a[244:247], v3 offset:58368
  v_cvt_pk_bf16_f32 v65, v58, v59
  v_cvt_pk_bf16_f32 v66, v60, v61
  v_mfma_f32_16x16x32_bf16 v[36:39], a[84:87], a[248:251], v[36:39]
  v_cvt_pk_bf16_f32 v67, v62, v63
  ds_write_b128 v6, v[64:67] offset:4352
  v_mfma_f32_16x16x32_bf16 v[32:35], a[88:91], a[252:255], v[32:35]
  ds_read_b128 a[248:251], v3 offset:59392
  v_sub_f32 v123, v123, v124
  v_exp_f32 v116, v116
  v_mfma_f32_16x16x32_bf16 v[36:39], a[92:95], a[252:255], v[36:39]
  s_waitcnt lgkmcnt(6)
  v_exp_f32 v117, v117
  v_exp_f32 v118, v118
  v_mfma_f32_16x16x32_bf16 v[32:35], a[96:99], a[224:227], v[32:35]
  ds_read_b128 a[252:255], v3 offset:60416
  v_exp_f32 v119, v119
  v_exp_f32 v120, v120
  v_mfma_f32_16x16x32_bf16 v[36:39], a[100:103], a[224:227], v[36:39]
  v_exp_f32 v121, v121
  v_exp_f32 v122, v122
  v_mfma_f32_16x16x32_bf16 v[32:35], a[104:107], a[228:231], v[32:35]
  ds_read_b128 v[72:75], v0 offset:0
  v_add_u32 v78, s44, v0
  ds_read_b64 v[76:77], v78 offset:1024
  v_mfma_f32_16x16x32_bf16 v[36:39], a[108:111], a[228:231], v[36:39]
  s_waitcnt lgkmcnt(7)
  v_exp_f32 v123, v123
  v_cvt_pk_bf16_f32 v104, v116, v117
  v_mfma_f32_16x16x32_bf16 v[32:35], a[112:115], a[232:235], v[32:35]
  v_cvt_pk_bf16_f32 v105, v118, v119
  v_cvt_pk_bf16_f32 v106, v120, v121
  v_mfma_f32_16x16x32_bf16 v[36:39], a[116:119], a[232:235], v[36:39]
  v_cvt_pk_bf16_f32 v107, v122, v123
  v_add_f32 v124, v116, v117
  s_cmp_lg_u32 s20, 0
  s_cbranch_scc1 Lpd45
  s_waitcnt vmcnt(4)
  v_cmp_ne_u32 vcc, 1, v85
  s_cbranch_vccz Lpd45
  s_lshl_b32 s62, s23, 10
  s_add_u32 s62, s62, s47
  s_mov_b32 s61, 0
Lp45:
  buffer_load_dword v85, v87, s[4:7], s62 offen sc1
  s_add_u32 s61, s61, 1
  s_cmp_gt_u32 s61, 0x100000
  s_cbranch_scc1 Lpd45
  s_waitcnt vmcnt(0)
  v_cmp_ne_u32 vcc, 1, v85
  s_cbranch_vccnz Lp45
Lpd45:
  s_barrier
  s_mul_i32 s58, s23, 1179648
  s_cmp_eq_u32 s21, 0
  s_cselect_b32 s58, 0, s58
  s_add_u32 s58, s58, s46
  s_lshl_b32 s59, s20, 10
  s_add_u32 s60, s58, s59
  s_add_u32 m0, s59, 102400
  s_nop 0
  buffer_load_dwordx4 v3, s[4:7], s60 offen sc1 lds
  s_lshl_b32 s59, s20, 6
  s_add_u32 s60, s58, s59
  s_add_u32 s60, s60, 4096
  s_add_u32 m0, s59, 106496
  s_mov_b64 exec, 0xf
  buffer_load_dwordx4 v3, s[4:7], s60 offen sc1 lds
  s_mov_b64 exec, -1
  v_mfma_f32_16x16x32_bf16 v[32:35], a[120:123], a[236:239], v[32:35]
  v_add_f32 v125, v118, v119
  v_add_f32 v126, v120, v121
  v_mfma_f32_16x16x32_bf16 v[36:39], a[124:127], a[236:239], v[36:39]
  s_waitcnt lgkmcnt(5)
  s_waitcnt lgkmcnt(0)
  s_add_u32 s60, s43, -1
  v_and_b32 v76, s60, v76
  v_and_b32 v77, s60, v77
  v_mfma_f32_16x16x32_bf16 v[32:35], a[128:131], a[240:243], v[32:35]
  v_lshlrev_b32 v79, 16, v72
  v_accvgpr_write_b32 a0, v79
  v_mfma_f32_16x16x32_bf16 v[36:39], a[132:135], a[240:243], v[36:39]
  v_and_b32 v80, 0xffff0000, v72
  v_accvgpr_write_b32 a1, v80
  v_mfma_f32_16x16x32_bf16 v[32:35], a[136:139], a[244:247], v[32:35]
  v_lshlrev_b32 v81, 16, v73
  v_accvgpr_write_b32 a2, v81
  v_mfma_f32_16x16x32_bf16 v[36:39], a[140:143], a[244:247], v[36:39]
  v_and_b32 v82, 0xffff0000, v73
  v_accvgpr_write_b32 a3, v82
  v_mfma_f32_16x16x32_bf16 v[32:35], a[144:147], a[248:251], v[32:35]
  v_lshlrev_b32 v79, 16, v74
  v_accvgpr_write_b32 a4, v79
  v_mfma_f32_16x16x32_bf16 v[36:39], a[148:151], a[248:251], v[36:39]
  v_and_b32 v80, 0xffff0000, v74
  v_accvgpr_write_b32 a5, v80
  v_mfma_f32_16x16x32_bf16 v[32:35], a[152:155], a[252:255], v[32:35]
  v_lshlrev_b32 v81, 16, v75
  v_accvgpr_write_b32 a6, v81
  v_mfma_f32_16x16x32_bf16 v[36:39], a[156:159], a[252:255], v[36:39]
  v_and_b32 v82, 0xffff0000, v75
  v_accvgpr_write_b32 a7, v82
  v_add_f32 v127, v122, v123
  v_add_f32 v124, v124, v125
  v_add_f32 v126, v126, v127
  v_add_f32 v124, v124, v126
  v_mfma_f32_16x16x32_bf16 v[116:119], v[108:111], v[104:107], 0
  v_mfma_f32_16x16x32_bf16 v[120:123], v[112:115], v[104:107], 0
  v_mov_b32 v125, v124
  s_nop 1
  v_permlane16_swap_b32 v124, v125
  v_add_f32 v124, v124, v125
  v_mov_b32 v125, v124
  s_nop 1
  v_permlane32_swap_b32 v124, v125
  v_add_f32 v124, v124, v125
  v_rcp_f32 v124, v124
  s_nop 0
  v_mul_f32 v116, v116, v124
  v_mul_f32 v117, v117, v124
  v_mul_f32 v118, v118, v124
  v_mul_f32 v119, v119, v124
  v_mul_f32 v120, v120, v124
  v_mul_f32 v121, v121, v124
  v_mul_f32 v122, v122, v124
  v_mul_f32 v123, v123, v124
  v_cvt_pk_bf16_f32 v104, v116, v117
  v_cvt_pk_bf16_f32 v105, v118, v119
  v_cvt_pk_bf16_f32 v106, v120, v121
  v_cvt_pk_bf16_f32 v107, v122, v123
  s_add_u32 s57, s71, s26
  s_add_u32 s57, s57, 102400
  s_cmp_eq_u32 s12, 1
  s_cbranch_scc1 Ldb46
  buffer_store_dwordx2 v[104:105], v10, s[4:7], s57 offen sc1
  buffer_store_dwordx2 v[106:107], v11, s[4:7], s57 offen sc1
  s_branch Lde46
Ldb46:
  buffer_store_dwordx2 v[104:105], v10, s[4:7], s57 offen
  buffer_store_dwordx2 v[106:107], v11, s[4:7], s57 offen
Lde46:
  ds_read_b64 v[70:71], v23 offset:896
  s_waitcnt lgkmcnt(0)
  v_mul_f32 v56, v71, v40
  v_mul_f32 v57, v71, v41
  v_mul_f32 v58, v71, v42
  v_mul_f32 v59, v71, v43
  v_mul_f32 v60, v71, v44
  v_mul_f32 v61, v71, v45
  v_mul_f32 v62, v71, v46
  v_mul_f32 v63, v71, v47
  v_fma_f32 v56, v32, v70, -v56
  v_fma_f32 v57, v33, v70, -v57
  v_fma_f32 v58, v34, v70, -v58
  v_fma_f32 v59, v35, v70, -v59
  v_fma_f32 v60, v36, v70, -v60
  v_fma_f32 v61, v37, v70, -v61
  v_fma_f32 v62, v38, v70, -v62
  v_fma_f32 v63, v39, v70, -v63
  v_cvt_pk_bf16_f32 v64, v56, v57
  v_cvt_pk_bf16_f32 v65, v58, v59
  v_cvt_pk_bf16_f32 v66, v60, v61
  v_cvt_pk_bf16_f32 v67, v62, v63
  ds_write_b128 v6, v[64:67] offset:0
  s_waitcnt vmcnt(2)
  s_waitcnt lgkmcnt(0)
  s_barrier
  v_mov_b32 v104, 0
  v_mov_b32 v128, 0
  v_mov_b32 v105, 0
  v_mov_b32 v129, 0
  v_mov_b32 v106, 0
  v_mov_b32 v130, 0
  v_mov_b32 v107, 0
  v_mov_b32 v131, 0
  s_mov_b32 exec_hi, 0xffff
  ds_read_b128 v[104:107], v8 offset:17408
  s_mov_b32 exec_hi, -1
  s_mov_b32 exec_hi, 0xffff
  ds_read_b128 v[128:131], v8 offset:8704
  s_mov_b32 exec_hi, -1
  ds_read_b128 v[108:111], v7 offset:13056
  ds_read_b128 v[132:135], v7 offset:4352
  ds_read_b128 v[112:115], v7 offset:17408
  ds_read_b128 v[136:139], v7 offset:8704
  s_waitcnt lgkmcnt(1)
  s_waitcnt lgkmcnt(0)
  v_mfma_f32_16x16x32_bf16 v[116:119], v[108:111], v[104:107], 0
  v_mfma_f32_16x16x32_bf16 v[140:143], v[132:135], v[128:131], 0
  v_mfma_f32_16x16x32_bf16 v[120:123], v[112:115], v[104:107], 0
  v_mfma_f32_16x16x32_bf16 v[144:147], v[136:139], v[128:131], 0
  ds_read_b64_tr_b16 v[108:109], v9 offset:13056
  ds_read_b64_tr_b16 v[132:133], v9 offset:4352
  ds_read_b64_tr_b16 v[110:111], v9 offset:17408
  ds_read_b64_tr_b16 v[134:135], v9 offset:8704
  ds_read_b64_tr_b16 v[112:113], v9 offset:13088
  ds_read_b64_tr_b16 v[136:137], v9 offset:4384
  ds_read_b64_tr_b16 v[114:115], v9 offset:17440
  ds_read_b64_tr_b16 v[138:139], v9 offset:8736
  s_mov_b32 s56, 0x3ea52b5c
  s_mov_b32 s56, 0x3ea52b5c
  v_fma_f32 v116, v116, s56, v96
  v_fma_f32 v140, v140, s56, v96
  v_fma_f32 v117, v117, s56, v97
  v_fma_f32 v141, v141, s56, v97
  v_fma_f32 v118, v118, s56, v98
  v_fma_f32 v142, v142, s56, v98
  v_fma_f32 v119, v119, s56, v99
  v_fma_f32 v143, v143, s56, v99
  v_fma_f32 v120, v120, s56, v100
  v_fma_f32 v144, v144, s56, v100
  v_fma_f32 v121, v121, s56, v101
  v_fma_f32 v145, v145, s56, v101
  v_fma_f32 v122, v122, s56, v102
  v_fma_f32 v146, v146, s56, v102
  v_fma_f32 v123, v123, s56, v103
  v_fma_f32 v147, v147, s56, v103
  v_max3_f32 v124, v116, v117, v118
  v_add_f32 v140, s51, v140
  v_max3_f32 v125, v119, v120, v121
  v_add_f32 v141, s51, v141
  v_max3_f32 v124, v124, v122, v123
  v_add_f32 v142, s51, v142
  v_max_f32 v124, v124, v125
  v_add_f32 v143, s51, v143
  v_mov_b32 v125, v124
  v_max3_f32 v148, v140, v141, v142
  s_nop 0
  v_permlane16_swap_b32 v124, v125
  v_max3_f32 v149, v143, v144, v145
  v_max_f32 v124, v124, v125
  v_max3_f32 v148, v148, v146, v147
  v_mov_b32 v125, v124
  v_max_f32 v148, v148, v149
  s_nop 0
  v_permlane32_swap_b32 v124, v125
  v_mov_b32 v149, v148
  v_max_f32 v124, v124, v125
  s_nop 0
  v_permlane16_swap_b32 v148, v149
  v_sub_f32 v116, v116, v124
  v_max_f32 v148, v148, v149
  v_sub_f32 v117, v117, v124
  v_mov_b32 v149, v148
  v_sub_f32 v118, v118, v124
  s_nop 0
  v_permlane32_swap_b32 v148, v149
  v_sub_f32 v119, v119, v124
  v_max_f32 v148, v148, v149
  v_sub_f32 v120, v120, v124
  v_sub_f32 v140, v140, v148
  v_sub_f32 v121, v121, v124
  v_sub_f32 v141, v141, v148
  v_sub_f32 v122, v122, v124
  v_sub_f32 v142, v142, v148
  v_sub_f32 v123, v123, v124
  v_sub_f32 v143, v143, v148
  v_exp_f32 v116, v116
  v_sub_f32 v144, v144, v148
  v_exp_f32 v117, v117
  v_sub_f32 v145, v145, v148
  v_exp_f32 v118, v118
  v_sub_f32 v146, v146, v148
  v_exp_f32 v119, v119
  v_sub_f32 v147, v147, v148
  s_waitcnt vmcnt(0)
  s_barrier
  s_cmp_lg_u32 s20, 0
  s_cbranch_scc1 Lf47
  s_add_u32 s62, s100, s28
  s_add_u32 s62, s62, 2048
  s_lshl_b32 s61, s22, 2
  s_add_u32 s62, s62, s61
  s_mov_b64 exec, 1
  s_cmp_eq_u32 s12, 1
  s_cbranch_scc1 Ldb48
  buffer_store_dword v86, v87, s[4:7], s62 offen sc1
  s_branch Lde48
Ldb48:
  buffer_store_dword v86, v87, s[4:7], s62 offen
Lde48:
  s_mov_b64 exec, -1
Lf47:
  v_exp_f32 v120, v120
  v_exp_f32 v140, v140
  v_exp_f32 v121, v121
  v_exp_f32 v141, v141
  v_exp_f32 v122, v122
  v_exp_f32 v142, v142
  v_exp_f32 v123, v123
  v_exp_f32 v143, v143
  v_cvt_pk_bf16_f32 v104, v116, v117
  v_exp_f32 v144, v144
  buffer_load_dwordx4 a[224:227], v3, s[4:7], s65 offen offset:3072
  v_cvt_pk_bf16_f32 v105, v118, v119
  v_exp_f32 v145, v145
  v_cvt_pk_bf16_f32 v106, v120, v121
  v_exp_f32 v146, v146
  v_cvt_pk_bf16_f32 v107, v122, v123
  v_exp_f32 v147, v147
  v_add_f32 v124, v116, v117
  v_cvt_pk_bf16_f32 v128, v140, v141
  v_add_f32 v125, v118, v119
  v_cvt_pk_bf16_f32 v129, v142, v143
  buffer_load_dwordx4 a[228:231], v3, s[4:7], s66 offen offset:3072
  v_add_f32 v126, v120, v121
  v_cvt_pk_bf16_f32 v130, v144, v145
  v_add_f32 v127, v122, v123
  v_cvt_pk_bf16_f32 v131, v146, v147
  v_add_f32 v124, v124, v125
  v_add_f32 v148, v140, v141
  v_add_f32 v126, v126, v127
  v_add_f32 v149, v142, v143
  v_add_f32 v124, v124, v126
  v_add_f32 v150, v144, v145
  buffer_load_dwordx4 a[232:235], v3, s[4:7], s67 offen offset:3072
  s_waitcnt lgkmcnt(1)
  v_add_f32 v151, v146, v147
  v_mfma_f32_16x16x32_bf16 v[116:119], v[108:111], v[104:107], 0
  v_add_f32 v148, v148, v149
  v_mfma_f32_16x16x32_bf16 v[120:123], v[112:115], v[104:107], 0
  v_add_f32 v150, v150, v151
  v_mov_b32 v125, v124
  v_add_f32 v148, v148, v150
  s_nop 0
  v_permlane16_swap_b32 v124, v125
  s_waitcnt lgkmcnt(0)
  buffer_load_dwordx4 a[236:239], v3, s[4:7], s68 offen offset:3072
  v_add_f32 v124, v124, v125
  v_mfma_f32_16x16x32_bf16 v[140:143], v[132:135], v[128:131], 0
  v_mov_b32 v125, v124
  v_mfma_f32_16x16x32_bf16 v[144:147], v[136:139], v[128:131], 0
  s_nop 0
  v_permlane32_swap_b32 v124, v125
  v_mov_b32 v149, v148
  v_add_f32 v124, v124, v125
  s_nop 0
  v_permlane16_swap_b32 v148, v149
  v_rcp_f32 v124, v124
  v_add_f32 v148, v148, v149
  s_add_u32 s63, s64, 4096
  buffer_load_dwordx4 a[240:243], v3, s[4:7], s63 offen offset:0
  v_mul_f32 v116, v116, v124
  v_mov_b32 v149, v148
  v_mul_f32 v117, v117, v124
  s_nop 0
  v_permlane32_swap_b32 v148, v149
  v_mul_f32 v118, v118, v124
  v_add_f32 v148, v148, v149
  v_mul_f32 v119, v119, v124
  v_rcp_f32 v148, v148
  v_mul_f32 v120, v120, v124
  v_mul_f32 v140, v140, v148
  s_add_u32 s63, s65, 4096
  buffer_load_dwordx4 a[244:247], v3, s[4:7], s63 offen offset:0
  v_mul_f32 v121, v121, v124
  v_mul_f32 v141, v141, v148
  v_mul_f32 v122, v122, v124
  v_mul_f32 v142, v142, v148
  v_mul_f32 v123, v123, v124
  v_mul_f32 v143, v143, v148
  v_cvt_pk_bf16_f32 v104, v116, v117
  v_mul_f32 v144, v144, v148
  v_cvt_pk_bf16_f32 v105, v118, v119
  v_mul_f32 v145, v145, v148
  s_add_u32 s63, s66, 4096
  buffer_load_dwordx4 a[248:251], v3, s[4:7], s63 offen offset:0
  v_cvt_pk_bf16_f32 v106, v120, v121
  v_mul_f32 v146, v146, v148
  v_cvt_pk_bf16_f32 v107, v122, v123
  v_mul_f32 v147, v147, v148
  s_add_u32 s57, s71, s26
  s_add_u32 s57, s57, 61440
  s_cmp_eq_u32 s12, 1
  s_cbranch_scc1 Ldb49
  buffer_store_dwordx2 v[104:105], v10, s[4:7], s57 offen sc1
  buffer_store_dwordx2 v[106:107], v11, s[4:7], s57 offen sc1
  s_branch Lde49
Ldb49:
  buffer_store_dwordx2 v[104:105], v10, s[4:7], s57 offen
  buffer_store_dwordx2 v[106:107], v11, s[4:7], s57 offen
Lde49:
  v_cvt_pk_bf16_f32 v128, v140, v141
  v_cvt_pk_bf16_f32 v129, v142, v143
  v_cvt_pk_bf16_f32 v130, v144, v145
  v_cvt_pk_bf16_f32 v131, v146, v147
  s_add_u32 s57, s71, s26
  s_add_u32 s57, s57, 20480
  s_cmp_eq_u32 s12, 1
  s_cbranch_scc1 Ldb50
  buffer_store_dwordx2 v[128:129], v10, s[4:7], s57 offen sc1
  buffer_store_dwordx2 v[130:131], v11, s[4:7], s57 offen sc1
  s_branch Lde50
Ldb50:
  buffer_store_dwordx2 v[128:129], v10, s[4:7], s57 offen
  buffer_store_dwordx2 v[130:131], v11, s[4:7], s57 offen
Lde50:
  s_add_u32 s63, s67, 4096
  buffer_load_dwordx4 a[252:255], v3, s[4:7], s63 offen offset:0
  s_add_u32 s62, s100, s28
  s_add_u32 s62, s62, 2048
  buffer_load_dword v84, v5, s[4:7], s62 offen sc1
  s_add_u32 s63, s68, 4096
  buffer_load_dwordx4 a[120:123], v3, s[4:7], s63 offen offset:0
  v_lshlrev_b32 v79, 16, v76
  v_accvgpr_write_b32 a16, v79
  v_and_b32 v80, 0xffff0000, v76
  v_accvgpr_write_b32 a17, v80
  v_lshlrev_b32 v81, 16, v77
  v_accvgpr_write_b32 a18, v81
  v_and_b32 v82, 0xffff0000, v77
  v_accvgpr_write_b32 a19, v82
  ds_read_b128 v[72:75], v0 offset:8192
  v_add_u32 v78, s44, v0
  ds_read_b64 v[76:77], v78 offset:9216
  s_waitcnt lgkmcnt(0)
  s_add_u32 s60, s43, -1
  v_and_b32 v76, s60, v76
  v_and_b32 v77, s60, v77
  v_lshlrev_b32 v79, 16, v72
  v_accvgpr_write_b32 a40, v79
  v_and_b32 v80, 0xffff0000, v72
  v_accvgpr_write_b32 a41, v80
  v_lshlrev_b32 v81, 16, v73
  v_accvgpr_write_b32 a42, v81
  v_and_b32 v82, 0xffff0000, v73
  v_accvgpr_write_b32 a43, v82
  v_lshlrev_b32 v79, 16, v74
  v_accvgpr_write_b32 a44, v79
  v_and_b32 v80, 0xffff0000, v74
  v_accvgpr_write_b32 a45, v80
  v_lshlrev_b32 v81, 16, v75
  v_accvgpr_write_b32 a46, v81
  v_and_b32 v82, 0xffff0000, v75
  v_accvgpr_write_b32 a47, v82
  v_lshlrev_b32 v79, 16, v76
  v_accvgpr_write_b32 a56, v79
  v_and_b32 v80, 0xffff0000, v76
  v_accvgpr_write_b32 a57, v80
  v_lshlrev_b32 v81, 16, v77
  v_accvgpr_write_b32 a58, v81
  v_and_b32 v82, 0xffff0000, v77
  v_accvgpr_write_b32 a59, v82
  s_add_u32 s63, s32, 12288
  buffer_load_dwordx4 v[148:151], v3, s[4:7], s63 offen offset:1024
  s_add_u32 s63, s32, 32768
  buffer_load_dwordx4 v[144:147], v3, s[4:7], s63 offen offset:1024
  s_add_u32 s63, s32, 12288
  buffer_load_dwordx4 v[140:143], v3, s[4:7], s63 offen offset:2048
  s_add_u32 s63, s32, 32768
  buffer_load_dwordx4 v[136:139], v3, s[4:7], s63 offen offset:2048
  s_cmp_lg_u32 s20, 0
  s_cbranch_scc1 Lpd51
  s_waitcnt vmcnt(5)
  v_cmp_ne_u32 vcc, 1, v84
  s_cbranch_vccz Lpd51
  s_add_u32 s62, s100, s28
  s_add_u32 s62, s62, 2048
  s_mov_b32 s61, 0
Lp51:
  buffer_load_dword v84, v5, s[4:7], s62 offen sc1
  s_add_u32 s61, s61, 1
  s_cmp_gt_u32 s61, 0x100000
  s_cbranch_scc1 Lpd51
  s_waitcnt vmcnt(0)
  v_cmp_ne_u32 vcc, 1, v84
  s_cbranch_vccnz Lp51
Lpd51:
  s_waitcnt vmcnt(7)
  s_barrier
  s_cmp_lg_u32 s20, 0
  s_cbranch_scc1 Lf52
  s_add_u32 s62, s100, s28
  s_add_u32 s62, s62, 3072
  s_lshl_b32 s61, s22, 2
  s_add_u32 s62, s62, s61
  s_mov_b64 exec, 1
  s_cmp_eq_u32 s12, 1
  s_cbranch_scc1 Ldb53
  buffer_store_dword v86, v87, s[4:7], s62 offen sc1
  s_branch Lde53
Ldb53:
  buffer_store_dword v86, v87, s[4:7], s62 offen
Lde53:
  s_mov_b64 exec, -1
Lf52:
  buffer_load_dwordx4 a[80:83], v3, s[4:7], s96 offen offset:0 sc1
  buffer_load_dwordx4 a[84:87], v3, s[4:7], s97 offen offset:0 sc1
  buffer_load_dwordx4 a[88:91], v3, s[4:7], s96 offen offset:1024 sc1
  buffer_load_dwordx4 a[92:95], v3, s[4:7], s97 offen offset:1024 sc1
  buffer_load_dwordx4 a[96:99], v3, s[4:7], s96 offen offset:2048 sc1
  buffer_load_dwordx4 a[100:103], v3, s[4:7], s97 offen offset:2048 sc1
  buffer_load_dwordx4 a[104:107], v3, s[4:7], s96 offen offset:3072 sc1
  buffer_load_dwordx4 a[108:111], v3, s[4:7], s97 offen offset:3072 sc1
  s_add_u32 s96, s96, 4096
  buffer_load_dwordx4 a[112:115], v3, s[4:7], s96 offen offset:0 sc1
  s_add_u32 s97, s97, 4096
  buffer_load_dwordx4 a[116:119], v3, s[4:7], s97 offen offset:0 sc1
  s_add_u32 s63, s32, 12288
  buffer_load_dwordx4 v[132:135], v3, s[4:7], s63 offen offset:3072
  s_add_u32 s63, s32, 32768
  buffer_load_dwordx4 v[128:131], v3, s[4:7], s63 offen offset:3072
  s_add_u32 s63, s32, 16384
  buffer_load_dwordx4 v[124:127], v3, s[4:7], s63 offen offset:0
  s_add_u32 s63, s32, 36864
  buffer_load_dwordx4 v[120:123], v3, s[4:7], s63 offen offset:0
  s_add_u32 s63, s32, 16384
  buffer_load_dwordx4 v[116:119], v3, s[4:7], s63 offen offset:1024
  s_add_u32 s63, s32, 36864
  buffer_load_dwordx4 v[112:115], v3, s[4:7], s63 offen offset:1024
  s_waitcnt vmcnt(14)
  v_mfma_f32_16x16x32_bf16 a[0:3], a[160:163], a[80:83], a[0:3]
  s_add_u32 s63, s32, 16384
  v_mfma_f32_16x16x32_bf16 a[4:7], a[164:167], a[80:83], a[4:7]
  v_mfma_f32_16x16x32_bf16 a[8:11], a[168:171], a[80:83], 0
  v_mfma_f32_16x16x32_bf16 a[12:15], a[172:175], a[80:83], 0
  buffer_load_dwordx4 v[108:111], v3, s[4:7], s63 offen offset:2048
  v_mfma_f32_16x16x32_bf16 a[16:19], a[176:179], a[80:83], a[16:19]
  s_add_u32 s63, s32, 36864
  v_mfma_f32_16x16x32_bf16 a[20:23], a[160:163], a[84:87], 0
  v_mfma_f32_16x16x32_bf16 a[24:27], a[164:167], a[84:87], 0
  v_mfma_f32_16x16x32_bf16 a[28:31], a[168:171], a[84:87], 0
  buffer_load_dwordx4 v[104:107], v3, s[4:7], s63 offen offset:2048
  v_mfma_f32_16x16x32_bf16 a[32:35], a[172:175], a[84:87], 0
  s_add_u32 s63, s32, 16384
  v_mfma_f32_16x16x32_bf16 a[36:39], a[176:179], a[84:87], 0
  s_waitcnt vmcnt(14)
  v_mfma_f32_16x16x32_bf16 a[0:3], a[180:183], a[88:91], a[0:3]
  v_mfma_f32_16x16x32_bf16 a[4:7], a[184:187], a[88:91], a[4:7]
  buffer_load_dwordx4 v[100:103], v3, s[4:7], s63 offen offset:3072
  v_mfma_f32_16x16x32_bf16 a[8:11], a[188:191], a[88:91], a[8:11]
  s_add_u32 s63, s32, 36864
  v_mfma_f32_16x16x32_bf16 a[12:15], a[192:195], a[88:91], a[12:15]
  v_mfma_f32_16x16x32_bf16 a[16:19], a[196:199], a[88:91], a[16:19]
  v_mfma_f32_16x16x32_bf16 a[20:23], a[180:183], a[92:95], a[20:23]
  buffer_load_dwordx4 v[96:99], v3, s[4:7], s63 offen offset:3072
  v_mfma_f32_16x16x32_bf16 a[24:27], a[184:187], a[92:95], a[24:27]
  v_mfma_f32_16x16x32_bf16 a[28:31], a[188:191], a[92:95], a[28:31]
  v_mfma_f32_16x16x32_bf16 a[32:35], a[192:195], a[92:95], a[32:35]
  v_mfma_f32_16x16x32_bf16 a[36:39], a[196:199], a[92:95], a[36:39]
  s_add_u32 s62, s100, s28
  s_add_u32 s62, s62, 3072
  buffer_load_dword v84, v5, s[4:7], s62 offen sc1
  s_waitcnt vmcnt(15)
  v_mfma_f32_16x16x32_bf16 a[0:3], a[200:203], a[96:99], a[0:3]
  v_mfma_f32_16x16x32_bf16 a[4:7], a[204:207], a[96:99], a[4:7]
  v_mfma_f32_16x16x32_bf16 a[8:11], a[208:211], a[96:99], a[8:11]
  v_mfma_f32_16x16x32_bf16 a[12:15], a[212:215], a[96:99], a[12:15]
  v_mfma_f32_16x16x32_bf16 a[16:19], a[216:219], a[96:99], a[16:19]
  v_mfma_f32_16x16x32_bf16 a[20:23], a[200:203], a[100:103], a[20:23]
  v_mfma_f32_16x16x32_bf16 a[24:27], a[204:207], a[100:103], a[24:27]
  v_mfma_f32_16x16x32_bf16 a[28:31], a[208:211], a[100:103], a[28:31]
  v_mfma_f32_16x16x32_bf16 a[32:35], a[212:215], a[100:103], a[32:35]
  v_mfma_f32_16x16x32_bf16 a[36:39], a[216:219], a[100:103], a[36:39]
  s_waitcnt vmcnt(13)
  v_mfma_f32_16x16x32_bf16 a[0:3], a[220:223], a[104:107], a[0:3]
  v_mfma_f32_16x16x32_bf16 a[4:7], a[224:227], a[104:107], a[4:7]
  v_mfma_f32_16x16x32_bf16 a[8:11], a[228:231], a[104:107], a[8:11]
  v_mfma_f32_16x16x32_bf16 a[12:15], a[232:235], a[104:107], a[12:15]
  v_mfma_f32_16x16x32_bf16 a[16:19], a[236:239], a[104:107], a[16:19]
  v_mfma_f32_16x16x32_bf16 a[20:23], a[220:223], a[108:111], a[20:23]
  v_mfma_f32_16x16x32_bf16 a[24:27], a[224:227], a[108:111], a[24:27]
  v_mfma_f32_16x16x32_bf16 a[28:31], a[228:231], a[108:111], a[28:31]
  v_mfma_f32_16x16x32_bf16 a[32:35], a[232:235], a[108:111], a[32:35]
  v_mfma_f32_16x16x32_bf16 a[36:39], a[236:239], a[108:111], a[36:39]
  s_waitcnt vmcnt(11)
  v_mfma_f32_16x16x32_bf16 a[0:3], a[240:243], a[112:115], a[0:3]
  v_mfma_f32_16x16x32_bf16 a[4:7], a[244:247], a[112:115], a[4:7]
  v_mfma_f32_16x16x32_bf16 a[8:11], a[248:251], a[112:115], a[8:11]
  v_mfma_f32_16x16x32_bf16 a[12:15], a[252:255], a[112:115], a[12:15]
  v_mfma_f32_16x16x32_bf16 a[16:19], a[120:123], a[112:115], a[16:19]
  v_mfma_f32_16x16x32_bf16 a[20:23], a[240:243], a[116:119], a[20:23]
  v_mfma_f32_16x16x32_bf16 a[24:27], a[244:247], a[116:119], a[24:27]
  v_mfma_f32_16x16x32_bf16 a[28:31], a[248:251], a[116:119], a[28:31]
  v_mfma_f32_16x16x32_bf16 a[32:35], a[252:255], a[116:119], a[32:35]
  v_mfma_f32_16x16x32_bf16 a[36:39], a[120:123], a[116:119], a[36:39]
  s_nop 3
  ds_write_b128 v16, a[20:23] offset:0
  ds_write_b128 v16, a[24:27] offset:1024
  ds_write_b128 v17, a[8:11] offset:0
  ds_write_b128 v17, a[12:15] offset:1024
  ds_write_b128 v18, a[28:31] offset:0
  ds_write_b128 v18, a[32:35] offset:1024
  ds_write_b128 v17, a[16:19] offset:2048
  ds_write_b128 v19, a[36:39] offset:2048
  s_cmp_lg_u32 s20, 0
  s_cbranch_scc1 Lpd54
  s_waitcnt vmcnt(0)
  v_cmp_ne_u32 vcc, 1, v84
  s_cbranch_vccz Lpd54
  s_add_u32 s62, s100, s28
  s_add_u32 s62, s62, 3072
  s_mov_b32 s61, 0
Lp54:
  buffer_load_dword v84, v5, s[4:7], s62 offen sc1
  s_add_u32 s61, s61, 1
  s_cmp_gt_u32 s61, 0x100000
  s_cbranch_scc1 Lpd54
  s_waitcnt vmcnt(0)
  v_cmp_ne_u32 vcc, 1, v84
  s_cbranch_vccnz Lp54
Lpd54:
  s_waitcnt lgkmcnt(0)
  s_barrier
  buffer_load_dwordx4 a[80:83], v3, s[4:7], s98 offen offset:0 sc1
  buffer_load_dwordx4 a[84:87], v3, s[4:7], s99 offen offset:0 sc1
  buffer_load_dwordx4 a[88:91], v3, s[4:7], s98 offen offset:1024 sc1
  buffer_load_dwordx4 a[92:95], v3, s[4:7], s99 offen offset:1024 sc1
  buffer_load_dwordx4 a[96:99], v3, s[4:7], s98 offen offset:2048 sc1
  buffer_load_dwordx4 a[100:103], v3, s[4:7], s99 offen offset:2048 sc1
  buffer_load_dwordx4 a[104:107], v3, s[4:7], s98 offen offset:3072 sc1
  buffer_load_dwordx4 a[108:111], v3, s[4:7], s99 offen offset:3072 sc1
  s_add_u32 s98, s98, 4096
  buffer_load_dwordx4 a[112:115], v3, s[4:7], s98 offen offset:0 sc1
  s_add_u32 s99, s99, 4096
  buffer_load_dwordx4 a[116:119], v3, s[4:7], s99 offen offset:0 sc1
  ds_read_b128 v[36:39], v20 offset:0
  ds_read_b128 v[40:43], v20 offset:1024
  ds_read_b128 v[44:47], v20 offset:2048
  ds_read_b128 v[48:51], v20 offset:3072
  ds_read_b128 v[52:55], v20 offset:4096
  ds_read_b128 v[56:59], v20 offset:5120
  v_accvgpr_read_b32 v24, a0
  v_accvgpr_read_b32 v25, a1
  v_accvgpr_read_b32 v26, a2
  v_accvgpr_read_b32 v27, a3
  v_accvgpr_read_b32 v28, a4
  v_accvgpr_read_b32 v29, a5
  v_accvgpr_read_b32 v30, a6
  v_accvgpr_read_b32 v31, a7
  v_accvgpr_read_b32 v32, a16
  v_accvgpr_read_b32 v33, a17
  v_accvgpr_read_b32 v34, a18
  v_accvgpr_read_b32 v35, a19
  v_mov_b32 v68, 0x3f803f80
  v_mov_b32 v66, 0
  v_mov_b32 v67, 0
  s_waitcnt lgkmcnt(3)
  v_pk_add_f32 v[24:25], v[24:25], v[36:37]
  v_pk_add_f32 v[26:27], v[26:27], v[38:39]
  v_pk_add_f32 v[28:29], v[28:29], v[40:41]
  v_pk_add_f32 v[30:31], v[30:31], v[42:43]
  v_pk_add_f32 v[32:33], v[32:33], v[44:45]
  v_pk_add_f32 v[34:35], v[34:35], v[46:47]
  ds_read_b128 v[36:39], v20 offset:6144
  ds_read_b128 v[40:43], v20 offset:7168
  ds_read_b128 v[44:47], v20 offset:8192
  s_waitcnt lgkmcnt(3)
  v_pk_add_f32 v[24:25], v[24:25], v[48:49]
  v_pk_add_f32 v[26:27], v[26:27], v[50:51]
  v_pk_add_f32 v[28:29], v[28:29], v[52:53]
  v_pk_add_f32 v[30:31], v[30:31], v[54:55]
  v_pk_add_f32 v[32:33], v[32:33], v[56:57]
  v_pk_add_f32 v[34:35], v[34:35], v[58:59]
  s_waitcnt lgkmcnt(0)
  v_pk_add_f32 v[24:25], v[24:25], v[36:37]
  v_pk_add_f32 v[26:27], v[26:27], v[38:39]
  v_pk_add_f32 v[28:29], v[28:29], v[40:41]
  v_pk_add_f32 v[30:31], v[30:31], v[42:43]
  v_pk_add_f32 v[32:33], v[32:33], v[44:45]
  v_pk_add_f32 v[34:35], v[34:35], v[46:47]
  v_cvt_pk_bf16_f32 v60, v24, v25
  v_cvt_pk_bf16_f32 v61, v26, v27
  v_cvt_pk_bf16_f32 v62, v28, v29
  v_cvt_pk_bf16_f32 v63, v30, v31
  v_cvt_pk_bf16_f32 v64, v32, v33
  v_cvt_pk_bf16_f32 v65, v34, v35
  s_add_u32 s60, s43, -1
  v_and_b32 v64, s60, v64
  v_and_b32 v65, s60, v65
  s_lshl_b32 s59, s34, 1
  s_add_u32 s59, s59, s45
  s_add_u32 s59, s59, s29
  s_add_u32 s59, s59, 4
  s_mul_i32 s60, s59, 20480
  s_add_u32 s60, s60, s8
  s_add_u32 s60, s60, 8388608
  s_lshl_b32 s59, s41, 10
  s_add_u32 s59, s59, s60
  s_lshl_b32 s58, s42, 10
  s_add_u32 s58, s58, s60
  s_add_u32 s58, s58, s44
  s_cmp_eq_u32 s43, 1
  s_cselect_b32 s58, 0x7ff00000, s58
  s_cmp_eq_u32 s12, 1
  s_cbranch_scc1 Ldb56
  buffer_store_dwordx4 v[60:63], v3, s[4:7], s59 offen sc1
  buffer_store_dwordx2 v[64:65], v3, s[4:7], s58 offen sc1
  s_branch Lde56
Ldb56:
  buffer_store_dwordx4 v[60:63], v3, s[4:7], s59 offen
  buffer_store_dwordx2 v[64:65], v3, s[4:7], s58 offen
Lde56:
  v_dot2c_f32_bf16 v66, v60, v68
  v_dot2c_f32_bf16 v67, v60, v60
  v_dot2c_f32_bf16 v66, v61, v68
  v_dot2c_f32_bf16 v67, v61, v61
  v_dot2c_f32_bf16 v66, v62, v68
  v_dot2c_f32_bf16 v67, v62, v62
  v_dot2c_f32_bf16 v66, v63, v68
  v_dot2c_f32_bf16 v67, v63, v63
  v_dot2c_f32_bf16 v66, v64, v68
  v_dot2c_f32_bf16 v67, v64, v64
  v_dot2c_f32_bf16 v66, v65, v68
  v_dot2c_f32_bf16 v67, v65, v65
  s_nop 1
  v_mov_b32 v68, v66
  v_mov_b32 v69, v67
  s_nop 0
  v_permlane16_swap_b32 v66, v68
  v_permlane16_swap_b32 v67, v69
  v_add_f32 v66, v66, v68
  v_add_f32 v67, v67, v69
  v_mov_b32 v68, v66
  v_mov_b32 v69, v67
  s_nop 0
  v_permlane32_swap_b32 v66, v68
  v_permlane32_swap_b32 v67, v69
  v_add_f32 v66, v66, v68
  v_add_f32 v67, v67, v69
  s_lshl_b32 s59, s34, 1
  s_add_u32 s59, s59, s45
  s_add_u32 s59, s59, s29
  s_add_u32 s59, s59, 4
  s_lshl_b32 s59, s59, 11
  s_lshl_b32 s60, s35, 4
  s_add_u32 s59, s59, s60
  s_lshl_b32 s60, s43, 3
  s_add_u32 s59, s59, s60
  s_add_u32 s59, s59, s10
  s_add_u32 s59, s59, 39845888
  s_mov_b64 exec, 0xffff
  s_cmp_eq_u32 s12, 1
  s_cbranch_scc1 Ldb57
  buffer_store_dwordx2 v[66:67], v21, s[4:7], s59 offen sc1
  s_branch Lde57
Ldb57:
  buffer_store_dwordx2 v[66:67], v21, s[4:7], s59 offen
Lde57:
  s_mov_b64 exec, -1
  ds_write_b128 v0, v[60:63] offset:0
  v_add_u32 v68, s44, v0
  ds_write_b64 v68, v[64:65] offset:1024
  s_waitcnt vmcnt(11)
  v_mfma_f32_16x16x32_bf16 a[40:43], a[160:163], a[80:83], a[40:43]
  v_mfma_f32_16x16x32_bf16 a[44:47], a[164:167], a[80:83], a[44:47]
  v_mfma_f32_16x16x32_bf16 a[48:51], a[168:171], a[80:83], 0
  v_mfma_f32_16x16x32_bf16 a[52:55], a[172:175], a[80:83], 0
  v_mfma_f32_16x16x32_bf16 a[56:59], a[176:179], a[80:83], a[56:59]
  v_mfma_f32_16x16x32_bf16 a[60:63], a[160:163], a[84:87], 0
  v_mfma_f32_16x16x32_bf16 a[64:67], a[164:167], a[84:87], 0
  v_mfma_f32_16x16x32_bf16 a[68:71], a[168:171], a[84:87], 0
  v_mfma_f32_16x16x32_bf16 a[72:75], a[172:175], a[84:87], 0
  v_mfma_f32_16x16x32_bf16 a[76:79], a[176:179], a[84:87], 0
  s_waitcnt vmcnt(9)
  v_mfma_f32_16x16x32_bf16 a[40:43], a[180:183], a[88:91], a[40:43]
  v_mfma_f32_16x16x32_bf16 a[44:47], a[184:187], a[88:91], a[44:47]
  v_mfma_f32_16x16x32_bf16 a[48:51], a[188:191], a[88:91], a[48:51]
  v_mfma_f32_16x16x32_bf16 a[52:55], a[192:195], a[88:91], a[52:55]
  v_mfma_f32_16x16x32_bf16 a[56:59], a[196:199], a[88:91], a[56:59]
  v_mfma_f32_16x16x32_bf16 a[60:63], a[180:183], a[92:95], a[60:63]
  v_mfma_f32_16x16x32_bf16 a[64:67], a[184:187], a[92:95], a[64:67]
  v_mfma_f32_16x16x32_bf16 a[68:71], a[188:191], a[92:95], a[68:71]
  v_mfma_f32_16x16x32_bf16 a[72:75], a[192:195], a[92:95], a[72:75]
  v_mfma_f32_16x16x32_bf16 a[76:79], a[196:199], a[92:95], a[76:79]
  s_waitcnt vmcnt(0)
  s_barrier
  s_cmp_lg_u32 s20, 0
  s_cbranch_scc1 Lf58
  s_add_u32 s62, s100, s28
  s_add_u32 s62, s62, 4096
  s_lshl_b32 s61, s22, 2
  s_add_u32 s62, s62, s61
  s_mov_b64 exec, 1
  s_cmp_eq_u32 s12, 1
  s_cbranch_scc1 Ldb59
  buffer_store_dword v86, v87, s[4:7], s62 offen sc1
  s_branch Lde59
Ldb59:
  buffer_store_dword v86, v87, s[4:7], s62 offen
Lde59:
  s_mov_b64 exec, -1
Lf58:
  v_mfma_f32_16x16x32_bf16 a[40:43], a[200:203], a[96:99], a[40:43]
  v_mfma_f32_16x16x32_bf16 a[44:47], a[204:207], a[96:99], a[44:47]
  v_mfma_f32_16x16x32_bf16 a[48:51], a[208:211], a[96:99], a[48:51]
  v_mfma_f32_16x16x32_bf16 a[52:55], a[212:215], a[96:99], a[52:55]
  v_mfma_f32_16x16x32_bf16 a[56:59], a[216:219], a[96:99], a[56:59]
  v_mfma_f32_16x16x32_bf16 a[60:63], a[200:203], a[100:103], a[60:63]
  v_mfma_f32_16x16x32_bf16 a[64:67], a[204:207], a[100:103], a[64:67]
  v_mfma_f32_16x16x32_bf16 a[68:71], a[208:211], a[100:103], a[68:71]
  v_mfma_f32_16x16x32_bf16 a[72:75], a[212:215], a[100:103], a[72:75]
  v_mfma_f32_16x16x32_bf16 a[76:79], a[216:219], a[100:103], a[76:79]
  v_mfma_f32_16x16x32_bf16 a[40:43], a[220:223], a[104:107], a[40:43]
  v_mfma_f32_16x16x32_bf16 a[44:47], a[224:227], a[104:107], a[44:47]
  v_mfma_f32_16x16x32_bf16 a[48:51], a[228:231], a[104:107], a[48:51]
  v_mfma_f32_16x16x32_bf16 a[52:55], a[232:235], a[104:107], a[52:55]
  v_mfma_f32_16x16x32_bf16 a[56:59], a[236:239], a[104:107], a[56:59]
  v_mfma_f32_16x16x32_bf16 a[60:63], a[220:223], a[108:111], a[60:63]
  v_mfma_f32_16x16x32_bf16 a[64:67], a[224:227], a[108:111], a[64:67]
  v_mfma_f32_16x16x32_bf16 a[68:71], a[228:231], a[108:111], a[68:71]
  v_mfma_f32_16x16x32_bf16 a[72:75], a[232:235], a[108:111], a[72:75]
  v_mfma_f32_16x16x32_bf16 a[76:79], a[236:239], a[108:111], a[76:79]
  v_mfma_f32_16x16x32_bf16 a[40:43], a[240:243], a[112:115], a[40:43]
  v_mfma_f32_16x16x32_bf16 a[44:47], a[244:247], a[112:115], a[44:47]
  v_mfma_f32_16x16x32_bf16 a[48:51], a[248:251], a[112:115], a[48:51]
  v_mfma_f32_16x16x32_bf16 a[52:55], a[252:255], a[112:115], a[52:55]
  v_mfma_f32_16x16x32_bf16 a[56:59], a[120:123], a[112:115], a[56:59]
  v_mfma_f32_16x16x32_bf16 a[60:63], a[240:243], a[116:119], a[60:63]
  v_mfma_f32_16x16x32_bf16 a[64:67], a[244:247], a[116:119], a[64:67]
  v_mfma_f32_16x16x32_bf16 a[68:71], a[248:251], a[116:119], a[68:71]
  v_mfma_f32_16x16x32_bf16 a[72:75], a[252:255], a[116:119], a[72:75]
  v_mfma_f32_16x16x32_bf16 a[76:79], a[120:123], a[116:119], a[76:79]
  s_nop 3
  ds_write_b128 v16, a[60:63] offset:0
  ds_write_b128 v16, a[64:67] offset:1024
  ds_write_b128 v17, a[48:51] offset:0
  ds_write_b128 v17, a[52:55] offset:1024
  ds_write_b128 v18, a[68:71] offset:0
  ds_write_b128 v18, a[72:75] offset:1024
  ds_write_b128 v17, a[56:59] offset:2048
  ds_write_b128 v19, a[76:79] offset:2048
  s_waitcnt lgkmcnt(0)
  s_barrier
  ds_read_b128 v[36:39], v20 offset:0
  ds_read_b128 v[40:43], v20 offset:1024
  ds_read_b128 v[44:47], v20 offset:2048
  ds_read_b128 v[48:51], v20 offset:3072
  ds_read_b128 v[52:55], v20 offset:4096
  ds_read_b128 v[56:59], v20 offset:5120
  v_accvgpr_read_b32 v24, a40
  v_accvgpr_read_b32 v25, a41
  v_accvgpr_read_b32 v26, a42
  v_accvgpr_read_b32 v27, a43
  v_accvgpr_read_b32 v28, a44
  v_accvgpr_read_b32 v29, a45
  v_accvgpr_read_b32 v30, a46
  v_accvgpr_read_b32 v31, a47
  v_accvgpr_read_b32 v32, a56
  v_accvgpr_read_b32 v33, a57
  v_accvgpr_read_b32 v34, a58
  v_accvgpr_read_b32 v35, a59
  v_mov_b32 v68, 0x3f803f80
  v_mov_b32 v66, 0
  v_mov_b32 v67, 0
  s_waitcnt lgkmcnt(3)
  v_pk_add_f32 v[24:25], v[24:25], v[36:37]
  v_pk_add_f32 v[26:27], v[26:27], v[38:39]
  v_pk_add_f32 v[28:29], v[28:29], v[40:41]
  v_pk_add_f32 v[30:31], v[30:31], v[42:43]
  v_pk_add_f32 v[32:33], v[32:33], v[44:45]
  v_pk_add_f32 v[34:35], v[34:35], v[46:47]
  ds_read_b128 v[36:39], v20 offset:6144
  ds_read_b128 v[40:43], v20 offset:7168
  s_add_u32 s62, s100, s28
  s_add_u32 s62, s62, 4096
  buffer_load_dword v84, v5, s[4:7], s62 offen sc1
  ds_read_b128 v[44:47], v20 offset:8192
  s_waitcnt lgkmcnt(3)
  v_pk_add_f32 v[24:25], v[24:25], v[48:49]
  v_pk_add_f32 v[26:27], v[26:27], v[50:51]
  v_pk_add_f32 v[28:29], v[28:29], v[52:53]
  v_pk_add_f32 v[30:31], v[30:31], v[54:55]
  v_pk_add_f32 v[32:33], v[32:33], v[56:57]
  v_pk_add_f32 v[34:35], v[34:35], v[58:59]
  s_waitcnt lgkmcnt(0)
  v_pk_add_f32 v[24:25], v[24:25], v[36:37]
  v_pk_add_f32 v[26:27], v[26:27], v[38:39]
  v_pk_add_f32 v[28:29], v[28:29], v[40:41]
  v_pk_add_f32 v[30:31], v[30:31], v[42:43]
  v_pk_add_f32 v[32:33], v[32:33], v[44:45]
  v_pk_add_f32 v[34:35], v[34:35], v[46:47]
  v_cvt_pk_bf16_f32 v60, v24, v25
  v_cvt_pk_bf16_f32 v61, v26, v27
  v_cvt_pk_bf16_f32 v62, v28, v29
  v_cvt_pk_bf16_f32 v63, v30, v31
  v_cvt_pk_bf16_f32 v64, v32, v33
  v_cvt_pk_bf16_f32 v65, v34, v35
  s_add_u32 s60, s43, -1
  v_and_b32 v64, s60, v64
  v_and_b32 v65, s60, v65
  s_lshl_b32 s59, s34, 1
  s_add_u32 s59, s59, s45
  s_add_u32 s59, s59, s29
  s_mul_i32 s60, s59, 20480
  s_add_u32 s60, s60, s8
  s_add_u32 s60, s60, 8388608
  s_lshl_b32 s59, s41, 10
  s_add_u32 s59, s59, s60
  s_lshl_b32 s58, s42, 10
  s_add_u32 s58, s58, s60
  s_add_u32 s58, s58, s44
  s_cmp_eq_u32 s43, 1
  s_cselect_b32 s58, 0x7ff00000, s58
  s_cmp_eq_u32 s12, 1
  s_cbranch_scc1 Ldb61
  buffer_store_dwordx4 v[60:63], v3, s[4:7], s59 offen sc1
  buffer_store_dwordx2 v[64:65], v3, s[4:7], s58 offen sc1
  s_branch Lde61
Ldb61:
  buffer_store_dwordx4 v[60:63], v3, s[4:7], s59 offen
  buffer_store_dwordx2 v[64:65], v3, s[4:7], s58 offen
Lde61:
  v_dot2c_f32_bf16 v66, v60, v68
  v_dot2c_f32_bf16 v67, v60, v60
  v_dot2c_f32_bf16 v66, v61, v68
  v_dot2c_f32_bf16 v67, v61, v61
  v_dot2c_f32_bf16 v66, v62, v68
  v_dot2c_f32_bf16 v67, v62, v62
  v_dot2c_f32_bf16 v66, v63, v68
  v_dot2c_f32_bf16 v67, v63, v63
  v_dot2c_f32_bf16 v66, v64, v68
  v_dot2c_f32_bf16 v67, v64, v64
  v_dot2c_f32_bf16 v66, v65, v68
  v_dot2c_f32_bf16 v67, v65, v65
  s_nop 1
  v_mov_b32 v68, v66
  v_mov_b32 v69, v67
  s_nop 0
  v_permlane16_swap_b32 v66, v68
  v_permlane16_swap_b32 v67, v69
  v_add_f32 v66, v66, v68
  v_add_f32 v67, v67, v69
  v_mov_b32 v68, v66
  v_mov_b32 v69, v67
  s_nop 0
  v_permlane32_swap_b32 v66, v68
  v_permlane32_swap_b32 v67, v69
  v_add_f32 v66, v66, v68
  v_add_f32 v67, v67, v69
  s_lshl_b32 s59, s34, 1
  s_add_u32 s59, s59, s45
  s_add_u32 s59, s59, s29
  s_lshl_b32 s59, s59, 11
  s_lshl_b32 s60, s35, 4
  s_add_u32 s59, s59, s60
  s_lshl_b32 s60, s43, 3
  s_add_u32 s59, s59, s60
  s_add_u32 s59, s59, s10
  s_add_u32 s59, s59, 39845888
  s_mov_b64 exec, 0xffff
  s_cmp_eq_u32 s12, 1
  s_cbranch_scc1 Ldb62
  buffer_store_dwordx2 v[66:67], v21, s[4:7], s59 offen sc1
  s_branch Lde62
Ldb62:
  buffer_store_dwordx2 v[66:67], v21, s[4:7], s59 offen
Lde62:
  s_mov_b64 exec, -1
  ds_write_b128 v0, v[60:63] offset:8192
  v_add_u32 v68, s44, v0
  ds_write_b64 v68, v[64:65] offset:9216
  s_mul_i32 s63, s20, 14336
  s_add_u32 s63, s63, 5767168
  s_mul_i32 s64, s36, 55296
  s_add_u32 s64, s64, s63
  s_mul_i32 s65, s37, 55296
  s_add_u32 s65, s65, s63
  s_mul_i32 s66, s38, 55296
  s_add_u32 s66, s66, s63
  s_mul_i32 s67, s39, 55296
  s_add_u32 s67, s67, s63
  s_mul_i32 s68, s40, 55296
  s_add_u32 s68, s68, s63
  buffer_load_dwordx4 a[0:3], v3, s[4:7], s64 offen offset:0
  buffer_load_dwordx4 a[4:7], v3, s[4:7], s65 offen offset:0
  buffer_load_dwordx4 a[8:11], v3, s[4:7], s66 offen offset:0
  buffer_load_dwordx4 a[12:15], v3, s[4:7], s67 offen offset:0
  buffer_load_dwordx4 a[16:19], v3, s[4:7], s68 offen offset:0
  buffer_load_dwordx4 a[20:23], v3, s[4:7], s64 offen offset:1024
  s_cmp_lg_u32 s20, 0
  s_cbranch_scc1 Lpd63
  s_waitcnt vmcnt(9)
  v_cmp_ne_u32 vcc, 1, v84
  s_cbranch_vccz Lpd63
  s_add_u32 s62, s100, s28
  s_add_u32 s62, s62, 4096
  s_mov_b32 s61, 0
Lp63:
  buffer_load_dword v84, v5, s[4:7], s62 offen sc1
  s_add_u32 s61, s61, 1
  s_cmp_gt_u32 s61, 0x100000
  s_cbranch_scc1 Lpd63
  s_waitcnt vmcnt(0)
  v_cmp_ne_u32 vcc, 1, v84
  s_cbranch_vccnz Lp63
Lpd63:
  s_waitcnt vmcnt(6)
  s_barrier
  s_cmp_lg_u32 s20, 0
  s_cbranch_scc1 Lf64
  s_add_u32 s62, s100, s28
  s_add_u32 s62, s62, 5120
  s_lshl_b32 s61, s22, 2
  s_add_u32 s62, s62, s61
  s_mov_b64 exec, 1
  s_cmp_eq_u32 s12, 1
  s_cbranch_scc1 Ldb65
  buffer_store_dword v86, v87, s[4:7], s62 offen sc1
  s_branch Lde65
Ldb65:
  buffer_store_dword v86, v87, s[4:7], s62 offen
Lde65:
  s_mov_b64 exec, -1
Lf64:
  s_sub_u32 s53, s29, s20
  s_lshl_b32 s53, s53, 11
  s_add_u32 s53, s53, s10
  s_add_u32 s53, s53, 39860224
  buffer_load_dwordx4 v[72:75], v12, s[4:7], s53 offen sc1
  buffer_load_dwordx4 v[76:79], v12, s[4:7], s53 offen offset:16 sc1
  s_add_u32 s52, s3, s8
  s_add_u32 s52, s52, 8531968
  s_add_u32 m0, s30, 0
  s_nop 0
  buffer_load_dwordx4 v3, s[4:7], s52 offen offset:0 sc1 lds
  buffer_load_dwordx4 v3, s[4:7], s52 offen offset:1024 sc1 lds
  buffer_load_dwordx4 v3, s[4:7], s52 offen offset:2048 sc1 lds
  buffer_load_dwordx4 v3, s[4:7], s52 offen offset:3072 sc1 lds
  s_add_u32 s52, s52, 4096
  s_add_u32 m0, s30, 4096
  s_nop 0
  buffer_load_dwordx4 v3, s[4:7], s52 offen offset:0 sc1 lds
  s_add_u32 s52, s3, s8
  s_add_u32 s52, s52, 8511488
  s_add_u32 m0, s30, 20480
  s_nop 0
  buffer_load_dwordx4 v3, s[4:7], s52 offen offset:0 sc1 lds
  buffer_load_dwordx4 v3, s[4:7], s52 offen offset:1024 sc1 lds
  buffer_load_dwordx4 v3, s[4:7], s52 offen offset:2048 sc1 lds
  buffer_load_dwordx4 v3, s[4:7], s52 offen offset:3072 sc1 lds
  s_add_u32 s52, s52, 4096
  s_add_u32 m0, s30, 24576
  s_nop 0
  buffer_load_dwordx4 v3, s[4:7], s52 offen offset:0 sc1 lds
  buffer_load_dwordx4 a[24:27], v3, s[4:7], s65 offen offset:1024
  buffer_load_dwordx4 a[28:31], v3, s[4:7], s66 offen offset:1024
  buffer_load_dwordx4 a[32:35], v3, s[4:7], s67 offen offset:1024
  buffer_load_dwordx4 a[36:39], v3, s[4:7], s68 offen offset:1024
  buffer_load_dwordx4 a[40:43], v3, s[4:7], s64 offen offset:2048
  buffer_load_dwordx4 a[44:47], v3, s[4:7], s65 offen offset:2048
  s_waitcnt vmcnt(11)
  s_barrier
  ds_read_b128 a[224:227], v3 offset:0
  ds_read_b128 a[228:231], v3 offset:1024
  ds_read_b128 a[232:235], v3 offset:2048
  ds_read_b128 a[236:239], v3 offset:3072
  ds_read_b128 a[240:243], v3 offset:4096
  ds_read_b128 a[244:247], v3 offset:5120
  ds_read_b128 a[248:251], v3 offset:6144
  s_waitcnt lgkmcnt(5)
  v_mfma_f32_16x16x32_bf16 v[24:27], v[252:255], a[224:227], 0
  s_add_u32 s52, s3, s8
  ds_read_b128 a[252:255], v3 offset:7168
  s_add_u32 s52, s52, 8491008
  s_add_u32 m0, s30, 40960
  v_mfma_f32_16x16x32_bf16 v[28:31], v[248:251], a[224:227], 0
  v_add_f32 v72, v72, v74
  v_add_f32 v73, v73, v75
  v_mfma_f32_16x16x32_bf16 v[24:27], v[244:247], a[228:231], v[24:27]
  ds_read_b128 a[224:227], v3 offset:8192
  v_add_f32 v76, v76, v78
  v_add_f32 v77, v77, v79
  v_mfma_f32_16x16x32_bf16 v[28:31], v[240:243], a[228:231], v[28:31]
  s_waitcnt lgkmcnt(5)
  buffer_load_dwordx4 v3, s[4:7], s52 offen offset:0 sc1 lds
  v_add_f32 v72, v72, v76
  v_mfma_f32_16x16x32_bf16 v[24:27], v[236:239], a[232:235], v[24:27]
  ds_read_b128 a[228:231], v3 offset:9216
  v_add_f32 v73, v73, v77
  v_mov_b32 v74, v72
  v_mfma_f32_16x16x32_bf16 v[28:31], v[232:235], a[232:235], v[28:31]
  v_mov_b32 v75, v73
  v_permlane16_swap_b32 v72, v74
  v_mfma_f32_16x16x32_bf16 v[24:27], v[228:231], a[236:239], v[24:27]
  ds_read_b128 a[232:235], v3 offset:10240
  v_permlane16_swap_b32 v73, v75
  v_add_f32 v72, v72, v74
  v_mfma_f32_16x16x32_bf16 v[28:31], v[224:227], a[236:239], v[28:31]
  s_waitcnt lgkmcnt(5)
  buffer_load_dwordx4 v3, s[4:7], s52 offen offset:1024 sc1 lds
  v_add_f32 v73, v73, v75
  v_mfma_f32_16x16x32_bf16 v[24:27], v[220:223], a[240:243], v[24:27]
  ds_read_b128 a[236:239], v3 offset:11264
  v_mov_b32 v74, v72
  v_mov_b32 v75, v73
  v_mfma_f32_16x16x32_bf16 v[28:31], v[216:219], a[240:243], v[28:31]
  v_permlane32_swap_b32 v72, v74
  v_permlane32_swap_b32 v73, v75
  v_mfma_f32_16x16x32_bf16 v[24:27], v[212:215], a[244:247], v[24:27]
  ds_read_b128 a[240:243], v3 offset:12288
  v_add_f32 v72, v72, v74
  v_add_f32 v73, v73, v75
  v_mfma_f32_16x16x32_bf16 v[28:31], v[208:211], a[244:247], v[28:31]
  s_waitcnt lgkmcnt(5)
  buffer_load_dwordx4 v3, s[4:7], s52 offen offset:2048 sc1 lds
  v_mul_f32 v72, 0x3acccccd, v72
  v_mfma_f32_16x16x32_bf16 v[24:27], v[204:207], a[248:251], v[24:27]
  ds_read_b128 a[244:247], v3 offset:13312
  v_mul_f32 v73, 0x3acccccd, v73
  v_fma_f32 v73, -v72, v72, v73
  v_mfma_f32_16x16x32_bf16 v[28:31], v[200:203], a[248:251], v[28:31]
  v_max_f32 v73, 0, v73
  v_cvt_pk_bf16_f32 v74, v72, v73
  v_mfma_f32_16x16x32_bf16 v[24:27], v[196:199], a[252:255], v[24:27]
  ds_read_b128 a[248:251], v3 offset:14336
  v_lshlrev_b32 v72, 16, v74
  v_and_b32 v73, 0xffff0000, v74
  v_mfma_f32_16x16x32_bf16 v[28:31], v[192:195], a[252:255], v[28:31]
  s_waitcnt lgkmcnt(5)
  buffer_load_dwordx4 v3, s[4:7], s52 offen offset:3072 sc1 lds
  s_add_u32 s52, s52, 4096
  v_mfma_f32_16x16x32_bf16 v[24:27], v[188:191], a[224:227], v[24:27]
  ds_read_b128 a[252:255], v3 offset:15360
  s_add_u32 m0, s30, 45056
  v_add_f32 v73, 0x3727c5ac, v73
  v_mfma_f32_16x16x32_bf16 v[28:31], v[184:187], a[224:227], v[28:31]
  v_cvt_pk_bf16_f32 v73, v73, v73
  v_lshlrev_b32 v73, 16, v73
  v_mfma_f32_16x16x32_bf16 v[24:27], v[180:183], a[228:231], v[24:27]
  ds_read_b128 a[224:227], v3 offset:16384
  v_sqrt_f32 v73, v73
  s_nop 0
  v_cvt_pk_bf16_f32 v73, v73, v73
  v_mfma_f32_16x16x32_bf16 v[28:31], v[176:179], a[228:231], v[28:31]
  s_waitcnt lgkmcnt(5)
  buffer_load_dwordx4 v3, s[4:7], s52 offen offset:0 sc1 lds
  s_add_u32 s52, s3, s8
  v_mfma_f32_16x16x32_bf16 v[24:27], v[172:175], a[232:235], v[24:27]
  ds_read_b128 a[228:231], v3 offset:17408
  s_add_u32 s52, s52, 8470528
  s_add_u32 m0, s30, 61440
  v_mfma_f32_16x16x32_bf16 v[28:31], v[168:171], a[232:235], v[28:31]
  v_lshlrev_b32 v73, 16, v73
  v_rcp_f32 v74, v73
  v_mfma_f32_16x16x32_bf16 v[24:27], v[164:167], a[236:239], v[24:27]
  ds_read_b128 a[232:235], v3 offset:18432
  s_lshl_b32 s53, s20, 7
  v_add_u32 v76, s53, v23
  v_mfma_f32_16x16x32_bf16 v[28:31], v[160:163], a[236:239], v[28:31]
  s_waitcnt lgkmcnt(5)
  buffer_load_dwordx4 v3, s[4:7], s52 offen offset:0 sc1 lds
  v_mul_f32 v75, v72, v74
  v_mfma_f32_16x16x32_bf16 v[24:27], v[156:159], a[240:243], v[24:27]
  ds_read_b128 a[236:239], v3 offset:19456
  ds_write_b64 v76, v[74:75] offset:0
  v_mfma_f32_16x16x32_bf16 v[28:31], v[152:155], a[240:243], v[28:31]
  v_mfma_f32_16x16x32_bf16 v[24:27], v[148:151], a[244:247], v[24:27]
  s_waitcnt lgkmcnt(0)
  s_waitcnt vmcnt(12)
  s_barrier
  s_add_u32 s62, s100, s28
  s_add_u32 s62, s62, 5120
  buffer_load_dword v84, v5, s[4:7], s62 offen sc1
  ds_read_b128 a[240:243], v3 offset:20480
  v_mfma_f32_16x16x32_bf16 v[28:31], v[144:147], a[244:247], v[28:31]
  buffer_load_dwordx4 v3, s[4:7], s52 offen offset:1024 sc1 lds
  v_mfma_f32_16x16x32_bf16 v[24:27], v[140:143], a[248:251], v[24:27]
  ds_read_b128 a[244:247], v3 offset:21504
  v_mfma_f32_16x16x32_bf16 v[28:31], v[136:139], a[248:251], v[28:31]
  v_mfma_f32_16x16x32_bf16 v[24:27], v[132:135], a[252:255], v[24:27]
  ds_read_b128 a[248:251], v3 offset:22528
  v_mfma_f32_16x16x32_bf16 v[28:31], v[128:131], a[252:255], v[28:31]
  buffer_load_dwordx4 v3, s[4:7], s52 offen offset:2048 sc1 lds
  v_mfma_f32_16x16x32_bf16 v[24:27], v[124:127], a[224:227], v[24:27]
  ds_read_b128 a[252:255], v3 offset:23552
  v_mfma_f32_16x16x32_bf16 v[28:31], v[120:123], a[224:227], v[28:31]
  v_mfma_f32_16x16x32_bf16 v[24:27], v[116:119], a[228:231], v[24:27]
  ds_read_b128 a[224:227], v3 offset:24576
  v_mfma_f32_16x16x32_bf16 v[28:31], v[112:115], a[228:231], v[28:31]
  buffer_load_dwordx4 v3, s[4:7], s52 offen offset:3072 sc1 lds
  s_add_u32 s52, s52, 4096
  v_mfma_f32_16x16x32_bf16 v[24:27], v[108:111], a[232:235], v[24:27]
  ds_read_b128 a[228:231], v3 offset:25600
  s_add_u32 m0, s30, 65536
  v_mfma_f32_16x16x32_bf16 v[28:31], v[104:107], a[232:235], v[28:31]
  v_mfma_f32_16x16x32_bf16 v[24:27], v[100:103], a[236:239], v[24:27]
  ds_read_b128 a[232:235], v3 offset:26624
  v_mfma_f32_16x16x32_bf16 v[28:31], v[96:99], a[236:239], v[28:31]
  s_waitcnt lgkmcnt(5)
  buffer_load_dwordx4 v3, s[4:7], s52 offen offset:0 sc1 lds
  ds_read_b128 v[40:43], v1 offset:128
  ds_read_b128 v[44:47], v1 offset:144
  ds_read_b128 v[48:51], v1 offset:256
  ds_read_b128 v[52:55], v1 offset:272
  v_mfma_f32_16x16x32_bf16 v[32:35], v[252:255], a[240:243], 0
  ds_read_b128 a[236:239], v3 offset:27648
  v_mfma_f32_16x16x32_bf16 v[36:39], v[248:251], a[240:243], 0
  v_mfma_f32_16x16x32_bf16 v[32:35], v[244:247], a[244:247], v[32:35]
  ds_read_b128 a[240:243], v3 offset:28672
  v_mfma_f32_16x16x32_bf16 v[36:39], v[240:243], a[244:247], v[36:39]
  s_waitcnt lgkmcnt(9)
  buffer_load_dwordx4 a[48:51], v3, s[4:7], s66 offen offset:2048
  v_mfma_f32_16x16x32_bf16 v[32:35], v[236:239], a[248:251], v[32:35]
  ds_read_b128 a[244:247], v3 offset:29696
  ds_read_b64 v[68:69], v23 offset:0
  v_mfma_f32_16x16x32_bf16 v[36:39], v[232:235], a[248:251], v[36:39]
  v_mfma_f32_16x16x32_bf16 v[32:35], v[228:231], a[252:255], v[32:35]
  ds_read_b128 a[248:251], v3 offset:30720
  v_mfma_f32_16x16x32_bf16 v[36:39], v[224:227], a[252:255], v[36:39]
  s_waitcnt lgkmcnt(10)
  buffer_load_dwordx4 a[52:55], v3, s[4:7], s67 offen offset:2048
  v_mfma_f32_16x16x32_bf16 v[32:35], v[220:223], a[224:227], v[32:35]
  ds_read_b128 a[252:255], v3 offset:31744
  v_mfma_f32_16x16x32_bf16 v[36:39], v[216:219], a[224:227], v[36:39]
  s_waitcnt lgkmcnt(2)
  s_add_u32 s54, s70, s27
  s_add_u32 s54, s54, 401408
  v_mfma_f32_16x16x32_bf16 v[32:35], v[212:215], a[228:231], v[32:35]
  ds_read_b128 a[224:227], v3 offset:32768
  v_fma_f32 v56, -v69, v40, v48
  v_fma_f32 v57, -v69, v41, v49
  v_mfma_f32_16x16x32_bf16 v[36:39], v[208:211], a[228:231], v[36:39]
  buffer_load_dwordx4 a[56:59], v3, s[4:7], s68 offen offset:2048
  v_fma_f32 v58, -v69, v42, v50
  v_mfma_f32_16x16x32_bf16 v[32:35], v[204:207], a[232:235], v[32:35]
  ds_read_b128 a[228:231], v3 offset:33792
  v_fma_f32 v59, -v69, v43, v51
  v_fma_f32 v60, -v69, v44, v52
  v_mfma_f32_16x16x32_bf16 v[36:39], v[200:203], a[232:235], v[36:39]
  v_fma_f32 v61, -v69, v45, v53
  v_fma_f32 v62, -v69, v46, v54
  v_mfma_f32_16x16x32_bf16 v[32:35], v[196:199], a[236:239], v[32:35]
  ds_read_b128 a[232:235], v3 offset:34816
  v_fma_f32 v63, -v69, v47, v55
  v_fma_f32 v56, v24, v68, v56
  v_mfma_f32_16x16x32_bf16 v[36:39], v[192:195], a[236:239], v[36:39]
  buffer_load_dwordx4 a[60:63], v3, s[4:7], s64 offen offset:3072
  v_fma_f32 v57, v25, v68, v57
  v_mfma_f32_16x16x32_bf16 v[32:35], v[188:191], a[240:243], v[32:35]
  ds_read_b128 a[236:239], v3 offset:35840
  v_fma_f32 v58, v26, v68, v58
  v_fma_f32 v59, v27, v68, v59
  v_mfma_f32_16x16x32_bf16 v[36:39], v[184:187], a[240:243], v[36:39]
  v_fma_f32 v60, v28, v68, v60
  v_fma_f32 v61, v29, v68, v61
  v_mfma_f32_16x16x32_bf16 v[32:35], v[180:183], a[244:247], v[32:35]
  ds_read_b128 a[240:243], v3 offset:36864
  v_fma_f32 v62, v30, v68, v62
  v_fma_f32 v63, v31, v68, v63
  v_mfma_f32_16x16x32_bf16 v[36:39], v[176:179], a[244:247], v[36:39]
  s_waitcnt lgkmcnt(5)
  buffer_load_dwordx4 a[64:67], v3, s[4:7], s65 offen offset:3072
  v_mul_f32 v56, v56, |v56|
  v_mfma_f32_16x16x32_bf16 v[32:35], v[172:175], a[248:251], v[32:35]
  ds_read_b128 a[244:247], v3 offset:37888
  v_mul_f32 v57, v57, |v57|
  v_mul_f32 v58, v58, |v58|
  v_mfma_f32_16x16x32_bf16 v[36:39], v[168:171], a[248:251], v[36:39]
  v_mul_f32 v59, v59, |v59|
  v_mul_f32 v60, v60, |v60|
  v_mfma_f32_16x16x32_bf16 v[32:35], v[164:167], a[252:255], v[32:35]
  ds_read_b128 a[248:251], v3 offset:38912
  v_mul_f32 v61, v61, |v61|
  v_mul_f32 v62, v62, |v62|
  v_mfma_f32_16x16x32_bf16 v[36:39], v[160:163], a[252:255], v[36:39]
  s_waitcnt lgkmcnt(5)
  buffer_load_dwordx4 a[68:71], v3, s[4:7], s66 offen offset:3072
  v_mul_f32 v63, v63, |v63|
  v_mfma_f32_16x16x32_bf16 v[32:35], v[156:159], a[224:227], v[32:35]
  ds_read_b128 a[252:255], v3 offset:39936
  v_cvt_pk_bf16_f32 v64, v56, v57
  v_cvt_pk_bf16_f32 v65, v58, v59
  v_mfma_f32_16x16x32_bf16 v[36:39], v[152:155], a[224:227], v[36:39]
  v_cvt_pk_bf16_f32 v66, v60, v61
  v_cvt_pk_bf16_f32 v67, v62, v63
  v_mfma_f32_16x16x32_bf16 v[32:35], v[148:151], a[228:231], v[32:35]
  s_cmp_lg_u32 s20, 0
  s_cbranch_scc1 Lpd66
  s_waitcnt vmcnt(10)
  v_cmp_ne_u32 vcc, 1, v84
  s_cbranch_vccz Lpd66
  s_add_u32 s62, s100, s28
  s_add_u32 s62, s62, 5120
  s_mov_b32 s61, 0
Lp66:
  buffer_load_dword v84, v5, s[4:7], s62 offen sc1
  s_add_u32 s61, s61, 1
  s_cmp_gt_u32 s61, 0x100000
  s_cbranch_scc1 Lpd66
  s_waitcnt vmcnt(0)
  v_cmp_ne_u32 vcc, 1, v84
  s_cbranch_vccnz Lp66
Lpd66:
  s_waitcnt vmcnt(12)
  s_barrier
  s_sub_u32 s53, s29, s20
  s_lshl_b32 s53, s53, 11
  s_add_u32 s53, s53, s10
  s_add_u32 s53, s53, 39852032
  buffer_load_dwordx4 v[72:75], v12, s[4:7], s53 offen sc1
  buffer_load_dwordx4 v[76:79], v12, s[4:7], s53 offen offset:16 sc1
  s_add_u32 s52, s3, s8
  ds_read_b128 a[224:227], v3 offset:40960
  s_add_u32 s52, s52, 8450048
  s_add_u32 m0, s30, 81920
  v_mfma_f32_16x16x32_bf16 v[36:39], v[144:147], a[228:231], v[36:39]
  s_waitcnt lgkmcnt(5)
  buffer_load_dwordx4 v3, s[4:7], s52 offen offset:0 sc1 lds
  v_pk_max_i16 v64, v64, 0
  v_mfma_f32_16x16x32_bf16 v[32:35], v[140:143], a[232:235], v[32:35]
  ds_read_b128 a[228:231], v3 offset:41984
  v_pk_max_i16 v65, v65, 0
  v_pk_max_i16 v66, v66, 0
  v_mfma_f32_16x16x32_bf16 v[36:39], v[136:139], a[232:235], v[36:39]
  v_pk_max_i16 v67, v67, 0
  buffer_store_dwordx4 v[64:67], v3, s[4:7], s54 offen sc1
  v_mfma_f32_16x16x32_bf16 v[32:35], v[132:135], a[236:239], v[32:35]
  ds_read_b128 a[232:235], v3 offset:43008
  v_mfma_f32_16x16x32_bf16 v[36:39], v[128:131], a[236:239], v[36:39]
  s_waitcnt lgkmcnt(5)
  buffer_load_dwordx4 v3, s[4:7], s52 offen offset:1024 sc1 lds
  v_mfma_f32_16x16x32_bf16 v[32:35], v[124:127], a[240:243], v[32:35]
  ds_read_b128 a[236:239], v3 offset:44032
  v_mfma_f32_16x16x32_bf16 v[36:39], v[120:123], a[240:243], v[36:39]
  v_mfma_f32_16x16x32_bf16 v[32:35], v[116:119], a[244:247], v[32:35]
  ds_read_b128 a[240:243], v3 offset:45056
  v_mfma_f32_16x16x32_bf16 v[36:39], v[112:115], a[244:247], v[36:39]
  s_waitcnt lgkmcnt(5)
  buffer_load_dwordx4 v3, s[4:7], s52 offen offset:2048 sc1 lds
  v_mfma_f32_16x16x32_bf16 v[32:35], v[108:111], a[248:251], v[32:35]
  ds_read_b128 a[244:247], v3 offset:46080
  v_mfma_f32_16x16x32_bf16 v[36:39], v[104:107], a[248:251], v[36:39]
  v_mfma_f32_16x16x32_bf16 v[32:35], v[100:103], a[252:255], v[32:35]
  ds_read_b128 a[248:251], v3 offset:47104
  v_mfma_f32_16x16x32_bf16 v[36:39], v[96:99], a[252:255], v[36:39]
  s_waitcnt lgkmcnt(5)
  buffer_load_dwordx4 v3, s[4:7], s52 offen offset:3072 sc1 lds
  s_add_u32 s52, s52, 4096
  v_mfma_f32_16x16x32_bf16 v[24:27], v[252:255], a[224:227], 0
  ds_read_b128 a[252:255], v3 offset:48128
  s_add_u32 m0, s30, 86016
  v_mfma_f32_16x16x32_bf16 v[28:31], v[248:251], a[224:227], 0
  v_mfma_f32_16x16x32_bf16 v[24:27], v[244:247], a[228:231], v[24:27]
  ds_read_b128 a[224:227], v3 offset:49152
  v_mfma_f32_16x16x32_bf16 v[28:31], v[240:243], a[228:231], v[28:31]
  s_waitcnt lgkmcnt(5)
  buffer_load_dwordx4 v3, s[4:7], s52 offen offset:0 sc1 lds
  s_add_u32 s52, s3, s8
  v_mfma_f32_16x16x32_bf16 v[24:27], v[236:239], a[232:235], v[24:27]
  ds_read_b128 a[228:231], v3 offset:50176
  s_add_u32 s52, s52, 8429568
  s_add_u32 m0, s30, 0
  v_mfma_f32_16x16x32_bf16 v[28:31], v[232:235], a[232:235], v[28:31]
  ds_read_b64 v[70:71], v23 offset:128
  v_mfma_f32_16x16x32_bf16 v[24:27], v[228:231], a[236:239], v[24:27]
  ds_read_b128 a[232:235], v3 offset:51200
  v_mfma_f32_16x16x32_bf16 v[28:31], v[224:227], a[236:239], v[28:31]
  s_waitcnt lgkmcnt(6)
  buffer_load_dwordx4 v3, s[4:7], s52 offen offset:0 sc1 lds
  v_mfma_f32_16x16x32_bf16 v[24:27], v[220:223], a[240:243], v[24:27]
  ds_read_b128 a[236:239], v3 offset:52224
  v_mfma_f32_16x16x32_bf16 v[28:31], v[216:219], a[240:243], v[28:31]
  v_mfma_f32_16x16x32_bf16 v[24:27], v[212:215], a[244:247], v[24:27]
  s_waitcnt lgkmcnt(2)
  ds_read_b128 a[240:243], v3 offset:53248
  s_add_u32 s54, s70, s27
  s_add_u32 s54, s54, 344064
  v_mfma_f32_16x16x32_bf16 v[28:31], v[208:211], a[244:247], v[28:31]
  buffer_load_dwordx4 v3, s[4:7], s52 offen offset:1024 sc1 lds
  v_fma_f32 v56, -v71, v40, v48
  v_mfma_f32_16x16x32_bf16 v[24:27], v[204:207], a[248:251], v[24:27]
  ds_read_b128 a[244:247], v3 offset:54272
  v_fma_f32 v57, -v71, v41, v49
  v_fma_f32 v58, -v71, v42, v50
  v_mfma_f32_16x16x32_bf16 v[28:31], v[200:203], a[248:251], v[28:31]
  v_fma_f32 v59, -v71, v43, v51
  v_fma_f32 v60, -v71, v44, v52
  v_mfma_f32_16x16x32_bf16 v[24:27], v[196:199], a[252:255], v[24:27]
  ds_read_b128 a[248:251], v3 offset:55296
  v_fma_f32 v61, -v71, v45, v53
  v_fma_f32 v62, -v71, v46, v54
  v_mfma_f32_16x16x32_bf16 v[28:31], v[192:195], a[252:255], v[28:31]
  buffer_load_dwordx4 v3, s[4:7], s52 offen offset:2048 sc1 lds
  v_fma_f32 v63, -v71, v47, v55
  v_mfma_f32_16x16x32_bf16 v[24:27], v[188:191], a[224:227], v[24:27]
  ds_read_b128 a[252:255], v3 offset:56320
  v_fma_f32 v56, v32, v70, v56
  v_fma_f32 v57, v33, v70, v57
  v_mfma_f32_16x16x32_bf16 v[28:31], v[184:187], a[224:227], v[28:31]
  v_fma_f32 v58, v34, v70, v58
  v_fma_f32 v59, v35, v70, v59
  v_mfma_f32_16x16x32_bf16 v[24:27], v[180:183], a[228:231], v[24:27]
  ds_read_b128 a[224:227], v3 offset:57344
  v_fma_f32 v60, v36, v70, v60
  v_fma_f32 v61, v37, v70, v61
  v_mfma_f32_16x16x32_bf16 v[28:31], v[176:179], a[228:231], v[28:31]
  s_waitcnt lgkmcnt(5)
  buffer_load_dwordx4 v3, s[4:7], s52 offen offset:3072 sc1 lds
  s_add_u32 s52, s52, 4096
  v_mfma_f32_16x16x32_bf16 v[24:27], v[172:175], a[232:235], v[24:27]
  ds_read_b128 a[228:231], v3 offset:58368
  s_add_u32 m0, s30, 4096
  v_fma_f32 v62, v38, v70, v62
  v_mfma_f32_16x16x32_bf16 v[28:31], v[168:171], a[232:235], v[28:31]
  v_fma_f32 v63, v39, v70, v63
  v_mul_f32 v56, v56, |v56|
  v_mfma_f32_16x16x32_bf16 v[24:27], v[164:167], a[236:239], v[24:27]
  ds_read_b128 a[232:235], v3 offset:59392
  v_mul_f32 v57, v57, |v57|
  v_mul_f32 v58, v58, |v58|
  v_mfma_f32_16x16x32_bf16 v[28:31], v[160:163], a[236:239], v[28:31]
  s_waitcnt lgkmcnt(5)
  buffer_load_dwordx4 v3, s[4:7], s52 offen offset:0 sc1 lds
  v_mul_f32 v59, v59, |v59|
  v_mfma_f32_16x16x32_bf16 v[24:27], v[156:159], a[240:243], v[24:27]
  ds_read_b128 a[236:239], v3 offset:60416
  v_mul_f32 v60, v60, |v60|
  v_mul_f32 v61, v61, |v61|
  v_mfma_f32_16x16x32_bf16 v[28:31], v[152:155], a[240:243], v[28:31]
  v_mul_f32 v62, v62, |v62|
  v_mul_f32 v63, v63, |v63|
  v_mfma_f32_16x16x32_bf16 v[24:27], v[148:151], a[244:247], v[24:27]
  s_waitcnt vmcnt(19)
  s_barrier
  s_add_u32 s52, s3, s8
  ds_read_b128 a[240:243], v4 offset:0
  s_add_u32 s52, s52, 8409088
  s_add_u32 m0, s30, 20480
  v_mfma_f32_16x16x32_bf16 v[28:31], v[144:147], a[244:247], v[28:31]
  s_waitcnt lgkmcnt(5)
  buffer_load_dwordx4 v3, s[4:7], s52 offen offset:0 sc1 lds
  v_cvt_pk_bf16_f32 v64, v56, v57
  v_mfma_f32_16x16x32_bf16 v[24:27], v[140:143], a[248:251], v[24:27]
  ds_read_b128 a[244:247], v4 offset:1024
  v_cvt_pk_bf16_f32 v65, v58, v59
  v_cvt_pk_bf16_f32 v66, v60, v61
  v_mfma_f32_16x16x32_bf16 v[28:31], v[136:139], a[248:251], v[28:31]
  v_cvt_pk_bf16_f32 v67, v62, v63
  v_pk_max_i16 v64, v64, 0
  v_mfma_f32_16x16x32_bf16 v[24:27], v[132:135], a[252:255], v[24:27]
  ds_read_b128 a[248:251], v4 offset:2048
  v_pk_max_i16 v65, v65, 0
  v_pk_max_i16 v66, v66, 0
  v_mfma_f32_16x16x32_bf16 v[28:31], v[128:131], a[252:255], v[28:31]
  s_waitcnt lgkmcnt(5)
  buffer_load_dwordx4 v3, s[4:7], s52 offen offset:1024 sc1 lds
  v_pk_max_i16 v67, v67, 0
  v_mfma_f32_16x16x32_bf16 v[24:27], v[124:127], a[224:227], v[24:27]
  ds_read_b128 a[252:255], v4 offset:3072
  buffer_store_dwordx4 v[64:67], v3, s[4:7], s54 offen sc1
  v_mfma_f32_16x16x32_bf16 v[28:31], v[120:123], a[224:227], v[28:31]
  v_mfma_f32_16x16x32_bf16 v[24:27], v[116:119], a[228:231], v[24:27]
  ds_read_b128 a[224:227], v4 offset:4096
  v_mfma_f32_16x16x32_bf16 v[28:31], v[112:115], a[228:231], v[28:31]
  s_waitcnt lgkmcnt(5)
  buffer_load_dwordx4 v3, s[4:7], s52 offen offset:2048 sc1 lds
  s_waitcnt vmcnt(15)
  v_mfma_f32_16x16x32_bf16 v[24:27], v[108:111], a[232:235], v[24:27]
  ds_read_b128 a[228:231], v4 offset:5120
  v_add_f32 v72, v72, v74
  v_add_f32 v73, v73, v75
  v_mfma_f32_16x16x32_bf16 v[28:31], v[104:107], a[232:235], v[28:31]
  v_add_f32 v76, v76, v78
  v_add_f32 v77, v77, v79
  v_mfma_f32_16x16x32_bf16 v[24:27], v[100:103], a[236:239], v[24:27]
  ds_read_b128 a[232:235], v4 offset:6144
  v_add_f32 v72, v72, v76
  v_add_f32 v73, v73, v77
  v_mfma_f32_16x16x32_bf16 v[28:31], v[96:99], a[236:239], v[28:31]
  s_waitcnt lgkmcnt(5)
  buffer_load_dwordx4 v3, s[4:7], s52 offen offset:3072 sc1 lds
  s_add_u32 s52, s52, 4096
  v_mfma_f32_16x16x32_bf16 v[32:35], v[252:255], a[240:243], 0
  ds_read_b128 a[236:239], v4 offset:7168
  s_add_u32 m0, s30, 24576
  v_mov_b32 v74, v72
  v_mfma_f32_16x16x32_bf16 v[36:39], v[248:251], a[240:243], 0
  v_mov_b32 v75, v73
  v_permlane16_swap_b32 v72, v74
  v_mfma_f32_16x16x32_bf16 v[32:35], v[244:247], a[244:247], v[32:35]
  ds_read_b128 a[240:243], v4 offset:8192
  v_permlane16_swap_b32 v73, v75
  v_add_f32 v72, v72, v74
  v_mfma_f32_16x16x32_bf16 v[36:39], v[240:243], a[244:247], v[36:39]
  s_waitcnt lgkmcnt(5)
  buffer_load_dwordx4 v3, s[4:7], s52 offen offset:0 sc1 lds
  v_add_f32 v73, v73, v75
  v_mfma_f32_16x16x32_bf16 v[32:35], v[236:239], a[248:251], v[32:35]
  ds_read_b128 a[244:247], v4 offset:9216
  ds_read_b64 v[68:69], v23 offset:256
  v_mov_b32 v74, v72
  v_mfma_f32_16x16x32_bf16 v[36:39], v[232:235], a[248:251], v[36:39]
  v_mov_b32 v75, v73
  v_permlane32_swap_b32 v72, v74
  v_mfma_f32_16x16x32_bf16 v[32:35], v[228:231], a[252:255], v[32:35]
  ds_read_b128 a[248:251], v4 offset:10240
  v_permlane32_swap_b32 v73, v75
  v_add_f32 v72, v72, v74
  v_mfma_f32_16x16x32_bf16 v[36:39], v[224:227], a[252:255], v[36:39]
  s_waitcnt lgkmcnt(6)
  buffer_load_dwordx4 a[72:75], v3, s[4:7], s67 offen offset:3072
  v_add_f32 v73, v73, v75
  v_mfma_f32_16x16x32_bf16 v[32:35], v[220:223], a[224:227], v[32:35]
  ds_read_b128 a[252:255], v4 offset:11264
  v_mul_f32 v72, 0x3acccccd, v72
  v_mul_f32 v73, 0x3acccccd, v73
  v_mfma_f32_16x16x32_bf16 v[36:39], v[216:219], a[224:227], v[36:39]
  s_waitcnt lgkmcnt(2)
  s_add_u32 s54, s70, s27
  s_add_u32 s54, s54, 286720
  v_mfma_f32_16x16x32_bf16 v[32:35], v[212:215], a[228:231], v[32:35]
  ds_read_b128 a[224:227], v4 offset:12288
  v_fma_f32 v56, -v69, v40, v48
  v_fma_f32 v57, -v69, v41, v49
  v_mfma_f32_16x16x32_bf16 v[36:39], v[208:211], a[228:231], v[36:39]
  buffer_load_dwordx4 a[76:79], v3, s[4:7], s68 offen offset:3072
  s_add_u32 s63, s64, 4096
  v_mfma_f32_16x16x32_bf16 v[32:35], v[204:207], a[232:235], v[32:35]
  ds_read_b128 a[228:231], v4 offset:13312
  v_fma_f32 v58, -v69, v42, v50
  v_fma_f32 v59, -v69, v43, v51
  v_mfma_f32_16x16x32_bf16 v[36:39], v[200:203], a[232:235], v[36:39]
  v_fma_f32 v60, -v69, v44, v52
  v_fma_f32 v61, -v69, v45, v53
  v_mfma_f32_16x16x32_bf16 v[32:35], v[196:199], a[236:239], v[32:35]
  ds_read_b128 a[232:235], v4 offset:14336
  v_fma_f32 v62, -v69, v46, v54
  v_fma_f32 v63, -v69, v47, v55
  v_mfma_f32_16x16x32_bf16 v[36:39], v[192:195], a[236:239], v[36:39]
  buffer_load_dwordx4 a[80:83], v3, s[4:7], s63 offen offset:0
  s_add_u32 s63, s65, 4096
  v_mfma_f32_16x16x32_bf16 v[32:35], v[188:191], a[240:243], v[32:35]
  ds_read_b128 a[236:239], v4 offset:15360
  v_fma_f32 v56, v24, v68, v56
  v_fma_f32 v57, v25, v68, v57
  v_mfma_f32_16x16x32_bf16 v[36:39], v[184:187], a[240:243], v[36:39]
  v_fma_f32 v58, v26, v68, v58
  v_fma_f32 v59, v27, v68, v59
  v_mfma_f32_16x16x32_bf16 v[32:35], v[180:183], a[244:247], v[32:35]
  ds_read_b128 a[240:243], v4 offset:16384
  v_fma_f32 v60, v28, v68, v60
  v_fma_f32 v61, v29, v68, v61
  v_mfma_f32_16x16x32_bf16 v[36:39], v[176:179], a[244:247], v[36:39]
  s_waitcnt lgkmcnt(5)
  buffer_load_dwordx4 a[84:87], v3, s[4:7], s63 offen offset:0
  s_add_u32 s63, s66, 4096
  v_mfma_f32_16x16x32_bf16 v[32:35], v[172:175], a[248:251], v[32:35]
  ds_read_b128 a[244:247], v4 offset:17408
  v_fma_f32 v62, v30, v68, v62
  v_fma_f32 v63, v31, v68, v63
  v_mfma_f32_16x16x32_bf16 v[36:39], v[168:171], a[248:251], v[36:39]
  v_mul_f32 v56, v56, |v56|
  v_mul_f32 v57, v57, |v57|
  v_mfma_f32_16x16x32_bf16 v[32:35], v[164:167], a[252:255], v[32:35]
  ds_read_b128 a[248:251], v4 offset:18432
  v_mul_f32 v58, v58, |v58|
  v_mul_f32 v59, v59, |v59|
  v_mfma_f32_16x16x32_bf16 v[36:39], v[160:163], a[252:255], v[36:39]
  s_waitcnt lgkmcnt(5)
  buffer_load_dwordx4 a[88:91], v3, s[4:7], s63 offen offset:0
  s_add_u32 s63, s67, 4096
  v_mfma_f32_16x16x32_bf16 v[32:35], v[156:159], a[224:227], v[32:35]
  ds_read_b128 a[252:255], v4 offset:19456
  v_mul_f32 v60, v60, |v60|
  v_mul_f32 v61, v61, |v61|
  v_mfma_f32_16x16x32_bf16 v[36:39], v[152:155], a[224:227], v[36:39]
  v_mul_f32 v62, v62, |v62|
  v_mul_f32 v63, v63, |v63|
  v_mfma_f32_16x16x32_bf16 v[32:35], v[148:151], a[228:231], v[32:35]
  s_waitcnt vmcnt(16)
  s_barrier
  s_add_u32 s52, s3, s8
  ds_read_b128 a[224:227], v4 offset:20480
  s_add_u32 s52, s52, 8388608
  s_add_u32 m0, s30, 40960
  v_mfma_f32_16x16x32_bf16 v[36:39], v[144:147], a[228:231], v[36:39]
  s_waitcnt lgkmcnt(5)
  buffer_load_dwordx4 v3, s[4:7], s52 offen offset:0 sc1 lds
  v_cvt_pk_bf16_f32 v64, v56, v57
  v_mfma_f32_16x16x32_bf16 v[32:35], v[140:143], a[232:235], v[32:35]
  ds_read_b128 a[228:231], v4 offset:21504
  v_cvt_pk_bf16_f32 v65, v58, v59
  v_cvt_pk_bf16_f32 v66, v60, v61
  v_mfma_f32_16x16x32_bf16 v[36:39], v[136:139], a[232:235], v[36:39]
  v_cvt_pk_bf16_f32 v67, v62, v63
  v_pk_max_i16 v64, v64, 0
  v_mfma_f32_16x16x32_bf16 v[32:35], v[132:135], a[236:239], v[32:35]
  ds_read_b128 a[232:235], v4 offset:22528
  v_pk_max_i16 v65, v65, 0
  v_pk_max_i16 v66, v66, 0
  v_mfma_f32_16x16x32_bf16 v[36:39], v[128:131], a[236:239], v[36:39]
  s_waitcnt lgkmcnt(5)
  buffer_load_dwordx4 v3, s[4:7], s52 offen offset:1024 sc1 lds
  v_pk_max_i16 v67, v67, 0
  v_mfma_f32_16x16x32_bf16 v[32:35], v[124:127], a[240:243], v[32:35]
  ds_read_b128 a[236:239], v4 offset:23552
  buffer_store_dwordx4 v[64:67], v3, s[4:7], s54 offen sc1
  v_fma_f32 v73, -v72, v72, v73
  v_mfma_f32_16x16x32_bf16 v[36:39], v[120:123], a[240:243], v[36:39]
  v_max_f32 v73, 0, v73
  v_cvt_pk_bf16_f32 v74, v72, v73
  v_mfma_f32_16x16x32_bf16 v[32:35], v[116:119], a[244:247], v[32:35]
  ds_read_b128 a[240:243], v4 offset:24576
  v_lshlrev_b32 v72, 16, v74
  v_and_b32 v73, 0xffff0000, v74
  v_mfma_f32_16x16x32_bf16 v[36:39], v[112:115], a[244:247], v[36:39]
  s_waitcnt lgkmcnt(5)
  buffer_load_dwordx4 v3, s[4:7], s52 offen offset:2048 sc1 lds
  v_add_f32 v73, 0x3727c5ac, v73
  v_mfma_f32_16x16x32_bf16 v[32:35], v[108:111], a[248:251], v[32:35]
  ds_read_b128 a[244:247], v4 offset:25600
  v_cvt_pk_bf16_f32 v73, v73, v73
  v_lshlrev_b32 v73, 16, v73
  v_mfma_f32_16x16x32_bf16 v[36:39], v[104:107], a[248:251], v[36:39]
  v_sqrt_f32 v73, v73
  s_nop 0
  v_cvt_pk_bf16_f32 v73, v73, v73
  v_mfma_f32_16x16x32_bf16 v[32:35], v[100:103], a[252:255], v[32:35]
  ds_read_b128 a[248:251], v4 offset:26624
  v_lshlrev_b32 v73, 16, v73
  v_rcp_f32 v74, v73
  v_mfma_f32_16x16x32_bf16 v[36:39], v[96:99], a[252:255], v[36:39]
  s_waitcnt lgkmcnt(5)
  buffer_load_dwordx4 v3, s[4:7], s52 offen offset:3072 sc1 lds
  s_add_u32 s52, s52, 4096
  v_mfma_f32_16x16x32_bf16 v[24:27], v[252:255], a[224:227], 0
  ds_read_b128 a[252:255], v4 offset:27648
  s_add_u32 m0, s30, 45056
  s_lshl_b32 s53, s20, 7
  v_add_u32 v76, s53, v23
  v_mfma_f32_16x16x32_bf16 v[28:31], v[248:251], a[224:227], 0
  v_mul_f32 v75, v72, v74
  ds_write_b64 v76, v[74:75] offset:512
  v_mfma_f32_16x16x32_bf16 v[24:27], v[244:247], a[228:231], v[24:27]
  ds_read_b128 a[224:227], v4 offset:28672
  v_mfma_f32_16x16x32_bf16 v[28:31], v[240:243], a[228:231], v[28:31]
  s_waitcnt lgkmcnt(6)
  buffer_load_dwordx4 v3, s[4:7], s52 offen offset:0 sc1 lds
  v_mfma_f32_16x16x32_bf16 v[24:27], v[236:239], a[232:235], v[24:27]
  ds_read_b128 a[228:231], v4 offset:29696
  ds_read_b64 v[70:71], v23 offset:384
  v_mfma_f32_16x16x32_bf16 v[28:31], v[232:235], a[232:235], v[28:31]
  v_mfma_f32_16x16x32_bf16 v[24:27], v[228:231], a[236:239], v[24:27]
  ds_read_b128 a[232:235], v4 offset:30720
  v_mfma_f32_16x16x32_bf16 v[28:31], v[224:227], a[236:239], v[28:31]
  s_waitcnt lgkmcnt(7)
  buffer_load_dwordx4 a[92:95], v3, s[4:7], s63 offen offset:0
  s_add_u32 s63, s68, 4096
  v_mfma_f32_16x16x32_bf16 v[24:27], v[220:223], a[240:243], v[24:27]
  ds_read_b128 a[236:239], v4 offset:31744
  v_mfma_f32_16x16x32_bf16 v[28:31], v[216:219], a[240:243], v[28:31]
  s_waitcnt lgkmcnt(2)
  s_add_u32 s54, s70, s27
  s_add_u32 s54, s54, 229376
  v_mfma_f32_16x16x32_bf16 v[24:27], v[212:215], a[244:247], v[24:27]
  ds_read_b128 a[240:243], v4 offset:32768
  v_fma_f32 v56, -v71, v40, v48
  v_fma_f32 v57, -v71, v41, v49
  v_mfma_f32_16x16x32_bf16 v[28:31], v[208:211], a[244:247], v[28:31]
  buffer_load_dwordx4 a[96:99], v3, s[4:7], s63 offen offset:0
  s_add_u32 s63, s64, 4096
  v_mfma_f32_16x16x32_bf16 v[24:27], v[204:207], a[248:251], v[24:27]
  ds_read_b128 a[244:247], v4 offset:33792
  v_fma_f32 v58, -v71, v42, v50
  v_fma_f32 v59, -v71, v43, v51
  v_mfma_f32_16x16x32_bf16 v[28:31], v[200:203], a[248:251], v[28:31]
  v_fma_f32 v60, -v71, v44, v52
  v_fma_f32 v61, -v71, v45, v53
  v_mfma_f32_16x16x32_bf16 v[24:27], v[196:199], a[252:255], v[24:27]
  ds_read_b128 a[248:251], v4 offset:34816
  v_fma_f32 v62, -v71, v46, v54
  v_fma_f32 v63, -v71, v47, v55
  v_mfma_f32_16x16x32_bf16 v[28:31], v[192:195], a[252:255], v[28:31]
  buffer_load_dwordx4 a[100:103], v3, s[4:7], s63 offen offset:1024
  s_add_u32 s63, s65, 4096
  v_mfma_f32_16x16x32_bf16 v[24:27], v[188:191], a[224:227], v[24:27]
  ds_read_b128 a[252:255], v4 offset:35840
  v_fma_f32 v56, v32, v70, v56
  v_fma_f32 v57, v33, v70, v57
  v_mfma_f32_16x16x32_bf16 v[28:31], v[184:187], a[224:227], v[28:31]
  v_fma_f32 v58, v34, v70, v58
  v_fma_f32 v59, v35, v70, v59
  v_mfma_f32_16x16x32_bf16 v[24:27], v[180:183], a[228:231], v[24:27]
  ds_read_b128 a[224:227], v4 offset:36864
  v_fma_f32 v60, v36, v70, v60
  v_fma_f32 v61, v37, v70, v61
  v_mfma_f32_16x16x32_bf16 v[28:31], v[176:179], a[228:231], v[28:31]
  s_waitcnt lgkmcnt(5)
  buffer_load_dwordx4 a[104:107], v3, s[4:7], s63 offen offset:1024
  s_add_u32 s63, s66, 4096
  v_mfma_f32_16x16x32_bf16 v[24:27], v[172:175], a[232:235], v[24:27]
  ds_read_b128 a[228:231], v4 offset:37888
  v_fma_f32 v62, v38, v70, v62
  v_fma_f32 v63, v39, v70, v63
  v_mfma_f32_16x16x32_bf16 v[28:31], v[168:171], a[232:235], v[28:31]
  v_mul_f32 v56, v56, |v56|
  v_mul_f32 v57, v57, |v57|
  v_mfma_f32_16x16x32_bf16 v[24:27], v[164:167], a[236:239], v[24:27]
  ds_read_b128 a[232:235], v4 offset:38912
  v_mul_f32 v58, v58, |v58|
  v_mul_f32 v59, v59, |v59|
  v_mfma_f32_16x16x32_bf16 v[28:31], v[160:163], a[236:239], v[28:31]
  s_waitcnt lgkmcnt(5)
  buffer_load_dwordx4 a[108:111], v3, s[4:7], s63 offen offset:1024
  s_add_u32 s63, s67, 4096
  v_mfma_f32_16x16x32_bf16 v[24:27], v[156:159], a[240:243], v[24:27]
  ds_read_b128 a[236:239], v4 offset:39936
  v_mul_f32 v60, v60, |v60|
  v_mul_f32 v61, v61, |v61|
  v_mfma_f32_16x16x32_bf16 v[28:31], v[152:155], a[240:243], v[28:31]
  v_mul_f32 v62, v62, |v62|
  v_mul_f32 v63, v63, |v63|
  v_mfma_f32_16x16x32_bf16 v[24:27], v[148:151], a[244:247], v[24:27]
  s_waitcnt vmcnt(22)
  s_barrier
  ds_read_b128 a[240:243], v3 offset:0
  v_cvt_pk_bf16_f32 v64, v56, v57
  v_cvt_pk_bf16_f32 v65, v58, v59
  v_mfma_f32_16x16x32_bf16 v[28:31], v[144:147], a[244:247], v[28:31]
  s_waitcnt lgkmcnt(5)
  buffer_load_dwordx4 a[112:115], v3, s[4:7], s63 offen offset:1024
  s_add_u32 s63, s68, 4096
  v_mfma_f32_16x16x32_bf16 v[24:27], v[140:143], a[248:251], v[24:27]
  ds_read_b128 a[244:247], v3 offset:1024
  v_cvt_pk_bf16_f32 v66, v60, v61
  v_cvt_pk_bf16_f32 v67, v62, v63
  v_mfma_f32_16x16x32_bf16 v[28:31], v[136:139], a[248:251], v[28:31]
  v_pk_max_i16 v64, v64, 0
  v_pk_max_i16 v65, v65, 0
  v_mfma_f32_16x16x32_bf16 v[24:27], v[132:135], a[252:255], v[24:27]
  ds_read_b128 a[248:251], v3 offset:2048
  v_pk_max_i16 v66, v66, 0
  v_pk_max_i16 v67, v67, 0
  v_mfma_f32_16x16x32_bf16 v[28:31], v[128:131], a[252:255], v[28:31]
  s_waitcnt lgkmcnt(5)
  buffer_load_dwordx4 a[116:119], v3, s[4:7], s63 offen offset:1024
  s_add_u32 s63, s64, 4096
  v_mfma_f32_16x16x32_bf16 v[24:27], v[124:127], a[224:227], v[24:27]
  ds_read_b128 a[252:255], v3 offset:3072
  buffer_store_dwordx4 v[64:67], v3, s[4:7], s54 offen sc1
  v_mfma_f32_16x16x32_bf16 v[28:31], v[120:123], a[224:227], v[28:31]
  v_mfma_f32_16x16x32_bf16 v[24:27], v[116:119], a[228:231], v[24:27]
  ds_read_b128 a[224:227], v3 offset:4096
  v_mfma_f32_16x16x32_bf16 v[28:31], v[112:115], a[228:231], v[28:31]
  s_waitcnt lgkmcnt(5)
  buffer_load_dwordx4 a[120:123], v3, s[4:7], s63 offen offset:2048
  s_add_u32 s63, s65, 4096
  v_mfma_f32_16x16x32_bf16 v[24:27], v[108:111], a[232:235], v[24:27]
  ds_read_b128 a[228:231], v3 offset:5120
  v_mfma_f32_16x16x32_bf16 v[28:31], v[104:107], a[232:235], v[28:31]
  v_mfma_f32_16x16x32_bf16 v[24:27], v[100:103], a[236:239], v[24:27]
  ds_read_b128 a[232:235], v3 offset:6144
  v_mfma_f32_16x16x32_bf16 v[28:31], v[96:99], a[236:239], v[28:31]
  s_waitcnt lgkmcnt(5)
  buffer_load_dwordx4 a[124:127], v3, s[4:7], s63 offen offset:2048
  s_add_u32 s63, s66, 4096
  v_mfma_f32_16x16x32_bf16 v[32:35], v[252:255], a[240:243], 0
  ds_read_b128 a[236:239], v3 offset:7168
  v_mfma_f32_16x16x32_bf16 v[36:39], v[248:251], a[240:243], 0
  v_mfma_f32_16x16x32_bf16 v[32:35], v[244:247], a[244:247], v[32:35]
  ds_read_b128 a[240:243], v3 offset:8192
  v_mfma_f32_16x16x32_bf16 v[36:39], v[240:243], a[244:247], v[36:39]
  s_waitcnt lgkmcnt(5)
  buffer_load_dwordx4 a[128:131], v3, s[4:7], s63 offen offset:2048
  s_add_u32 s63, s67, 4096
  v_mfma_f32_16x16x32_bf16 v[32:35], v[236:239], a[248:251], v[32:35]
  ds_read_b128 a[244:247], v3 offset:9216
  ds_read_b64 v[68:69], v23 offset:512
  v_mfma_f32_16x16x32_bf16 v[36:39], v[232:235], a[248:251], v[36:39]
  v_mfma_f32_16x16x32_bf16 v[32:35], v[228:231], a[252:255], v[32:35]
  ds_read_b128 a[248:251], v3 offset:10240
  v_mfma_f32_16x16x32_bf16 v[36:39], v[224:227], a[252:255], v[36:39]
  s_waitcnt lgkmcnt(6)
  buffer_load_dwordx4 a[132:135], v3, s[4:7], s63 offen offset:2048
  s_add_u32 s63, s68, 4096
  v_mfma_f32_16x16x32_bf16 v[32:35], v[220:223], a[224:227], v[32:35]
  ds_read_b128 a[252:255], v3 offset:11264
  v_mfma_f32_16x16x32_bf16 v[36:39], v[216:219], a[224:227], v[36:39]
  s_waitcnt lgkmcnt(2)
  s_add_u32 s54, s70, s27
  s_add_u32 s54, s54, 172032
  v_mfma_f32_16x16x32_bf16 v[32:35], v[212:215], a[228:231], v[32:35]
  ds_read_b128 a[224:227], v3 offset:12288
  v_fma_f32 v56, -v69, v40, v48
  v_fma_f32 v57, -v69, v41, v49
  v_mfma_f32_16x16x32_bf16 v[36:39], v[208:211], a[228:231], v[36:39]
  buffer_load_dwordx4 a[136:139], v3, s[4:7], s63 offen offset:2048
  s_add_u32 s63, s64, 4096
  v_mfma_f32_16x16x32_bf16 v[32:35], v[204:207], a[232:235], v[32:35]
  ds_read_b128 a[228:231], v3 offset:13312
  v_fma_f32 v58, -v69, v42, v50
  v_fma_f32 v59, -v69, v43, v51
  v_mfma_f32_16x16x32_bf16 v[36:39], v[200:203], a[232:235], v[36:39]
  v_fma_f32 v60, -v69, v44, v52
  v_fma_f32 v61, -v69, v45, v53
  v_mfma_f32_16x16x32_bf16 v[32:35], v[196:199], a[236:239], v[32:35]
  ds_read_b128 a[232:235], v3 offset:14336
  v_fma_f32 v62, -v69, v46, v54
  v_fma_f32 v63, -v69, v47, v55
  v_mfma_f32_16x16x32_bf16 v[36:39], v[192:195], a[236:239], v[36:39]
  buffer_load_dwordx4 a[140:143], v3, s[4:7], s63 offen offset:3072
  s_add_u32 s63, s65, 4096
  v_mfma_f32_16x16x32_bf16 v[32:35], v[188:191], a[240:243], v[32:35]
  ds_read_b128 a[236:239], v3 offset:15360
  v_fma_f32 v56, v24, v68, v56
  v_fma_f32 v57, v25, v68, v57
  v_mfma_f32_16x16x32_bf16 v[36:39], v[184:187], a[240:243], v[36:39]
  v_fma_f32 v58, v26, v68, v58
  v_fma_f32 v59, v27, v68, v59
  v_mfma_f32_16x16x32_bf16 v[32:35], v[180:183], a[244:247], v[32:35]
  ds_read_b128 a[240:243], v3 offset:16384
  v_fma_f32 v60, v28, v68, v60
  v_fma_f32 v61, v29, v68, v61
  v_mfma_f32_16x16x32_bf16 v[36:39], v[176:179], a[244:247], v[36:39]
  s_waitcnt lgkmcnt(5)
  buffer_load_dwordx4 a[144:147], v3, s[4:7], s63 offen offset:3072
  s_add_u32 s63, s66, 4096
  v_mfma_f32_16x16x32_bf16 v[32:35], v[172:175], a[248:251], v[32:35]
  ds_read_b128 a[244:247], v3 offset:17408
  v_fma_f32 v62, v30, v68, v62
  v_fma_f32 v63, v31, v68, v63
  v_mfma_f32_16x16x32_bf16 v[36:39], v[168:171], a[248:251], v[36:39]
  v_mul_f32 v56, v56, |v56|
  v_mul_f32 v57, v57, |v57|
  v_mfma_f32_16x16x32_bf16 v[32:35], v[164:167], a[252:255], v[32:35]
  ds_read_b128 a[248:251], v3 offset:18432
  v_mul_f32 v58, v58, |v58|
  v_mul_f32 v59, v59, |v59|
  v_mfma_f32_16x16x32_bf16 v[36:39], v[160:163], a[252:255], v[36:39]
  s_waitcnt lgkmcnt(5)
  buffer_load_dwordx4 a[148:151], v3, s[4:7], s63 offen offset:3072
  s_add_u32 s63, s67, 4096
  v_mfma_f32_16x16x32_bf16 v[32:35], v[156:159], a[224:227], v[32:35]
  ds_read_b128 a[252:255], v3 offset:19456
  v_mul_f32 v60, v60, |v60|
  v_mul_f32 v61, v61, |v61|
  v_mfma_f32_16x16x32_bf16 v[36:39], v[152:155], a[224:227], v[36:39]
  v_mul_f32 v62, v62, |v62|
  v_mul_f32 v63, v63, |v63|
  v_mfma_f32_16x16x32_bf16 v[32:35], v[148:151], a[228:231], v[32:35]
  s_waitcnt vmcnt(8)
  s_barrier
  s_cmp_lg_u32 s20, 0
  s_cbranch_scc1 Lf67
  s_add_u32 s62, s100, s28
  s_add_u32 s62, s62, 6144
  s_lshl_b32 s61, s22, 2
  s_add_u32 s62, s62, s61
  s_mov_b64 exec, 1
  s_cmp_eq_u32 s12, 1
  s_cbranch_scc1 Ldb68
  buffer_store_dword v86, v87, s[4:7], s62 offen sc1
  s_branch Lde68
Ldb68:
  buffer_store_dword v86, v87, s[4:7], s62 offen
Lde68:
  s_mov_b64 exec, -1
Lf67:
  ds_read_b128 a[224:227], v3 offset:20480
  v_cvt_pk_bf16_f32 v64, v56, v57
  v_cvt_pk_bf16_f32 v65, v58, v59
  v_mfma_f32_16x16x32_bf16 v[36:39], v[144:147], a[228:231], v[36:39]
  s_waitcnt lgkmcnt(5)
  buffer_load_dwordx4 a[152:155], v3, s[4:7], s63 offen offset:3072
  s_add_u32 s63, s68, 4096
  v_mfma_f32_16x16x32_bf16 v[32:35], v[140:143], a[232:235], v[32:35]
  ds_read_b128 a[228:231], v3 offset:21504
  v_cvt_pk_bf16_f32 v66, v60, v61
  v_cvt_pk_bf16_f32 v67, v62, v63
  v_mfma_f32_16x16x32_bf16 v[36:39], v[136:139], a[232:235], v[36:39]
  v_pk_max_i16 v64, v64, 0
  v_pk_max_i16 v65, v65, 0
  v_mfma_f32_16x16x32_bf16 v[32:35], v[132:135], a[236:239], v[32:35]
  ds_read_b128 a[232:235], v3 offset:22528
  v_pk_max_i16 v66, v66, 0
  v_pk_max_i16 v67, v67, 0
  v_mfma_f32_16x16x32_bf16 v[36:39], v[128:131], a[236:239], v[36:39]
  s_waitcnt lgkmcnt(5)
  buffer_load_dwordx4 a[156:159], v3, s[4:7], s63 offen offset:3072
  s_add_u32 s63, s64, 8192
  v_mfma_f32_16x16x32_bf16 v[32:35], v[124:127], a[240:243], v[32:35]
  ds_read_b128 a[236:239], v3 offset:23552
  buffer_store_dwordx4 v[64:67], v3, s[4:7], s54 offen sc1
  v_mfma_f32_16x16x32_bf16 v[36:39], v[120:123], a[240:243], v[36:39]
  v_mfma_f32_16x16x32_bf16 v[32:35], v[116:119], a[244:247], v[32:35]
  ds_read_b128 a[240:243], v3 offset:24576
  v_mfma_f32_16x16x32_bf16 v[36:39], v[112:115], a[244:247], v[36:39]
  s_waitcnt lgkmcnt(5)
  buffer_load_dwordx4 a[160:163], v3, s[4:7], s63 offen offset:0
  s_add_u32 s63, s65, 8192
  v_mfma_f32_16x16x32_bf16 v[32:35], v[108:111], a[248:251], v[32:35]
  ds_read_b128 a[244:247], v3 offset:25600
  v_mfma_f32_16x16x32_bf16 v[36:39], v[104:107], a[248:251], v[36:39]
  v_mfma_f32_16x16x32_bf16 v[32:35], v[100:103], a[252:255], v[32:35]
  ds_read_b128 a[248:251], v3 offset:26624
  v_mfma_f32_16x16x32_bf16 v[36:39], v[96:99], a[252:255], v[36:39]
  s_waitcnt lgkmcnt(5)
  buffer_load_dwordx4 a[164:167], v3, s[4:7], s63 offen offset:0
  s_add_u32 s63, s66, 8192
  v_mfma_f32_16x16x32_bf16 v[24:27], v[252:255], a[224:227], 0
  ds_read_b128 a[252:255], v3 offset:27648
  v_mfma_f32_16x16x32_bf16 v[28:31], v[248:251], a[224:227], 0
  v_mfma_f32_16x16x32_bf16 v[24:27], v[244:247], a[228:231], v[24:27]
  ds_read_b128 a[224:227], v3 offset:28672
  v_mfma_f32_16x16x32_bf16 v[28:31], v[240:243], a[228:231], v[28:31]
  s_waitcnt lgkmcnt(5)
  buffer_load_dwordx4 a[168:171], v3, s[4:7], s63 offen offset:0
  s_add_u32 s63, s67, 8192
  v_mfma_f32_16x16x32_bf16 v[24:27], v[236:239], a[232:235], v[24:27]
  ds_read_b128 a[228:231], v3 offset:29696
  ds_read_b64 v[70:71], v23 offset:640
  v_mfma_f32_16x16x32_bf16 v[28:31], v[232:235], a[232:235], v[28:31]
  v_mfma_f32_16x16x32_bf16 v[24:27], v[228:231], a[236:239], v[24:27]
  ds_read_b128 a[232:235], v3 offset:30720
  v_mfma_f32_16x16x32_bf16 v[28:31], v[224:227], a[236:239], v[28:31]
  s_waitcnt lgkmcnt(6)
  buffer_load_dwordx4 a[172:175], v3, s[4:7], s63 offen offset:0
  s_add_u32 s63, s68, 8192
  v_mfma_f32_16x16x32_bf16 v[24:27], v[220:223], a[240:243], v[24:27]
  ds_read_b128 a[236:239], v3 offset:31744
  v_mfma_f32_16x16x32_bf16 v[28:31], v[216:219], a[240:243], v[28:31]
  s_waitcnt lgkmcnt(2)
  s_add_u32 s54, s70, s27
  s_add_u32 s54, s54, 114688
  v_mfma_f32_16x16x32_bf16 v[24:27], v[212:215], a[244:247], v[24:27]
  ds_read_b128 a[240:243], v3 offset:32768
  v_fma_f32 v56, -v71, v40, v48
  v_fma_f32 v57, -v71, v41, v49
  v_mfma_f32_16x16x32_bf16 v[28:31], v[208:211], a[244:247], v[28:31]
  buffer_load_dwordx4 a[176:179], v3, s[4:7], s63 offen offset:0
  s_add_u32 s63, s64, 8192
  v_mfma_f32_16x16x32_bf16 v[24:27], v[204:207], a[248:251], v[24:27]
  ds_read_b128 a[244:247], v3 offset:33792
  v_fma_f32 v58, -v71, v42, v50
  v_fma_f32 v59, -v71, v43, v51
  v_mfma_f32_16x16x32_bf16 v[28:31], v[200:203], a[248:251], v[28:31]
  v_fma_f32 v60, -v71, v44, v52
  v_fma_f32 v61, -v71, v45, v53
  v_mfma_f32_16x16x32_bf16 v[24:27], v[196:199], a[252:255], v[24:27]
  ds_read_b128 a[248:251], v3 offset:34816
  v_fma_f32 v62, -v71, v46, v54
  v_fma_f32 v63, -v71, v47, v55
  v_mfma_f32_16x16x32_bf16 v[28:31], v[192:195], a[252:255], v[28:31]
  buffer_load_dwordx4 a[180:183], v3, s[4:7], s63 offen offset:1024
  s_add_u32 s63, s65, 8192
  v_mfma_f32_16x16x32_bf16 v[24:27], v[188:191], a[224:227], v[24:27]
  ds_read_b128 a[252:255], v3 offset:35840
  v_fma_f32 v56, v32, v70, v56
  v_fma_f32 v57, v33, v70, v57
  v_mfma_f32_16x16x32_bf16 v[28:31], v[184:187], a[224:227], v[28:31]
  v_fma_f32 v58, v34, v70, v58
  v_fma_f32 v59, v35, v70, v59
  v_mfma_f32_16x16x32_bf16 v[24:27], v[180:183], a[228:231], v[24:27]
  ds_read_b128 a[224:227], v3 offset:36864
  v_fma_f32 v60, v36, v70, v60
  v_fma_f32 v61, v37, v70, v61
  v_mfma_f32_16x16x32_bf16 v[28:31], v[176:179], a[228:231], v[28:31]
  s_waitcnt lgkmcnt(5)
  buffer_load_dwordx4 a[184:187], v3, s[4:7], s63 offen offset:1024
  s_add_u32 s63, s66, 8192
  v_mfma_f32_16x16x32_bf16 v[24:27], v[172:175], a[232:235], v[24:27]
  ds_read_b128 a[228:231], v3 offset:37888
  v_fma_f32 v62, v38, v70, v62
  v_fma_f32 v63, v39, v70, v63
  v_mfma_f32_16x16x32_bf16 v[28:31], v[168:171], a[232:235], v[28:31]
  v_mul_f32 v56, v56, |v56|
  v_mul_f32 v57, v57, |v57|
  v_mfma_f32_16x16x32_bf16 v[24:27], v[164:167], a[236:239], v[24:27]
  ds_read_b128 a[232:235], v3 offset:38912
  v_mul_f32 v58, v58, |v58|
  v_mul_f32 v59, v59, |v59|
  v_mfma_f32_16x16x32_bf16 v[28:31], v[160:163], a[236:239], v[28:31]
  s_waitcnt lgkmcnt(5)
  buffer_load_dwordx4 a[188:191], v3, s[4:7], s63 offen offset:1024
  s_add_u32 s63, s67, 8192
  v_mfma_f32_16x16x32_bf16 v[24:27], v[156:159], a[240:243], v[24:27]
  ds_read_b128 a[236:239], v3 offset:39936
  v_mul_f32 v60, v60, |v60|
  v_mul_f32 v61, v61, |v61|
  v_mfma_f32_16x16x32_bf16 v[28:31], v[152:155], a[240:243], v[28:31]
  v_mul_f32 v62, v62, |v62|
  v_mul_f32 v63, v63, |v63|
  v_mfma_f32_16x16x32_bf16 v[24:27], v[148:151], a[244:247], v[24:27]
  s_barrier
  s_xor_b32 s96, s45, 0
  s_lshl_b32 s59, s34, 1
  s_add_u32 s96, s96, s59
  s_add_u32 s96, s96, s29
  s_add_u32 s96, s96, 4
  s_mul_i32 s96, s96, 57344
  s_mul_i32 s59, s20, 14336
  s_add_u32 s96, s96, s59
  s_add_u32 s96, s96, s27
  s_add_u32 s96, s96, 25165824
  s_xor_b32 s97, s45, 1
  s_lshl_b32 s59, s34, 1
  s_add_u32 s97, s97, s59
  s_add_u32 s97, s97, s29
  s_add_u32 s97, s97, 4
  s_mul_i32 s97, s97, 57344
  s_mul_i32 s59, s20, 14336
  s_add_u32 s97, s97, s59
  s_add_u32 s97, s97, s27
  s_add_u32 s97, s97, 25165824
  s_xor_b32 s98, s45, 0
  s_lshl_b32 s59, s34, 1
  s_add_u32 s98, s98, s59
  s_add_u32 s98, s98, s29
  s_mul_i32 s98, s98, 57344
  s_mul_i32 s59, s20, 14336
  s_add_u32 s98, s98, s59
  s_add_u32 s98, s98, s27
  s_add_u32 s98, s98, 25165824
  s_xor_b32 s99, s45, 1
  s_lshl_b32 s59, s34, 1
  s_add_u32 s99, s99, s59
  s_add_u32 s99, s99, s29
  s_mul_i32 s99, s99, 57344
  s_mul_i32 s59, s20, 14336
  s_add_u32 s99, s99, s59
  s_add_u32 s99, s99, s27
  s_add_u32 s99, s99, 25165824
  s_add_u32 s62, s100, s28
  s_add_u32 s62, s62, 6144
  buffer_load_dword v84, v5, s[4:7], s62 offen sc1
  ds_read_b128 a[240:243], v3 offset:40960
  v_cvt_pk_bf16_f32 v64, v56, v57
  v_cvt_pk_bf16_f32 v65, v58, v59
  v_mfma_f32_16x16x32_bf16 v[28:31], v[144:147], a[244:247], v[28:31]
  s_waitcnt lgkmcnt(5)
  buffer_load_dwordx4 a[192:195], v3, s[4:7], s63 offen offset:1024
  s_add_u32 s63, s68, 8192
  v_mfma_f32_16x16x32_bf16 v[24:27], v[140:143], a[248:251], v[24:27]
  ds_read_b128 a[244:247], v3 offset:41984
  v_cvt_pk_bf16_f32 v66, v60, v61
  v_cvt_pk_bf16_f32 v67, v62, v63
  v_mfma_f32_16x16x32_bf16 v[28:31], v[136:139], a[248:251], v[28:31]
  v_pk_max_i16 v64, v64, 0
  v_pk_max_i16 v65, v65, 0
  v_mfma_f32_16x16x32_bf16 v[24:27], v[132:135], a[252:255], v[24:27]
  ds_read_b128 a[248:251], v3 offset:43008
  v_pk_max_i16 v66, v66, 0
  v_pk_max_i16 v67, v67, 0
  v_mfma_f32_16x16x32_bf16 v[28:31], v[128:131], a[252:255], v[28:31]
  s_waitcnt lgkmcnt(5)
  buffer_load_dwordx4 a[196:199], v3, s[4:7], s63 offen offset:1024
  s_add_u32 s63, s64, 8192
  v_mfma_f32_16x16x32_bf16 v[24:27], v[124:127], a[224:227], v[24:27]
  ds_read_b128 a[252:255], v3 offset:44032
  buffer_store_dwordx4 v[64:67], v3, s[4:7], s54 offen sc1
  v_mfma_f32_16x16x32_bf16 v[28:31], v[120:123], a[224:227], v[28:31]
  v_mfma_f32_16x16x32_bf16 v[24:27], v[116:119], a[228:231], v[24:27]
  ds_read_b128 a[224:227], v3 offset:45056
  v_mfma_f32_16x16x32_bf16 v[28:31], v[112:115], a[228:231], v[28:31]
  s_waitcnt lgkmcnt(5)
  buffer_load_dwordx4 a[200:203], v3, s[4:7], s63 offen offset:2048
  s_add_u32 s63, s65, 8192
  v_mfma_f32_16x16x32_bf16 v[24:27], v[108:111], a[232:235], v[24:27]
  ds_read_b128 a[228:231], v3 offset:46080
  v_mfma_f32_16x16x32_bf16 v[28:31], v[104:107], a[232:235], v[28:31]
  v_mfma_f32_16x16x32_bf16 v[24:27], v[100:103], a[236:239], v[24:27]
  ds_read_b128 a[232:235], v3 offset:47104
  v_mfma_f32_16x16x32_bf16 v[28:31], v[96:99], a[236:239], v[28:31]
  s_waitcnt lgkmcnt(5)
  buffer_load_dwordx4 a[204:207], v3, s[4:7], s63 offen offset:2048
  s_add_u32 s63, s66, 8192
  v_mfma_f32_16x16x32_bf16 v[32:35], v[252:255], a[240:243], 0
  ds_read_b128 a[236:239], v3 offset:48128
  v_mfma_f32_16x16x32_bf16 v[36:39], v[248:251], a[240:243], 0
  v_mfma_f32_16x16x32_bf16 v[32:35], v[244:247], a[244:247], v[32:35]
  ds_read_b128 a[240:243], v3 offset:49152
  v_mfma_f32_16x16x32_bf16 v[36:39], v[240:243], a[244:247], v[36:39]
  s_waitcnt lgkmcnt(5)
  buffer_load_dwordx4 a[208:211], v3, s[4:7], s63 offen offset:2048
  s_add_u32 s63, s67, 8192
  v_mfma_f32_16x16x32_bf16 v[32:35], v[236:239], a[248:251], v[32:35]
  ds_read_b128 a[244:247], v3 offset:50176
  ds_read_b64 v[68:69], v23 offset:768
  v_mfma_f32_16x16x32_bf16 v[36:39], v[232:235], a[248:251], v[36:39]
  v_mfma_f32_16x16x32_bf16 v[32:35], v[228:231], a[252:255], v[32:35]
  ds_read_b128 a[248:251], v3 offset:51200
  v_mfma_f32_16x16x32_bf16 v[36:39], v[224:227], a[252:255], v[36:39]
  s_waitcnt lgkmcnt(6)
  buffer_load_dwordx4 a[212:215], v3, s[4:7], s63 offen offset:2048
  s_add_u32 s63, s68, 8192
  v_mfma_f32_16x16x32_bf16 v[32:35], v[220:223], a[224:227], v[32:35]
  ds_read_b128 a[252:255], v3 offset:52224
  v_mfma_f32_16x16x32_bf16 v[36:39], v[216:219], a[224:227], v[36:39]
  s_waitcnt lgkmcnt(2)
  s_add_u32 s54, s70, s27
  s_add_u32 s54, s54, 57344
  v_mfma_f32_16x16x32_bf16 v[32:35], v[212:215], a[228:231], v[32:35]
  ds_read_b128 a[224:227], v3 offset:53248
  v_fma_f32 v56, -v69, v40, v48
  v_fma_f32 v57, -v69, v41, v49
  v_mfma_f32_16x16x32_bf16 v[36:39], v[208:211], a[228:231], v[36:39]
  buffer_load_dwordx4 a[216:219], v3, s[4:7], s63 offen offset:2048
  s_add_u32 s63, s64, 8192
  v_mfma_f32_16x16x32_bf16 v[32:35], v[204:207], a[232:235], v[32:35]
  ds_read_b128 a[228:231], v3 offset:54272
  v_fma_f32 v58, -v69, v42, v50
  v_fma_f32 v59, -v69, v43, v51
  v_mfma_f32_16x16x32_bf16 v[36:39], v[200:203], a[232:235], v[36:39]
  v_fma_f32 v60, -v69, v44, v52
  v_fma_f32 v61, -v69, v45, v53
  v_mfma_f32_16x16x32_bf16 v[32:35], v[196:199], a[236:239], v[32:35]
  ds_read_b128 a[232:235], v3 offset:55296
  v_fma_f32 v62, -v69, v46, v54
  v_fma_f32 v63, -v69, v47, v55
  v_mfma_f32_16x16x32_bf16 v[36:39], v[192:195], a[236:239], v[36:39]
  buffer_load_dwordx4 a[220:223], v3, s[4:7], s63 offen offset:3072
  v_fma_f32 v56, v24, v68, v56
  v_mfma_f32_16x16x32_bf16 v[32:35], v[188:191], a[240:243], v[32:35]
  ds_read_b128 a[236:239], v3 offset:56320
  v_fma_f32 v57, v25, v68, v57
  v_fma_f32 v58, v26, v68, v58
  v_mfma_f32_16x16x32_bf16 v[36:39], v[184:187], a[240:243], v[36:39]
  v_fma_f32 v59, v27, v68, v59
  v_fma_f32 v60, v28, v68, v60
  v_mfma_f32_16x16x32_bf16 v[32:35], v[180:183], a[244:247], v[32:35]
  ds_read_b128 a[240:243], v3 offset:57344
  v_fma_f32 v61, v29, v68, v61
  v_fma_f32 v62, v30, v68, v62
  v_mfma_f32_16x16x32_bf16 v[36:39], v[176:179], a[244:247], v[36:39]
  s_waitcnt lgkmcnt(5)
  v_fma_f32 v63, v31, v68, v63
  v_mul_f32 v56, v56, |v56|
  v_mfma_f32_16x16x32_bf16 v[32:35], v[172:175], a[248:251], v[32:35]
  ds_read_b128 a[244:247], v3 offset:58368
  v_mul_f32 v57, v57, |v57|
  v_mul_f32 v58, v58, |v58|
  v_mfma_f32_16x16x32_bf16 v[36:39], v[168:171], a[248:251], v[36:39]
  v_mul_f32 v59, v59, |v59|
  v_mul_f32 v60, v60, |v60|
  v_mfma_f32_16x16x32_bf16 v[32:35], v[164:167], a[252:255], v[32:35]
  ds_read_b128 a[248:251], v3 offset:59392
  v_mul_f32 v61, v61, |v61|
  v_mul_f32 v62, v62, |v62|
  v_mfma_f32_16x16x32_bf16 v[36:39], v[160:163], a[252:255], v[36:39]
  s_waitcnt lgkmcnt(5)
  v_mul_f32 v63, v63, |v63|
  v_cvt_pk_bf16_f32 v64, v56, v57
  s_cmp_lg_u32 s20, 0
  s_cbranch_scc1 Lpd69
  s_waitcnt vmcnt(9)
  v_cmp_ne_u32 vcc, 1, v84
  s_cbranch_vccz Lpd69
  s_add_u32 s62, s100, s28
  s_add_u32 s62, s62, 6144
  s_mov_b32 s61, 0
Lp69:
  buffer_load_dword v84, v5, s[4:7], s62 offen sc1
  s_add_u32 s61, s61, 1
  s_cmp_gt_u32 s61, 0x100000
  s_cbranch_scc1 Lpd69
  s_waitcnt vmcnt(0)
  v_cmp_ne_u32 vcc, 1, v84
  s_cbranch_vccnz Lp69
Lpd69:
  s_barrier
  v_mfma_f32_16x16x32_bf16 v[32:35], v[156:159], a[224:227], v[32:35]
  ds_read_b128 a[252:255], v3 offset:60416
  buffer_load_dwordx4 v[160:163], v3, s[4:7], s96 offen offset:0 sc1
  v_cvt_pk_bf16_f32 v65, v58, v59
  v_mfma_f32_16x16x32_bf16 v[36:39], v[152:155], a[224:227], v[36:39]
  v_cvt_pk_bf16_f32 v66, v60, v61
  v_cvt_pk_bf16_f32 v67, v62, v63
  v_mfma_f32_16x16x32_bf16 v[32:35], v[148:151], a[228:231], v[32:35]
  v_pk_max_i16 v64, v64, 0
  v_pk_max_i16 v65, v65, 0
  v_mfma_f32_16x16x32_bf16 v[36:39], v[144:147], a[228:231], v[36:39]
  s_waitcnt lgkmcnt(4)
  v_pk_max_i16 v66, v66, 0
  v_pk_max_i16 v67, v67, 0
  v_mfma_f32_16x16x32_bf16 v[32:35], v[140:143], a[232:235], v[32:35]
  buffer_load_dwordx4 v[164:167], v3, s[4:7], s97 offen offset:0 sc1
  buffer_store_dwordx4 v[64:67], v3, s[4:7], s54 offen sc1
  v_mfma_f32_16x16x32_bf16 v[36:39], v[136:139], a[232:235], v[36:39]
  ds_read_b128 v[236:239], v0 offset:0
  v_add_u32 v242, s44, v0
  ds_read_b64 v[240:241], v242 offset:1024
  v_lshl_add_u32 v243, v13, 1, v1
  ds_read_b128 v[244:247], v243 offset:384
  ds_read_b128 v[248:251], v243 offset:400
  ds_read_b128 v[252:255], v243 offset:416
  v_mfma_f32_16x16x32_bf16 v[32:35], v[132:135], a[236:239], v[32:35]
  v_mfma_f32_16x16x32_bf16 v[36:39], v[128:131], a[236:239], v[36:39]
  s_waitcnt lgkmcnt(7)
  v_mfma_f32_16x16x32_bf16 v[32:35], v[124:127], a[240:243], v[32:35]
  buffer_load_dwordx4 v[168:171], v3, s[4:7], s96 offen offset:1024 sc1
  s_add_u32 s63, s68, 12288
  v_mfma_f32_16x16x32_bf16 v[36:39], v[120:123], a[240:243], v[36:39]
  s_cmp_eq_u32 s20, 3
  s_cselect_b32 s63, 0x7ff00000, s63
  v_mfma_f32_16x16x32_bf16 v[32:35], v[116:119], a[244:247], v[32:35]
  s_waitcnt lgkmcnt(0)
  s_add_u32 s60, s43, -1
  v_and_b32 v240, s60, v240
  v_and_b32 v241, s60, v241
  v_mfma_f32_16x16x32_bf16 v[36:39], v[112:115], a[244:247], v[36:39]
  v_lshlrev_b32 v216, 16, v236
  v_add_f32 v216, v216, v244
  v_mfma_f32_16x16x32_bf16 v[32:35], v[108:111], a[248:251], v[32:35]
  buffer_load_dwordx4 v[172:175], v3, s[4:7], s97 offen offset:1024 sc1
  v_and_b32 v217, 0xffff0000, v236
  v_mfma_f32_16x16x32_bf16 v[36:39], v[104:107], a[248:251], v[36:39]
  v_add_f32 v217, v217, v245
  v_lshlrev_b32 v218, 16, v237
  v_mfma_f32_16x16x32_bf16 v[32:35], v[100:103], a[252:255], v[32:35]
  v_add_f32 v218, v218, v246
  v_and_b32 v219, 0xffff0000, v237
  v_mfma_f32_16x16x32_bf16 v[36:39], v[96:99], a[252:255], v[36:39]
  v_add_f32 v219, v219, v247
  v_lshlrev_b32 v220, 16, v238
  buffer_load_dwordx4 v[176:179], v3, s[4:7], s96 offen offset:2048 sc1
  buffer_load_dwordx4 v[180:183], v3, s[4:7], s97 offen offset:2048 sc1
  buffer_load_dwordx4 v[184:187], v3, s[4:7], s96 offen offset:3072 sc1
  buffer_load_dwordx4 v[188:191], v3, s[4:7], s97 offen offset:3072 sc1
  s_add_u32 s96, s96, 4096
  buffer_load_dwordx4 v[192:195], v3, s[4:7], s96 offen offset:0 sc1
  s_add_u32 s97, s97, 4096
  buffer_load_dwordx4 v[196:199], v3, s[4:7], s97 offen offset:0 sc1
  ds_read_b64 v[70:71], v23 offset:896
  s_waitcnt lgkmcnt(0)
  s_add_u32 s54, s70, s27
  s_add_u32 s54, s54, 0
  v_fma_f32 v56, -v71, v40, v48
  v_fma_f32 v57, -v71, v41, v49
  v_fma_f32 v58, -v71, v42, v50
  v_fma_f32 v59, -v71, v43, v51
  v_fma_f32 v60, -v71, v44, v52
  v_fma_f32 v61, -v71, v45, v53
  v_fma_f32 v62, -v71, v46, v54
  v_fma_f32 v63, -v71, v47, v55
  v_fma_f32 v56, v32, v70, v56
  v_fma_f32 v57, v33, v70, v57
  v_fma_f32 v58, v34, v70, v58
  v_fma_f32 v59, v35, v70, v59
  v_fma_f32 v60, v36, v70, v60
  v_fma_f32 v61, v37, v70, v61
  v_fma_f32 v62, v38, v70, v62
  v_fma_f32 v63, v39, v70, v63
  v_mul_f32 v56, v56, |v56|
  v_mul_f32 v57, v57, |v57|
  v_mul_f32 v58, v58, |v58|
  v_mul_f32 v59, v59, |v59|
  v_mul_f32 v60, v60, |v60|
  v_mul_f32 v61, v61, |v61|
  v_mul_f32 v62, v62, |v62|
  v_mul_f32 v63, v63, |v63|
  v_cvt_pk_bf16_f32 v64, v56, v57
  v_cvt_pk_bf16_f32 v65, v58, v59
  v_cvt_pk_bf16_f32 v66, v60, v61
  v_cvt_pk_bf16_f32 v67, v62, v63
  v_pk_max_i16 v64, v64, 0
  v_pk_max_i16 v65, v65, 0
  v_pk_max_i16 v66, v66, 0
  v_pk_max_i16 v67, v67, 0
  buffer_store_dwordx4 v[64:67], v3, s[4:7], s54 offen sc1
  v_add_f32 v220, v220, v248
  v_and_b32 v221, 0xffff0000, v238
  v_add_f32 v221, v221, v249
  v_lshlrev_b32 v222, 16, v239
  v_add_f32 v222, v222, v250
  v_and_b32 v223, 0xffff0000, v239
  v_add_f32 v223, v223, v251
  v_lshlrev_b32 v232, 16, v240
  v_add_f32 v232, v232, v252
  v_and_b32 v233, 0xffff0000, v240
  v_add_f32 v233, v233, v253
  v_lshlrev_b32 v234, 16, v241
  v_add_f32 v234, v234, v254
  v_and_b32 v235, 0xffff0000, v241
  v_add_f32 v235, v235, v255
  buffer_load_dwordx4 v[200:203], v3, s[4:7], s96 offen offset:1024 sc1
  buffer_load_dwordx4 v[204:207], v3, s[4:7], s97 offen offset:1024 sc1
  buffer_load_dwordx4 v[208:211], v3, s[4:7], s96 offen offset:2048 sc1
  buffer_load_dwordx4 v[212:215], v3, s[4:7], s97 offen offset:2048 sc1
  s_waitcnt vmcnt(14)
  v_mfma_f32_16x16x32_bf16 v[216:219], a[0:3], v[160:163], v[216:219]
  ds_read_b128 v[48:51], v0 offset:8192
  v_add_u32 v54, s44, v0
  ds_read_b64 v[52:53], v54 offset:9216
  v_lshl_add_u32 v55, v13, 1, v1
  ds_read_b128 v[56:59], v55 offset:384
  ds_read_b128 v[60:63], v55 offset:400
  ds_read_b128 v[64:67], v55 offset:416
  v_mfma_f32_16x16x32_bf16 v[220:223], a[4:7], v[160:163], v[220:223]
  v_mfma_f32_16x16x32_bf16 v[224:227], a[8:11], v[160:163], 0
  v_mfma_f32_16x16x32_bf16 v[228:231], a[12:15], v[160:163], 0
  buffer_load_dwordx4 v[136:139], v3, s[4:7], s63 offen offset:0
  s_add_u32 s63, s64, 12288
  v_mfma_f32_16x16x32_bf16 v[232:235], a[16:19], v[160:163], v[232:235]
  s_cmp_eq_u32 s20, 3
  s_cselect_b32 s63, 0x7ff00000, s63
  v_mfma_f32_16x16x32_bf16 v[236:239], a[0:3], v[164:167], 0
  s_waitcnt lgkmcnt(0)
  s_add_u32 s60, s43, -1
  v_and_b32 v52, s60, v52
  v_and_b32 v53, s60, v53
  v_mfma_f32_16x16x32_bf16 v[240:243], a[4:7], v[164:167], 0
  v_lshlrev_b32 v96, 16, v48
  v_add_f32 v96, v96, v56
  v_mfma_f32_16x16x32_bf16 v[244:247], a[8:11], v[164:167], 0
  buffer_load_dwordx4 v[140:143], v3, s[4:7], s63 offen offset:1024
  s_add_u32 s63, s65, 12288
  v_mfma_f32_16x16x32_bf16 v[248:251], a[12:15], v[164:167], 0
  s_cmp_eq_u32 s20, 3
  s_cselect_b32 s63, 0x7ff00000, s63
  v_mfma_f32_16x16x32_bf16 v[252:255], a[16:19], v[164:167], 0
  v_and_b32 v97, 0xffff0000, v48
  v_add_f32 v97, v97, v57
  buffer_load_dwordx4 v[160:163], v3, s[4:7], s96 offen offset:3072 sc1
  buffer_load_dwordx4 v[164:167], v3, s[4:7], s97 offen offset:3072 sc1
  s_waitcnt vmcnt(15)
  v_mfma_f32_16x16x32_bf16 v[216:219], a[20:23], v[168:171], v[216:219]
  v_lshlrev_b32 v98, 16, v49
  v_add_f32 v98, v98, v58
  v_mfma_f32_16x16x32_bf16 v[220:223], a[24:27], v[168:171], v[220:223]
  v_and_b32 v99, 0xffff0000, v49
  v_add_f32 v99, v99, v59
  v_mfma_f32_16x16x32_bf16 v[224:227], a[28:31], v[168:171], v[224:227]
  v_lshlrev_b32 v100, 16, v50
  v_add_f32 v100, v100, v60
  v_mfma_f32_16x16x32_bf16 v[228:231], a[32:35], v[168:171], v[228:231]
  buffer_load_dwordx4 v[144:147], v3, s[4:7], s63 offen offset:1024
  s_add_u32 s63, s66, 12288
  v_mfma_f32_16x16x32_bf16 v[232:235], a[36:39], v[168:171], v[232:235]
  s_cmp_eq_u32 s20, 3
  s_cselect_b32 s63, 0x7ff00000, s63
  v_mfma_f32_16x16x32_bf16 v[236:239], a[20:23], v[172:175], v[236:239]
  v_and_b32 v101, 0xffff0000, v50
  v_add_f32 v101, v101, v61
  v_mfma_f32_16x16x32_bf16 v[240:243], a[24:27], v[172:175], v[240:243]
  v_lshlrev_b32 v102, 16, v51
  v_add_f32 v102, v102, v62
  v_mfma_f32_16x16x32_bf16 v[244:247], a[28:31], v[172:175], v[244:247]
  buffer_load_dwordx4 v[148:151], v3, s[4:7], s63 offen offset:1024
  s_add_u32 s63, s67, 12288
  v_mfma_f32_16x16x32_bf16 v[248:251], a[32:35], v[172:175], v[248:251]
  s_cmp_eq_u32 s20, 3
  s_cselect_b32 s63, 0x7ff00000, s63
  v_mfma_f32_16x16x32_bf16 v[252:255], a[36:39], v[172:175], v[252:255]
  v_and_b32 v103, 0xffff0000, v51
  v_add_f32 v103, v103, v63
  s_add_u32 s96, s96, 4096
  buffer_load_dwordx4 v[168:171], v3, s[4:7], s96 offen offset:0 sc1
  s_add_u32 s97, s97, 4096
  buffer_load_dwordx4 v[172:175], v3, s[4:7], s97 offen offset:0 sc1
  s_waitcnt vmcnt(17)
  v_mfma_f32_16x16x32_bf16 v[216:219], a[40:43], v[176:179], v[216:219]
  v_lshlrev_b32 v112, 16, v52
  v_add_f32 v112, v112, v64
  v_mfma_f32_16x16x32_bf16 v[220:223], a[44:47], v[176:179], v[220:223]
  v_and_b32 v113, 0xffff0000, v52
  v_add_f32 v113, v113, v65
  v_mfma_f32_16x16x32_bf16 v[224:227], a[48:51], v[176:179], v[224:227]
  v_lshlrev_b32 v114, 16, v53
  v_add_f32 v114, v114, v66
  v_mfma_f32_16x16x32_bf16 v[228:231], a[52:55], v[176:179], v[228:231]
  buffer_load_dwordx4 v[152:155], v3, s[4:7], s63 offen offset:1024
  s_add_u32 s63, s68, 12288
  v_mfma_f32_16x16x32_bf16 v[232:235], a[56:59], v[176:179], v[232:235]
  s_cmp_eq_u32 s20, 3
  s_cselect_b32 s63, 0x7ff00000, s63
  v_mfma_f32_16x16x32_bf16 v[236:239], a[40:43], v[180:183], v[236:239]
  v_and_b32 v115, 0xffff0000, v53
  v_add_f32 v115, v115, v67
  v_mfma_f32_16x16x32_bf16 v[240:243], a[44:47], v[180:183], v[240:243]
  v_mfma_f32_16x16x32_bf16 v[244:247], a[48:51], v[180:183], v[244:247]
  buffer_load_dwordx4 v[156:159], v3, s[4:7], s63 offen offset:1024
  s_add_u32 s63, s65, 8192
  v_mfma_f32_16x16x32_bf16 v[248:251], a[52:55], v[180:183], v[248:251]
  v_mfma_f32_16x16x32_bf16 v[252:255], a[56:59], v[180:183], v[252:255]
  s_waitcnt vmcnt(14)
  s_barrier
  s_cmp_lg_u32 s20, 0
  s_cbranch_scc1 Lf70
  s_add_u32 s62, s100, s28
  s_add_u32 s62, s62, 7168
  s_lshl_b32 s61, s22, 2
  s_add_u32 s62, s62, s61
  s_mov_b64 exec, 1
  s_cmp_eq_u32 s12, 1
  s_cbranch_scc1 Ldb71
  buffer_store_dword v86, v87, s[4:7], s62 offen sc1
  s_branch Lde71
Ldb71:
  buffer_store_dword v86, v87, s[4:7], s62 offen
Lde71:
  s_mov_b64 exec, -1
Lf70:
  buffer_load_dwordx4 v[176:179], v3, s[4:7], s96 offen offset:1024 sc1
  buffer_load_dwordx4 v[180:183], v3, s[4:7], s97 offen offset:1024 sc1
  v_mfma_f32_16x16x32_bf16 v[216:219], a[60:63], v[184:187], v[216:219]
  v_mfma_f32_16x16x32_bf16 v[220:223], a[64:67], v[184:187], v[220:223]
  v_mfma_f32_16x16x32_bf16 v[224:227], a[68:71], v[184:187], v[224:227]
  v_mfma_f32_16x16x32_bf16 v[228:231], a[72:75], v[184:187], v[228:231]
  buffer_load_dwordx4 a[224:227], v3, s[4:7], s63 offen offset:3072
  s_add_u32 s63, s66, 8192
  v_mfma_f32_16x16x32_bf16 v[232:235], a[76:79], v[184:187], v[232:235]
  v_mfma_f32_16x16x32_bf16 v[236:239], a[60:63], v[188:191], v[236:239]
  v_mfma_f32_16x16x32_bf16 v[240:243], a[64:67], v[188:191], v[240:243]
  v_mfma_f32_16x16x32_bf16 v[244:247], a[68:71], v[188:191], v[244:247]
  buffer_load_dwordx4 a[228:231], v3, s[4:7], s63 offen offset:3072
  s_add_u32 s63, s67, 8192
  v_mfma_f32_16x16x32_bf16 v[248:251], a[72:75], v[188:191], v[248:251]
  v_mfma_f32_16x16x32_bf16 v[252:255], a[76:79], v[188:191], v[252:255]
  buffer_load_dwordx4 v[184:187], v3, s[4:7], s96 offen offset:2048 sc1
  buffer_load_dwordx4 v[188:191], v3, s[4:7], s97 offen offset:2048 sc1
  v_mfma_f32_16x16x32_bf16 v[216:219], a[80:83], v[192:195], v[216:219]
  v_mfma_f32_16x16x32_bf16 v[220:223], a[84:87], v[192:195], v[220:223]
  v_mfma_f32_16x16x32_bf16 v[224:227], a[88:91], v[192:195], v[224:227]
  v_mfma_f32_16x16x32_bf16 v[228:231], a[92:95], v[192:195], v[228:231]
  buffer_load_dwordx4 a[232:235], v3, s[4:7], s63 offen offset:3072
  s_add_u32 s63, s68, 8192
  v_mfma_f32_16x16x32_bf16 v[232:235], a[96:99], v[192:195], v[232:235]
  v_mfma_f32_16x16x32_bf16 v[236:239], a[80:83], v[196:199], v[236:239]
  v_mfma_f32_16x16x32_bf16 v[240:243], a[84:87], v[196:199], v[240:243]
  v_mfma_f32_16x16x32_bf16 v[244:247], a[88:91], v[196:199], v[244:247]
  buffer_load_dwordx4 a[236:239], v3, s[4:7], s63 offen offset:3072
  s_add_u32 s63, s64, 12288
  v_mfma_f32_16x16x32_bf16 v[248:251], a[92:95], v[196:199], v[248:251]
  s_cmp_eq_u32 s20, 3
  s_cselect_b32 s63, 0x7ff00000, s63
  v_mfma_f32_16x16x32_bf16 v[252:255], a[96:99], v[196:199], v[252:255]
  buffer_load_dwordx4 v[192:195], v3, s[4:7], s96 offen offset:3072 sc1
  buffer_load_dwordx4 v[196:199], v3, s[4:7], s97 offen offset:3072 sc1
  s_waitcnt vmcnt(22)
  v_mfma_f32_16x16x32_bf16 v[216:219], a[100:103], v[200:203], v[216:219]
  v_mfma_f32_16x16x32_bf16 v[220:223], a[104:107], v[200:203], v[220:223]
  v_mfma_f32_16x16x32_bf16 v[224:227], a[108:111], v[200:203], v[224:227]
  v_mfma_f32_16x16x32_bf16 v[228:231], a[112:115], v[200:203], v[228:231]
  buffer_load_dwordx4 a[240:243], v3, s[4:7], s63 offen offset:0
  s_add_u32 s63, s65, 12288
  v_mfma_f32_16x16x32_bf16 v[232:235], a[116:119], v[200:203], v[232:235]
  s_cmp_eq_u32 s20, 3
  s_cselect_b32 s63, 0x7ff00000, s63
  v_mfma_f32_16x16x32_bf16 v[236:239], a[100:103], v[204:207], v[236:239]
  v_mfma_f32_16x16x32_bf16 v[240:243], a[104:107], v[204:207], v[240:243]
  v_mfma_f32_16x16x32_bf16 v[244:247], a[108:111], v[204:207], v[244:247]
  buffer_load_dwordx4 a[244:247], v3, s[4:7], s63 offen offset:0
  s_add_u32 s63, s66, 12288
  v_mfma_f32_16x16x32_bf16 v[248:251], a[112:115], v[204:207], v[248:251]
  s_cmp_eq_u32 s20, 3
  s_cselect_b32 s63, 0x7ff00000, s63
  v_mfma_f32_16x16x32_bf16 v[252:255], a[116:119], v[204:207], v[252:255]
  s_add_u32 s96, s96, 4096
  s_cmp_eq_u32 s20, 3
  s_cselect_b32 s96, 0x7ff00000, s96
  buffer_load_dwordx4 v[200:203], v3, s[4:7], s96 offen offset:0 sc1
  s_add_u32 s97, s97, 4096
  s_cmp_eq_u32 s20, 3
  s_cselect_b32 s97, 0x7ff00000, s97
  buffer_load_dwordx4 v[204:207], v3, s[4:7], s97 offen offset:0 sc1
  s_waitcnt vmcnt(24)
  v_mfma_f32_16x16x32_bf16 v[216:219], a[120:123], v[208:211], v[216:219]
  v_mfma_f32_16x16x32_bf16 v[220:223], a[124:127], v[208:211], v[220:223]
  v_mfma_f32_16x16x32_bf16 v[224:227], a[128:131], v[208:211], v[224:227]
  v_mfma_f32_16x16x32_bf16 v[228:231], a[132:135], v[208:211], v[228:231]
  buffer_load_dwordx4 a[248:251], v3, s[4:7], s63 offen offset:0
  s_add_u32 s63, s67, 12288
  v_mfma_f32_16x16x32_bf16 v[232:235], a[136:139], v[208:211], v[232:235]
  s_cmp_eq_u32 s20, 3
  s_cselect_b32 s63, 0x7ff00000, s63
  v_mfma_f32_16x16x32_bf16 v[236:239], a[120:123], v[212:215], v[236:239]
  v_mfma_f32_16x16x32_bf16 v[240:243], a[124:127], v[212:215], v[240:243]
  v_mfma_f32_16x16x32_bf16 v[244:247], a[128:131], v[212:215], v[244:247]
  buffer_load_dwordx4 a[252:255], v3, s[4:7], s63 offen offset:0
  v_mfma_f32_16x16x32_bf16 v[248:251], a[132:135], v[212:215], v[248:251]
  v_mfma_f32_16x16x32_bf16 v[252:255], a[136:139], v[212:215], v[252:255]
  buffer_load_dwordx4 v[208:211], v3, s[4:7], s96 offen offset:1024 sc1
  buffer_load_dwordx4 v[212:215], v3, s[4:7], s97 offen offset:1024 sc1
  s_waitcnt vmcnt(24)
  v_mfma_f32_16x16x32_bf16 v[216:219], a[140:143], v[160:163], v[216:219]
  v_mfma_f32_16x16x32_bf16 v[220:223], a[144:147], v[160:163], v[220:223]
  v_mfma_f32_16x16x32_bf16 v[224:227], a[148:151], v[160:163], v[224:227]
  v_mfma_f32_16x16x32_bf16 v[228:231], a[152:155], v[160:163], v[228:231]
  v_mfma_f32_16x16x32_bf16 v[232:235], a[156:159], v[160:163], v[232:235]
  v_mfma_f32_16x16x32_bf16 v[236:239], a[140:143], v[164:167], v[236:239]
  v_mfma_f32_16x16x32_bf16 v[240:243], a[144:147], v[164:167], v[240:243]
  v_mfma_f32_16x16x32_bf16 v[244:247], a[148:151], v[164:167], v[244:247]
  v_mfma_f32_16x16x32_bf16 v[248:251], a[152:155], v[164:167], v[248:251]
  v_mfma_f32_16x16x32_bf16 v[252:255], a[156:159], v[164:167], v[252:255]
  s_add_u32 s62, s100, s28
  s_add_u32 s62, s62, 7168
  buffer_load_dword v84, v5, s[4:7], s62 offen sc1
  s_waitcnt vmcnt(21)
  v_mfma_f32_16x16x32_bf16 v[216:219], a[160:163], v[168:171], v[216:219]
  v_mfma_f32_16x16x32_bf16 v[220:223], a[164:167], v[168:171], v[220:223]
  v_mfma_f32_16x16x32_bf16 v[224:227], a[168:171], v[168:171], v[224:227]
  v_mfma_f32_16x16x32_bf16 v[228:231], a[172:175], v[168:171], v[228:231]
  v_mfma_f32_16x16x32_bf16 v[232:235], a[176:179], v[168:171], v[232:235]
  v_mfma_f32_16x16x32_bf16 v[236:239], a[160:163], v[172:175], v[236:239]
  v_mfma_f32_16x16x32_bf16 v[240:243], a[164:167], v[172:175], v[240:243]
  v_mfma_f32_16x16x32_bf16 v[244:247], a[168:171], v[172:175], v[244:247]
  v_mfma_f32_16x16x32_bf16 v[248:251], a[172:175], v[172:175], v[248:251]
  v_mfma_f32_16x16x32_bf16 v[252:255], a[176:179], v[172:175], v[252:255]
  s_waitcnt vmcnt(17)
  v_mfma_f32_16x16x32_bf16 v[216:219], a[180:183], v[176:179], v[216:219]
  v_mfma_f32_16x16x32_bf16 v[220:223], a[184:187], v[176:179], v[220:223]
  v_mfma_f32_16x16x32_bf16 v[224:227], a[188:191], v[176:179], v[224:227]
  v_mfma_f32_16x16x32_bf16 v[228:231], a[192:195], v[176:179], v[228:231]
  v_mfma_f32_16x16x32_bf16 v[232:235], a[196:199], v[176:179], v[232:235]
  v_mfma_f32_16x16x32_bf16 v[236:239], a[180:183], v[180:183], v[236:239]
  v_mfma_f32_16x16x32_bf16 v[240:243], a[184:187], v[180:183], v[240:243]
  v_mfma_f32_16x16x32_bf16 v[244:247], a[188:191], v[180:183], v[244:247]
  v_mfma_f32_16x16x32_bf16 v[248:251], a[192:195], v[180:183], v[248:251]
  v_mfma_f32_16x16x32_bf16 v[252:255], a[196:199], v[180:183], v[252:255]
  s_cmp_lg_u32 s20, 0
  s_cbranch_scc1 Lpd72
  s_waitcnt vmcnt(0)
  v_cmp_ne_u32 vcc, 1, v84
  s_cbranch_vccz Lpd72
  s_add_u32 s62, s100, s28
  s_add_u32 s62, s62, 7168
  s_mov_b32 s61, 0
Lp72:
  buffer_load_dword v84, v5, s[4:7], s62 offen sc1
  s_add_u32 s61, s61, 1
  s_cmp_gt_u32 s61, 0x100000
  s_cbranch_scc1 Lpd72
  s_waitcnt vmcnt(0)
  v_cmp_ne_u32 vcc, 1, v84
  s_cbranch_vccnz Lp72
Lpd72:
  s_barrier
  buffer_load_dwordx4 v[160:163], v3, s[4:7], s98 offen offset:0 sc1
  buffer_load_dwordx4 v[164:167], v3, s[4:7], s99 offen offset:0 sc1
  buffer_load_dwordx4 v[168:171], v3, s[4:7], s98 offen offset:1024 sc1
  buffer_load_dwordx4 v[172:175], v3, s[4:7], s99 offen offset:1024 sc1
  buffer_load_dwordx4 v[176:179], v3, s[4:7], s98 offen offset:2048 sc1
  buffer_load_dwordx4 v[180:183], v3, s[4:7], s99 offen offset:2048 sc1
  s_waitcnt vmcnt(19)
  v_mfma_f32_16x16x32_bf16 v[216:219], a[200:203], v[184:187], v[216:219]
  v_mfma_f32_16x16x32_bf16 v[220:223], a[204:207], v[184:187], v[220:223]
  v_mfma_f32_16x16x32_bf16 v[224:227], a[208:211], v[184:187], v[224:227]
  v_mfma_f32_16x16x32_bf16 v[228:231], a[212:215], v[184:187], v[228:231]
  v_mfma_f32_16x16x32_bf16 v[232:235], a[216:219], v[184:187], v[232:235]
  v_mfma_f32_16x16x32_bf16 v[236:239], a[200:203], v[188:191], v[236:239]
  v_mfma_f32_16x16x32_bf16 v[240:243], a[204:207], v[188:191], v[240:243]
  v_mfma_f32_16x16x32_bf16 v[244:247], a[208:211], v[188:191], v[244:247]
  v_mfma_f32_16x16x32_bf16 v[248:251], a[212:215], v[188:191], v[248:251]
  v_mfma_f32_16x16x32_bf16 v[252:255], a[216:219], v[188:191], v[252:255]
  buffer_load_dwordx4 v[184:187], v3, s[4:7], s98 offen offset:3072 sc1
  buffer_load_dwordx4 v[188:191], v3, s[4:7], s99 offen offset:3072 sc1
  s_waitcnt vmcnt(17)
  v_mfma_f32_16x16x32_bf16 v[216:219], a[220:223], v[192:195], v[216:219]
  v_mfma_f32_16x16x32_bf16 v[220:223], a[224:227], v[192:195], v[220:223]
  v_mfma_f32_16x16x32_bf16 v[224:227], a[228:231], v[192:195], v[224:227]
  v_mfma_f32_16x16x32_bf16 v[228:231], a[232:235], v[192:195], v[228:231]
  v_mfma_f32_16x16x32_bf16 v[232:235], a[236:239], v[192:195], v[232:235]
  v_mfma_f32_16x16x32_bf16 v[236:239], a[220:223], v[196:199], v[236:239]
  v_mfma_f32_16x16x32_bf16 v[240:243], a[224:227], v[196:199], v[240:243]
  v_mfma_f32_16x16x32_bf16 v[244:247], a[228:231], v[196:199], v[244:247]
  v_mfma_f32_16x16x32_bf16 v[248:251], a[232:235], v[196:199], v[248:251]
  v_mfma_f32_16x16x32_bf16 v[252:255], a[236:239], v[196:199], v[252:255]
  s_add_u32 s98, s98, 4096
  buffer_load_dwordx4 v[192:195], v3, s[4:7], s98 offen offset:0 sc1
  s_add_u32 s99, s99, 4096
  buffer_load_dwordx4 v[196:199], v3, s[4:7], s99 offen offset:0 sc1
  s_waitcnt vmcnt(15)
  s_waitcnt vmcnt(13)
  v_mfma_f32_16x16x32_bf16 v[216:219], a[240:243], v[200:203], v[216:219]
  v_mfma_f32_16x16x32_bf16 v[220:223], a[244:247], v[200:203], v[220:223]
  v_mfma_f32_16x16x32_bf16 v[224:227], a[248:251], v[200:203], v[224:227]
  v_mfma_f32_16x16x32_bf16 v[228:231], a[252:255], v[200:203], v[228:231]
  v_mfma_f32_16x16x32_bf16 v[232:235], v[136:139], v[200:203], v[232:235]
  v_mfma_f32_16x16x32_bf16 v[236:239], a[240:243], v[204:207], v[236:239]
  v_mfma_f32_16x16x32_bf16 v[240:243], a[244:247], v[204:207], v[240:243]
  v_mfma_f32_16x16x32_bf16 v[244:247], a[248:251], v[204:207], v[244:247]
  v_mfma_f32_16x16x32_bf16 v[248:251], a[252:255], v[204:207], v[248:251]
  v_mfma_f32_16x16x32_bf16 v[252:255], v[136:139], v[204:207], v[252:255]
  buffer_load_dwordx4 v[200:203], v3, s[4:7], s98 offen offset:1024 sc1
  buffer_load_dwordx4 v[204:207], v3, s[4:7], s99 offen offset:1024 sc1
  s_waitcnt vmcnt(13)
  v_mfma_f32_16x16x32_bf16 v[216:219], v[140:143], v[208:211], v[216:219]
  v_mfma_f32_16x16x32_bf16 v[220:223], v[144:147], v[208:211], v[220:223]
  v_mfma_f32_16x16x32_bf16 v[224:227], v[148:151], v[208:211], v[224:227]
  v_mfma_f32_16x16x32_bf16 v[228:231], v[152:155], v[208:211], v[228:231]
  v_mfma_f32_16x16x32_bf16 v[232:235], v[156:159], v[208:211], v[232:235]
  v_mfma_f32_16x16x32_bf16 v[236:239], v[140:143], v[212:215], v[236:239]
  v_mfma_f32_16x16x32_bf16 v[240:243], v[144:147], v[212:215], v[240:243]
  v_mfma_f32_16x16x32_bf16 v[244:247], v[148:151], v[212:215], v[244:247]
  v_mfma_f32_16x16x32_bf16 v[248:251], v[152:155], v[212:215], v[248:251]
  v_mfma_f32_16x16x32_bf16 v[252:255], v[156:159], v[212:215], v[252:255]
  buffer_load_dwordx4 v[208:211], v3, s[4:7], s98 offen offset:2048 sc1
  buffer_load_dwordx4 v[212:215], v3, s[4:7], s99 offen offset:2048 sc1
  s_waitcnt vmcnt(12)
  v_mfma_f32_16x16x32_bf16 v[96:99], a[0:3], v[160:163], v[96:99]
  ds_write_b128 v16, v[236:239] offset:0
  ds_write_b128 v16, v[240:243] offset:1024
  v_mfma_f32_16x16x32_bf16 v[100:103], a[4:7], v[160:163], v[100:103]
  ds_write_b128 v17, v[224:227] offset:0
  ds_write_b128 v17, v[228:231] offset:1024
  v_mfma_f32_16x16x32_bf16 v[104:107], a[8:11], v[160:163], 0
  ds_write_b128 v18, v[244:247] offset:0
  ds_write_b128 v18, v[248:251] offset:1024
  v_mfma_f32_16x16x32_bf16 v[108:111], a[12:15], v[160:163], 0
  ds_write_b128 v17, v[232:235] offset:2048
  ds_write_b128 v19, v[252:255] offset:2048
  v_mfma_f32_16x16x32_bf16 v[112:115], a[16:19], v[160:163], v[112:115]
  s_waitcnt lgkmcnt(0)
  s_barrier
  v_mfma_f32_16x16x32_bf16 v[116:119], a[0:3], v[164:167], 0
  ds_read_b128 v[36:39], v20 offset:0
  ds_read_b128 v[40:43], v20 offset:1024
  v_mfma_f32_16x16x32_bf16 v[120:123], a[4:7], v[164:167], 0
  ds_read_b128 v[44:47], v20 offset:2048
  ds_read_b128 v[48:51], v20 offset:3072
  v_mfma_f32_16x16x32_bf16 v[124:127], a[8:11], v[164:167], 0
  ds_read_b128 v[52:55], v20 offset:4096
  ds_read_b128 v[56:59], v20 offset:5120
  v_mfma_f32_16x16x32_bf16 v[128:131], a[12:15], v[164:167], 0
  v_mov_b32 v68, 0x3f803f80
  v_mov_b32 v66, 0
  v_mfma_f32_16x16x32_bf16 v[132:135], a[16:19], v[164:167], 0
  v_mov_b32 v67, 0
  buffer_load_dwordx4 v[160:163], v3, s[4:7], s98 offen offset:3072 sc1
  buffer_load_dwordx4 v[164:167], v3, s[4:7], s99 offen offset:3072 sc1
  s_waitcnt vmcnt(12)
  v_mfma_f32_16x16x32_bf16 v[96:99], a[20:23], v[168:171], v[96:99]
  v_mfma_f32_16x16x32_bf16 v[100:103], a[24:27], v[168:171], v[100:103]
  v_mfma_f32_16x16x32_bf16 v[104:107], a[28:31], v[168:171], v[104:107]
  v_mfma_f32_16x16x32_bf16 v[108:111], a[32:35], v[168:171], v[108:111]
  s_waitcnt lgkmcnt(3)
  v_add_f32 v216, v216, v36
  v_add_f32 v217, v217, v37
  v_mfma_f32_16x16x32_bf16 v[112:115], a[36:39], v[168:171], v[112:115]
  v_add_f32 v218, v218, v38
  v_add_f32 v219, v219, v39
  v_mfma_f32_16x16x32_bf16 v[116:119], a[20:23], v[172:175], v[116:119]
  v_add_f32 v220, v220, v40
  v_add_f32 v221, v221, v41
  v_mfma_f32_16x16x32_bf16 v[120:123], a[24:27], v[172:175], v[120:123]
  v_add_f32 v222, v222, v42
  v_add_f32 v223, v223, v43
  v_mfma_f32_16x16x32_bf16 v[124:127], a[28:31], v[172:175], v[124:127]
  v_add_f32 v232, v232, v44
  v_add_f32 v233, v233, v45
  v_mfma_f32_16x16x32_bf16 v[128:131], a[32:35], v[172:175], v[128:131]
  v_add_f32 v234, v234, v46
  v_add_f32 v235, v235, v47
  v_mfma_f32_16x16x32_bf16 v[132:135], a[36:39], v[172:175], v[132:135]
  ds_read_b128 v[36:39], v20 offset:6144
  ds_read_b128 v[40:43], v20 offset:7168
  s_add_u32 s98, s98, 4096
  buffer_load_dwordx4 v[168:171], v3, s[4:7], s98 offen offset:0 sc1
  s_add_u32 s99, s99, 4096
  buffer_load_dwordx4 v[172:175], v3, s[4:7], s99 offen offset:0 sc1
  s_waitcnt vmcnt(12)
  v_mfma_f32_16x16x32_bf16 v[96:99], a[40:43], v[176:179], v[96:99]
  ds_read_b128 v[44:47], v20 offset:8192
  s_waitcnt lgkmcnt(3)
  v_mfma_f32_16x16x32_bf16 v[100:103], a[44:47], v[176:179], v[100:103]
  v_add_f32 v216, v216, v48
  v_add_f32 v217, v217, v49
  v_mfma_f32_16x16x32_bf16 v[104:107], a[48:51], v[176:179], v[104:107]
  v_add_f32 v218, v218, v50
  v_add_f32 v219, v219, v51
  v_mfma_f32_16x16x32_bf16 v[108:111], a[52:55], v[176:179], v[108:111]
  v_add_f32 v220, v220, v52
  v_add_f32 v221, v221, v53
  v_mfma_f32_16x16x32_bf16 v[112:115], a[56:59], v[176:179], v[112:115]
  v_add_f32 v222, v222, v54
  v_add_f32 v223, v223, v55
  v_mfma_f32_16x16x32_bf16 v[116:119], a[40:43], v[180:183], v[116:119]
  v_add_f32 v232, v232, v56
  v_add_f32 v233, v233, v57
  v_mfma_f32_16x16x32_bf16 v[120:123], a[44:47], v[180:183], v[120:123]
  v_add_f32 v234, v234, v58
  v_add_f32 v235, v235, v59
  v_mfma_f32_16x16x32_bf16 v[124:127], a[48:51], v[180:183], v[124:127]
  s_waitcnt lgkmcnt(0)
  v_add_f32 v216, v216, v36
  v_add_f32 v217, v217, v37
  v_mfma_f32_16x16x32_bf16 v[128:131], a[52:55], v[180:183], v[128:131]
  v_add_f32 v218, v218, v38
  v_add_f32 v219, v219, v39
  v_mfma_f32_16x16x32_bf16 v[132:135], a[56:59], v[180:183], v[132:135]
  v_add_f32 v220, v220, v40
  v_add_f32 v221, v221, v41
  buffer_load_dwordx4 v[176:179], v3, s[4:7], s98 offen offset:1024 sc1
  buffer_load_dwordx4 v[180:183], v3, s[4:7], s99 offen offset:1024 sc1
  s_waitcnt vmcnt(12)
  v_mfma_f32_16x16x32_bf16 v[96:99], a[60:63], v[184:187], v[96:99]
  v_add_f32 v222, v222, v42
  v_add_f32 v223, v223, v43
  v_mfma_f32_16x16x32_bf16 v[100:103], a[64:67], v[184:187], v[100:103]
  v_add_f32 v232, v232, v44
  v_add_f32 v233, v233, v45
  v_mfma_f32_16x16x32_bf16 v[104:107], a[68:71], v[184:187], v[104:107]
  v_add_f32 v234, v234, v46
  v_add_f32 v235, v235, v47
  v_mfma_f32_16x16x32_bf16 v[108:111], a[72:75], v[184:187], v[108:111]
  v_cvt_pk_bf16_f32 v60, v216, v217
  v_cvt_pk_bf16_f32 v61, v218, v219
  v_mfma_f32_16x16x32_bf16 v[112:115], a[76:79], v[184:187], v[112:115]
  v_cvt_pk_bf16_f32 v62, v220, v221
  v_cvt_pk_bf16_f32 v63, v222, v223
  v_mfma_f32_16x16x32_bf16 v[116:119], a[60:63], v[188:191], v[116:119]
  v_cvt_pk_bf16_f32 v64, v232, v233
  v_cvt_pk_bf16_f32 v65, v234, v235
  v_mfma_f32_16x16x32_bf16 v[120:123], a[64:67], v[188:191], v[120:123]
  s_add_u32 s60, s43, -1
  v_and_b32 v64, s60, v64
  v_and_b32 v65, s60, v65
  v_mfma_f32_16x16x32_bf16 v[124:127], a[68:71], v[188:191], v[124:127]
  s_lshl_b32 s59, s34, 1
  s_add_u32 s59, s59, s45
  s_add_u32 s59, s59, s29
  s_add_u32 s59, s59, 4
  s_mul_i32 s60, s59, 20480
  s_lshl_b32 s59, s41, 6
  s_add_u32 s59, s59, s60
  buffer_store_dwordx4 v[60:63], v22, s[16:19], s59 offen
  s_lshl_b32 s59, s42, 6
  s_add_u32 s59, s59, s60
  s_add_u32 s59, s59, s44
  s_cmp_eq_u32 s43, 1
  s_cselect_b32 s59, 0x7ff00000, s59
  buffer_store_dwordx2 v[64:65], v22, s[16:19], s59 offen
  v_mfma_f32_16x16x32_bf16 v[128:131], a[72:75], v[188:191], v[128:131]
  s_barrier
  v_mfma_f32_16x16x32_bf16 v[132:135], a[76:79], v[188:191], v[132:135]
  buffer_load_dwordx4 v[184:187], v3, s[4:7], s98 offen offset:2048 sc1
  buffer_load_dwordx4 v[188:191], v3, s[4:7], s99 offen offset:2048 sc1
  s_waitcnt vmcnt(14)
  v_mfma_f32_16x16x32_bf16 v[96:99], a[80:83], v[192:195], v[96:99]
  v_mfma_f32_16x16x32_bf16 v[100:103], a[84:87], v[192:195], v[100:103]
  v_mfma_f32_16x16x32_bf16 v[104:107], a[88:91], v[192:195], v[104:107]
  v_mfma_f32_16x16x32_bf16 v[108:111], a[92:95], v[192:195], v[108:111]
  v_mfma_f32_16x16x32_bf16 v[112:115], a[96:99], v[192:195], v[112:115]
  v_mfma_f32_16x16x32_bf16 v[116:119], a[80:83], v[196:199], v[116:119]
  v_mfma_f32_16x16x32_bf16 v[120:123], a[84:87], v[196:199], v[120:123]
  v_mfma_f32_16x16x32_bf16 v[124:127], a[88:91], v[196:199], v[124:127]
  v_mfma_f32_16x16x32_bf16 v[128:131], a[92:95], v[196:199], v[128:131]
  v_mfma_f32_16x16x32_bf16 v[132:135], a[96:99], v[196:199], v[132:135]
  buffer_load_dwordx4 v[192:195], v3, s[4:7], s98 offen offset:3072 sc1
  buffer_load_dwordx4 v[196:199], v3, s[4:7], s99 offen offset:3072 sc1
  s_waitcnt vmcnt(14)
  v_mfma_f32_16x16x32_bf16 v[96:99], a[100:103], v[200:203], v[96:99]
  v_mfma_f32_16x16x32_bf16 v[100:103], a[104:107], v[200:203], v[100:103]
  v_mfma_f32_16x16x32_bf16 v[104:107], a[108:111], v[200:203], v[104:107]
  v_mfma_f32_16x16x32_bf16 v[108:111], a[112:115], v[200:203], v[108:111]
  v_mfma_f32_16x16x32_bf16 v[112:115], a[116:119], v[200:203], v[112:115]
  v_mfma_f32_16x16x32_bf16 v[116:119], a[100:103], v[204:207], v[116:119]
  v_mfma_f32_16x16x32_bf16 v[120:123], a[104:107], v[204:207], v[120:123]
  v_mfma_f32_16x16x32_bf16 v[124:127], a[108:111], v[204:207], v[124:127]
  v_mfma_f32_16x16x32_bf16 v[128:131], a[112:115], v[204:207], v[128:131]
  v_mfma_f32_16x16x32_bf16 v[132:135], a[116:119], v[204:207], v[132:135]
  s_add_u32 s98, s98, 4096
  s_cmp_eq_u32 s20, 3
  s_cselect_b32 s98, 0x7ff00000, s98
  buffer_load_dwordx4 v[200:203], v3, s[4:7], s98 offen offset:0 sc1
  s_add_u32 s99, s99, 4096
  s_cmp_eq_u32 s20, 3
  s_cselect_b32 s99, 0x7ff00000, s99
  buffer_load_dwordx4 v[204:207], v3, s[4:7], s99 offen offset:0 sc1
  s_waitcnt vmcnt(14)
  v_mfma_f32_16x16x32_bf16 v[96:99], a[120:123], v[208:211], v[96:99]
  v_mfma_f32_16x16x32_bf16 v[100:103], a[124:127], v[208:211], v[100:103]
  v_mfma_f32_16x16x32_bf16 v[104:107], a[128:131], v[208:211], v[104:107]
  v_mfma_f32_16x16x32_bf16 v[108:111], a[132:135], v[208:211], v[108:111]
  v_mfma_f32_16x16x32_bf16 v[112:115], a[136:139], v[208:211], v[112:115]
  v_mfma_f32_16x16x32_bf16 v[116:119], a[120:123], v[212:215], v[116:119]
  v_mfma_f32_16x16x32_bf16 v[120:123], a[124:127], v[212:215], v[120:123]
  v_mfma_f32_16x16x32_bf16 v[124:127], a[128:131], v[212:215], v[124:127]
  v_mfma_f32_16x16x32_bf16 v[128:131], a[132:135], v[212:215], v[128:131]
  v_mfma_f32_16x16x32_bf16 v[132:135], a[136:139], v[212:215], v[132:135]
  buffer_load_dwordx4 v[208:211], v3, s[4:7], s98 offen offset:1024 sc1
  buffer_load_dwordx4 v[212:215], v3, s[4:7], s99 offen offset:1024 sc1
  s_waitcnt vmcnt(14)
  v_mfma_f32_16x16x32_bf16 v[96:99], a[140:143], v[160:163], v[96:99]
  v_mfma_f32_16x16x32_bf16 v[100:103], a[144:147], v[160:163], v[100:103]
  v_mfma_f32_16x16x32_bf16 v[104:107], a[148:151], v[160:163], v[104:107]
  v_mfma_f32_16x16x32_bf16 v[108:111], a[152:155], v[160:163], v[108:111]
  v_mfma_f32_16x16x32_bf16 v[112:115], a[156:159], v[160:163], v[112:115]
  v_mfma_f32_16x16x32_bf16 v[116:119], a[140:143], v[164:167], v[116:119]
  v_mfma_f32_16x16x32_bf16 v[120:123], a[144:147], v[164:167], v[120:123]
  v_mfma_f32_16x16x32_bf16 v[124:127], a[148:151], v[164:167], v[124:127]
  v_mfma_f32_16x16x32_bf16 v[128:131], a[152:155], v[164:167], v[128:131]
  v_mfma_f32_16x16x32_bf16 v[132:135], a[156:159], v[164:167], v[132:135]
  s_waitcnt vmcnt(12)
  v_mfma_f32_16x16x32_bf16 v[96:99], a[160:163], v[168:171], v[96:99]
  v_mfma_f32_16x16x32_bf16 v[100:103], a[164:167], v[168:171], v[100:103]
  v_mfma_f32_16x16x32_bf16 v[104:107], a[168:171], v[168:171], v[104:107]
  v_mfma_f32_16x16x32_bf16 v[108:111], a[172:175], v[168:171], v[108:111]
  v_mfma_f32_16x16x32_bf16 v[112:115], a[176:179], v[168:171], v[112:115]
  v_mfma_f32_16x16x32_bf16 v[116:119], a[160:163], v[172:175], v[116:119]
  v_mfma_f32_16x16x32_bf16 v[120:123], a[164:167], v[172:175], v[120:123]
  v_mfma_f32_16x16x32_bf16 v[124:127], a[168:171], v[172:175], v[124:127]
  v_mfma_f32_16x16x32_bf16 v[128:131], a[172:175], v[172:175], v[128:131]
  v_mfma_f32_16x16x32_bf16 v[132:135], a[176:179], v[172:175], v[132:135]
  s_waitcnt vmcnt(10)
  v_mfma_f32_16x16x32_bf16 v[96:99], a[180:183], v[176:179], v[96:99]
  v_mfma_f32_16x16x32_bf16 v[100:103], a[184:187], v[176:179], v[100:103]
  v_mfma_f32_16x16x32_bf16 v[104:107], a[188:191], v[176:179], v[104:107]
  v_mfma_f32_16x16x32_bf16 v[108:111], a[192:195], v[176:179], v[108:111]
  v_mfma_f32_16x16x32_bf16 v[112:115], a[196:199], v[176:179], v[112:115]
  v_mfma_f32_16x16x32_bf16 v[116:119], a[180:183], v[180:183], v[116:119]
  v_mfma_f32_16x16x32_bf16 v[120:123], a[184:187], v[180:183], v[120:123]
  v_mfma_f32_16x16x32_bf16 v[124:127], a[188:191], v[180:183], v[124:127]
  v_mfma_f32_16x16x32_bf16 v[128:131], a[192:195], v[180:183], v[128:131]
  v_mfma_f32_16x16x32_bf16 v[132:135], a[196:199], v[180:183], v[132:135]
  s_waitcnt vmcnt(6)
  v_mfma_f32_16x16x32_bf16 v[96:99], a[200:203], v[184:187], v[96:99]
  v_mfma_f32_16x16x32_bf16 v[100:103], a[204:207], v[184:187], v[100:103]
  v_mfma_f32_16x16x32_bf16 v[104:107], a[208:211], v[184:187], v[104:107]
  v_mfma_f32_16x16x32_bf16 v[108:111], a[212:215], v[184:187], v[108:111]
  v_mfma_f32_16x16x32_bf16 v[112:115], a[216:219], v[184:187], v[112:115]
  v_mfma_f32_16x16x32_bf16 v[116:119], a[200:203], v[188:191], v[116:119]
  v_mfma_f32_16x16x32_bf16 v[120:123], a[204:207], v[188:191], v[120:123]
  v_mfma_f32_16x16x32_bf16 v[124:127], a[208:211], v[188:191], v[124:127]
  v_mfma_f32_16x16x32_bf16 v[128:131], a[212:215], v[188:191], v[128:131]
  v_mfma_f32_16x16x32_bf16 v[132:135], a[216:219], v[188:191], v[132:135]
  s_waitcnt vmcnt(4)
  v_mfma_f32_16x16x32_bf16 v[96:99], a[220:223], v[192:195], v[96:99]
  v_mfma_f32_16x16x32_bf16 v[100:103], a[224:227], v[192:195], v[100:103]
  v_mfma_f32_16x16x32_bf16 v[104:107], a[228:231], v[192:195], v[104:107]
  v_mfma_f32_16x16x32_bf16 v[108:111], a[232:235], v[192:195], v[108:111]
  v_mfma_f32_16x16x32_bf16 v[112:115], a[236:239], v[192:195], v[112:115]
  v_mfma_f32_16x16x32_bf16 v[116:119], a[220:223], v[196:199], v[116:119]
  v_mfma_f32_16x16x32_bf16 v[120:123], a[224:227], v[196:199], v[120:123]
  v_mfma_f32_16x16x32_bf16 v[124:127], a[228:231], v[196:199], v[124:127]
  v_mfma_f32_16x16x32_bf16 v[128:131], a[232:235], v[196:199], v[128:131]
  v_mfma_f32_16x16x32_bf16 v[132:135], a[236:239], v[196:199], v[132:135]
  s_waitcnt vmcnt(2)
  v_mfma_f32_16x16x32_bf16 v[96:99], a[240:243], v[200:203], v[96:99]
  v_mfma_f32_16x16x32_bf16 v[100:103], a[244:247], v[200:203], v[100:103]
  v_mfma_f32_16x16x32_bf16 v[104:107], a[248:251], v[200:203], v[104:107]
  v_mfma_f32_16x16x32_bf16 v[108:111], a[252:255], v[200:203], v[108:111]
  v_mfma_f32_16x16x32_bf16 v[112:115], v[136:139], v[200:203], v[112:115]
  v_mfma_f32_16x16x32_bf16 v[116:119], a[240:243], v[204:207], v[116:119]
  v_mfma_f32_16x16x32_bf16 v[120:123], a[244:247], v[204:207], v[120:123]
  v_mfma_f32_16x16x32_bf16 v[124:127], a[248:251], v[204:207], v[124:127]
  v_mfma_f32_16x16x32_bf16 v[128:131], a[252:255], v[204:207], v[128:131]
  v_mfma_f32_16x16x32_bf16 v[132:135], v[136:139], v[204:207], v[132:135]
  s_waitcnt vmcnt(0)
  v_mfma_f32_16x16x32_bf16 v[96:99], v[140:143], v[208:211], v[96:99]
  v_mfma_f32_16x16x32_bf16 v[100:103], v[144:147], v[208:211], v[100:103]
  v_mfma_f32_16x16x32_bf16 v[104:107], v[148:151], v[208:211], v[104:107]
  v_mfma_f32_16x16x32_bf16 v[108:111], v[152:155], v[208:211], v[108:111]
  v_mfma_f32_16x16x32_bf16 v[112:115], v[156:159], v[208:211], v[112:115]
  v_mfma_f32_16x16x32_bf16 v[116:119], v[140:143], v[212:215], v[116:119]
  v_mfma_f32_16x16x32_bf16 v[120:123], v[144:147], v[212:215], v[120:123]
  v_mfma_f32_16x16x32_bf16 v[124:127], v[148:151], v[212:215], v[124:127]
  v_mfma_f32_16x16x32_bf16 v[128:131], v[152:155], v[212:215], v[128:131]
  v_mfma_f32_16x16x32_bf16 v[132:135], v[156:159], v[212:215], v[132:135]
  s_nop 3
  ds_write_b128 v16, v[116:119] offset:0
  ds_write_b128 v16, v[120:123] offset:1024
  ds_write_b128 v17, v[104:107] offset:0
  ds_write_b128 v17, v[108:111] offset:1024
  ds_write_b128 v18, v[124:127] offset:0
  ds_write_b128 v18, v[128:131] offset:1024
  ds_write_b128 v17, v[112:115] offset:2048
  ds_write_b128 v19, v[132:135] offset:2048
  s_waitcnt lgkmcnt(0)
  s_barrier
  ds_read_b128 v[172:175], v20 offset:0
  ds_read_b128 v[176:179], v20 offset:1024
  ds_read_b128 v[180:183], v20 offset:2048
  ds_read_b128 v[184:187], v20 offset:3072
  ds_read_b128 v[188:191], v20 offset:4096
  ds_read_b128 v[192:195], v20 offset:5120
  v_mov_b32 v204, 0x3f803f80
  v_mov_b32 v202, 0
  v_mov_b32 v203, 0
  s_waitcnt lgkmcnt(3)
  v_pk_add_f32 v[96:97], v[96:97], v[172:173]
  v_pk_add_f32 v[98:99], v[98:99], v[174:175]
  v_pk_add_f32 v[100:101], v[100:101], v[176:177]
  v_pk_add_f32 v[102:103], v[102:103], v[178:179]
  v_pk_add_f32 v[112:113], v[112:113], v[180:181]
  v_pk_add_f32 v[114:115], v[114:115], v[182:183]
  ds_read_b128 v[172:175], v20 offset:6144
  ds_read_b128 v[176:179], v20 offset:7168
  ds_read_b128 v[180:183], v20 offset:8192
  s_waitcnt lgkmcnt(3)
  v_pk_add_f32 v[96:97], v[96:97], v[184:185]
  v_pk_add_f32 v[98:99], v[98:99], v[186:187]
  v_pk_add_f32 v[100:101], v[100:101], v[188:189]
  v_pk_add_f32 v[102:103], v[102:103], v[190:191]
  v_pk_add_f32 v[112:113], v[112:113], v[192:193]
  v_pk_add_f32 v[114:115], v[114:115], v[194:195]
  s_waitcnt lgkmcnt(0)
  v_pk_add_f32 v[96:97], v[96:97], v[172:173]
  v_pk_add_f32 v[98:99], v[98:99], v[174:175]
  v_pk_add_f32 v[100:101], v[100:101], v[176:177]
  v_pk_add_f32 v[102:103], v[102:103], v[178:179]
  v_pk_add_f32 v[112:113], v[112:113], v[180:181]
  v_pk_add_f32 v[114:115], v[114:115], v[182:183]
  v_cvt_pk_bf16_f32 v196, v96, v97
  v_cvt_pk_bf16_f32 v197, v98, v99
  v_cvt_pk_bf16_f32 v198, v100, v101
  v_cvt_pk_bf16_f32 v199, v102, v103
  v_cvt_pk_bf16_f32 v200, v112, v113
  v_cvt_pk_bf16_f32 v201, v114, v115
  s_add_u32 s60, s43, -1
  v_and_b32 v200, s60, v200
  v_and_b32 v201, s60, v201
  s_lshl_b32 s59, s34, 1
  s_add_u32 s59, s59, s45
  s_add_u32 s59, s59, s29
  s_mul_i32 s60, s59, 20480
  s_lshl_b32 s59, s41, 6
  s_add_u32 s59, s59, s60
  buffer_store_dwordx4 v[196:199], v22, s[16:19], s59 offen
  s_lshl_b32 s59, s42, 6
  s_add_u32 s59, s59, s60
  s_add_u32 s59, s59, s44
  s_cmp_eq_u32 s43, 1
  s_cselect_b32 s59, 0x7ff00000, s59
  buffer_store_dwordx2 v[200:201], v22, s[16:19], s59 offen
main_kernel_end:
  s_endpgm
.section .rodata,"a"
.p2align 6
.amdhsa_kernel pack_kernel
  .amdhsa_next_free_vgpr 64
  .amdhsa_next_free_sgpr 102
  .amdhsa_accum_offset 64
  .amdhsa_group_segment_fixed_size 0
  .amdhsa_kernarg_size 88
  .amdhsa_user_sgpr_count 2
  .amdhsa_user_sgpr_kernarg_segment_ptr 1
  .amdhsa_system_sgpr_workgroup_id_x 1
.end_amdhsa_kernel
.p2align 6
.amdhsa_kernel main_kernel
  .amdhsa_next_free_vgpr 512
  .amdhsa_next_free_sgpr 102
  .amdhsa_accum_offset 256
  .amdhsa_group_segment_fixed_size 0
  .amdhsa_kernarg_size 88
  .amdhsa_user_sgpr_count 2
  .amdhsa_user_sgpr_kernarg_segment_ptr 1
  .amdhsa_system_sgpr_workgroup_id_x 1
.end_amdhsa_kernel
```
